```python
import torch

def _softmax(x, axis=-1):
    return torch.softmax(x, dim=axis)
def _gelu(x):
    return torch.nn.functional.gelu(x, approximate="tanh")
def _silu(x):
    return torch.nn.functional.silu(x)
def _sigmoid(x):
    return torch.sigmoid(x)
def _layernorm(x, axis=-1, eps=1e-5):
    m = x.mean(dim=axis, keepdim=True)
    v = x.var(dim=axis, keepdim=True, unbiased=False)
    return (x - m) / torch.sqrt(v + eps)
def _scatter_add(tgt, idx, src, axis=0):
    return tgt.clone().index_add_(axis, idx, src)
def _segment_sum(src, seg, n):
    out = torch.zeros((n,) + src.shape[1:], dtype=src.dtype)
    return out.index_add_(0, seg, src)
def _pad(x, pw):
    flat = tuple(v for pair in reversed(pw) for v in pair)
    return torch.nn.functional.pad(x, flat)

kernel_name = 'sequential_preLN__spectral_fnet__glu_gated_glu__prompt'

def setup_inputs():

    _w = (lambda a: (lambda t: t.to(torch.bfloat16) if t.is_floating_point() else t)(torch.as_tensor(a)))
    def _A_setup():
        B, S, D = 1, 2048, 640
        ns = torch.arange(S)[:, None] * torch.arange(S)[None, :]
        nd = torch.arange(D)[:, None] * torch.arange(D)[None, :]
        Ws_re = torch.cos(-2.0 * torch.pi * ns / S).to(float)
        Ws_im = torch.sin(-2.0 * torch.pi * ns / S).to(float)
        Wd_re = torch.cos(-2.0 * torch.pi * nd / D).to(float)
        Wd_im = torch.sin(-2.0 * torch.pi * nd / D).to(float)
        return {
            "x": _w((lambda *s: torch.randn(*s, dtype=torch.bfloat16) * 0.05)(B, S, D)),
            "dft_seq_re": _w(Ws_re),
            "dft_seq_im": _w(Ws_im),
            "dft_hid_re": _w(Wd_re),
            "dft_hid_im": _w(Wd_im),
        }
    _A_in = _A_setup()

    def _B_setup():
        B, S, D, F = 1, 2048, 640, 1728
        return {
            "x": _w((lambda *s: torch.randn(*s, dtype=torch.bfloat16) * 0.05)(B, S, D)),
            "w_gate": _w((lambda *s: torch.randn(*s, dtype=torch.bfloat16) * 1.6)(D, F)),
            "w_up": _w((lambda *s: torch.randn(*s, dtype=torch.bfloat16) * 0.8)(D, F)),
            "w_down": _w((lambda *s: torch.randn(*s, dtype=torch.bfloat16) * 0.8)(F, D)),
        }
    _B_in = _B_setup()

    return {
        "A_x": _A_in["x"],
        "A_dft_seq_re": _A_in["dft_seq_re"],
        "A_dft_seq_im": _A_in["dft_seq_im"],
        "A_dft_hid_re": _A_in["dft_hid_re"],
        "A_dft_hid_im": _A_in["dft_hid_im"],
        "B_x": _B_in["x"],
        "B_w_gate": _B_in["w_gate"],
        "B_w_up": _B_in["w_up"],
        "B_w_down": _B_in["w_down"],
    }

def reference(A_x, A_dft_seq_re, A_dft_seq_im, A_dft_hid_re, A_dft_hid_im, B_x, B_w_gate, B_w_up, B_w_down):
    def _A_ref(x, dft_seq_re, dft_seq_im, dft_hid_re, dft_hid_im):
        a = torch.einsum("bsd,ed->bse", x, dft_hid_re)
        b = torch.einsum("bsd,ed->bse", x, dft_hid_im)
        y = torch.einsum("ts,bse->bte", dft_seq_re, a) - torch.einsum("ts,bse->bte", dft_seq_im, b)
        return y

    def _B_ref(x, w_gate, w_up, w_down):
        g = torch.einsum("bsd,df->bsf", x, w_gate)
        u = torch.einsum("bsd,df->bsf", x, w_up)
        h = _sigmoid(g) * u
        return torch.einsum("bsf,fd->bsd", h, w_down)

    x = A_x
    h = x + _A_ref(_layernorm(x, axis=-1), A_dft_seq_re, A_dft_seq_im, A_dft_hid_re, A_dft_hid_im)
    h2 = h + _B_ref(_layernorm(h, axis=-1), B_w_gate, B_w_up, B_w_down)
    return h2
```

```asm
; @launch kernel=k1_kernel grid=(256,1,1) block=(512,1,1) lds=83008
; @launch kernel=k2_kernel grid=(256,1,1) block=(256,1,1) lds=20480
; @launch kernel=k3_kernel grid=(256,1,1) block=(512,1,1) lds=135168
; @launch kernel=k4_kernel grid=(256,1,1) block=(256,1,1) lds=147456
.amdgcn_target "amdgcn-amd-amdhsa--gfx950"
.text
.globl k1_kernel
.p2align 8
.type k1_kernel,@function
k1_kernel:
    s_cmp_ge_u32 s2, 256
    s_cbranch_scc1 k1k1_end1
    s_load_dwordx16 s[16:31], s[0:1], 0
    s_load_dwordx8 s[32:39], s[0:1], 64
    v_readfirstlane_b32 s64, v0
    v_and_b32 v1, 63, v0
    s_lshr_b32 s64, s64, 6
    v_and_b32 v2, 15, v1
    v_lshrrev_b32 v3, 4, v1
    v_lshrrev_b32 v4, 3, v1
    v_and_b32 v6, 7, v1
    v_xor_b32 v5, v6, v4
    v_lshlrev_b32 v5, 4, v5
    s_and_b32 s65, s2, 7
    s_lshl_b32 s65, s65, 3
    s_bfe_u32 s69, s2, 0x30003
    s_add_u32 s65, s65, s69
    s_lshr_b32 s66, s2, 6
    s_mul_i32 s67, s64, 320
    s_mul_i32 s68, s65, 1280
    s_mov_b32 s70, 52429
    v_add_u32 v6, s67, v1
    v_mul_u32_u24 v7, s70, v6
    v_lshrrev_b32 v7, 22, v7
    v_mul_u32_u24 v7, 80640, v7
    v_lshl_add_u32 v7, v6, 4, v7
    v_add_u32 v48, s68, v7
    v_add_u32 v6, s67, v1
    v_add_u32 v6, 64, v6
    v_mul_u32_u24 v7, s70, v6
    v_lshrrev_b32 v7, 22, v7
    v_mul_u32_u24 v7, 80640, v7
    v_lshl_add_u32 v7, v6, 4, v7
    v_add_u32 v49, s68, v7
    v_add_u32 v6, s67, v1
    v_add_u32 v6, 128, v6
    v_mul_u32_u24 v7, s70, v6
    v_lshrrev_b32 v7, 22, v7
    v_mul_u32_u24 v7, 80640, v7
    v_lshl_add_u32 v7, v6, 4, v7
    v_add_u32 v50, s68, v7
    v_add_u32 v6, s67, v1
    v_add_u32 v6, 192, v6
    v_mul_u32_u24 v7, s70, v6
    v_lshrrev_b32 v7, 22, v7
    v_mul_u32_u24 v7, 80640, v7
    v_lshl_add_u32 v7, v6, 4, v7
    v_add_u32 v51, s68, v7
    v_add_u32 v6, s67, v1
    v_add_u32 v6, 256, v6
    v_mul_u32_u24 v7, s70, v6
    v_lshrrev_b32 v7, 22, v7
    v_mul_u32_u24 v7, 80640, v7
    v_lshl_add_u32 v7, v6, 4, v7
    v_add_u32 v52, s68, v7
    s_mul_i32 s67, s64, 5120
    v_lshlrev_b32 v144, 4, v1
    s_waitcnt lgkmcnt(0)
    s_mov_b32 s40, s16
    s_mov_b32 s41, s17
    s_and_b32 s41, s41, 0xffff
    s_mov_b32 s42, 0x280000
    s_mov_b32 s43, 0x00020000
    s_add_u32 m0, s67, 0
    s_nop 0
    buffer_load_dwordx4 v48, s[40:43], 0 offen lds
    s_add_u32 m0, s67, 1024
    s_nop 0
    buffer_load_dwordx4 v49, s[40:43], 0 offen lds
    s_add_u32 m0, s67, 2048
    s_nop 0
    buffer_load_dwordx4 v50, s[40:43], 0 offen lds
    s_add_u32 m0, s67, 3072
    s_nop 0
    buffer_load_dwordx4 v51, s[40:43], 0 offen lds
    s_add_u32 m0, s67, 4096
    s_nop 0
    buffer_load_dwordx4 v52, s[40:43], 0 offen lds
    s_getpc_b64 s[44:45]
k1k1_pc2:
    s_add_u32 s44, s44, fnet_tbl-k1k1_pc2
    s_addc_u32 s45, s45, 0
    s_and_b32 s45, s45, 0xffff
    s_mov_b32 s46, 43008
    s_mov_b32 s47, 0x00020000
    s_lshl_b32 s67, s64, 11
    s_mul_i32 s68, s66, 3072
    s_add_u32 m0, s67, 62528
    s_cmp_eq_u32 s64, 7
    s_cselect_b32 s69, s68, 0
    s_add_u32 s69, s69, s67
    buffer_load_dwordx4 v144, s[44:47], s69 offen offset:0 lds
    buffer_load_dwordx4 v144, s[44:47], s69 offen offset:1024 lds
    s_mov_b32 m0, 78912
    s_add_u32 s69, s68, 16384
    buffer_load_dwordx4 v144, s[44:47], s69 offen lds
    s_mov_b32 s48, s38
    s_mov_b32 s49, s39
    s_and_b32 s49, s49, 0xffff
    s_mov_b32 s50, 0x500000
    s_mov_b32 s51, 0x00020000
    v_mov_b32 v148, 0
    v_lshlrev_b32 v149, 2, v2
    ds_write_b32 v149, v148 offset:40960
    s_mov_b32 s67, 0x3a000000
    v_add_u32 v150, 0, v2
    v_mul_u32_u24 v148, s65, v150
    v_cvt_f32_u32 v148, v148
    v_mul_f32 v148, s67, v148
    v_cos_f32 v40, v148
    v_sin_f32 v42, v148
    v_mov_b32 v41, v40
    v_mov_b32 v43, v42
    v_add_u32 v150, 16, v2
    v_mul_u32_u24 v149, s65, v150
    v_cvt_f32_u32 v149, v149
    v_mul_f32 v149, s67, v149
    v_cos_f32 v44, v149
    v_sin_f32 v46, v149
    v_mov_b32 v45, v44
    v_mov_b32 v47, v46
    v_mov_b32 v148, 0x42000000
    v_cmp_eq_u32 vcc, 0, v2
    s_nop 1
    v_cndmask_b32 v142, 0, v148, vcc
    v_lshrrev_b32 v6, 2, v2
    v_lshl_add_u32 v6, v3, 2, v6
    v_and_b32 v7, 3, v2
    v_mul_u32_u24 v136, 40, v6
    v_lshl_add_u32 v136, v7, 3, v136
    s_mul_i32 s67, s64, 5120
    v_add_u32 v136, s67, v136
    v_mul_u32_u24 v138, 672, v6
    v_lshl_add_u32 v138, v7, 3, v138
    s_lshl_b32 s68, s64, 5
    s_add_u32 s68, s68, 41024
    v_add_u32 v138, s68, v138
    v_lshlrev_b32 v137, 6, v2
    v_lshl_add_u32 v137, v3, 3, v137
    s_mul_i32 s68, s64, 2688
    s_add_u32 s68, s68, 41024
    v_add_u32 v137, s68, v137
    v_mul_u32_u24 v143, 1280, v3
    v_lshl_add_u32 v143, v2, 4, v143
    v_add_u32 v143, s67, v143
    v_and_b32 v6, 1, v3
    v_lshl_add_u32 v139, v2, 1, v6
    v_lshl_add_u32 v139, v139, 6, s65
    v_mul_u32_u24 v139, 1280, v139
    v_lshrrev_b32 v6, 1, v3
    v_lshl_add_u32 v139, v6, 4, v139
    s_mul_i32 s67, s66, 320
    s_lshl_b32 s68, s64, 5
    s_add_u32 s67, s67, s68
    v_add_u32 v139, s67, v139
    v_add_u32 v144, 62528, v144
    s_mov_b32 s62, 0x001f001f
    s_mov_b32 s63, 0x001f001f
    s_lshl_b32 s74, s64, 8
    s_add_u32 s74, s74, s2
    s_cmp_ge_u32 s74, 810
    s_cbranch_scc1 k1k1_not3
    s_mul_i32 s71, s74, 243
    s_lshr_b32 s71, s71, 16
    s_mul_i32 s67, s71, 270
    s_sub_u32 s67, s74, s67
    s_cmp_eq_u32 s71, 0
    s_cselect_b32 s52, s28, s30
    s_cselect_b32 s53, s29, s31
    s_cmp_eq_u32 s71, 2
    s_cselect_b32 s52, s32, s52
    s_cselect_b32 s53, s33, s53
    s_mov_b32 s72, 3456
    s_mov_b32 s73, 1280
    s_mov_b32 s68, 2428
    s_cselect_b32 s72, 1280, s72
    s_cselect_b32 s73, 3456, s73
    s_cselect_b32 s68, 6554, s68
    s_cselect_b32 s69, 10, 27
    s_and_b32 s53, s53, 0xffff
    s_mov_b32 s54, 0x21c000
    s_mov_b32 s55, 0x00020000
    s_add_u32 s56, s38, 0x1000000
    s_addc_u32 s57, s39, 0
    s_and_b32 s57, s57, 0xffff
    s_mov_b32 s58, 0x654000
    s_mov_b32 s59, 0x00020000
    s_mul_i32 s68, s67, s68
    s_lshr_b32 s68, s68, 16
    s_mul_i32 s69, s68, s69
    s_sub_u32 s69, s67, s69
    s_lshl_b32 s68, s68, 6
    s_lshl_b32 s69, s69, 6
    v_and_b32 v7, 7, v1
    v_lshl_add_u32 v6, v4, 3, s69
    v_lshl_add_u32 v7, v7, 3, s68
    v_mul_lo_u32 v140, v7, s72
    v_lshl_add_u32 v140, v6, 1, v140
    v_mul_lo_u32 v141, v6, s73
    v_lshl_add_u32 v141, v7, 1, v141
    s_mul_i32 s67, s71, 0x21c000
    v_add_u32 v141, s67, v141
k1k1_not3:
    s_waitcnt vmcnt(0) lgkmcnt(0)
    s_barrier
    ds_read_b128 v[48:51], v143 offset:0
    ds_read_b128 v[52:55], v143 offset:256
    ds_read_b128 v[56:59], v143 offset:512
    ds_read_b128 v[60:63], v143 offset:768
    ds_read_b128 v[64:67], v143 offset:1024
    ds_read_b64_tr_b16 a[68:69], v136 offset:0
    ds_read_b64_tr_b16 a[70:71], v136 offset:640
    ds_read_b64_tr_b16 a[72:73], v136 offset:32
    ds_read_b64_tr_b16 a[74:75], v136 offset:672
    ds_read_b128 a[32:35], v144 offset:0
    ds_read_b128 a[36:39], v144 offset:1024
    ds_read_b128 a[40:43], v144 offset:2048
    ds_read_b128 a[44:47], v144 offset:3072
    ds_read_b128 a[48:51], v144 offset:4096
    ds_read_b128 a[52:55], v144 offset:5120
    ds_read_b128 v[8:11], v144 offset:6144
    ds_read_b128 v[12:15], v144 offset:7168
    ds_read_b128 v[16:19], v144 offset:8192
    ds_read_b128 v[20:23], v144 offset:9216
    ds_read_b128 v[24:27], v144 offset:10240
    ds_read_b128 v[28:31], v144 offset:11264
    ds_read_b128 v[32:35], v144 offset:12288
    ds_read_b128 v[36:39], v144 offset:13312
    ds_read_b128 a[56:59], v144 offset:14336
    ds_read_b128 a[60:63], v144 offset:15360
    ds_read_b128 a[64:67], v144 offset:16384
    s_cmp_ge_u32 s74, 810
    s_cbranch_scc1 k1k1_not4
    s_mov_b32 s67, 0
    buffer_load_dwordx4 a[0:3], v140, s[52:55], s67 offen
    s_add_u32 s67, s67, s72
    buffer_load_dwordx4 a[4:7], v140, s[52:55], s67 offen
    s_add_u32 s67, s67, s72
    buffer_load_dwordx4 a[8:11], v140, s[52:55], s67 offen
    s_add_u32 s67, s67, s72
    buffer_load_dwordx4 a[12:15], v140, s[52:55], s67 offen
    s_add_u32 s67, s67, s72
    buffer_load_dwordx4 a[16:19], v140, s[52:55], s67 offen
    s_add_u32 s67, s67, s72
    buffer_load_dwordx4 a[20:23], v140, s[52:55], s67 offen
    s_add_u32 s67, s67, s72
    buffer_load_dwordx4 a[24:27], v140, s[52:55], s67 offen
    s_add_u32 s67, s67, s72
    buffer_load_dwordx4 a[28:31], v140, s[52:55], s67 offen
k1k1_not4:
    s_mov_b32 s67, 0x3f803f80
    v_mov_b32 v148, 0
    v_mov_b32 v149, 0
    v_mov_b32 v150, 0
    v_mov_b32 v151, 0
    s_waitcnt lgkmcnt(15)
    s_waitcnt lgkmcnt(0)
    v_dot2_f32_bf16 v148, v48, s67, v148
    v_dot2_f32_bf16 v150, v48, v48, v150
    v_dot2_f32_bf16 v149, v49, s67, v149
    v_dot2_f32_bf16 v151, v49, v49, v151
    v_dot2_f32_bf16 v148, v50, s67, v148
    v_dot2_f32_bf16 v150, v50, v50, v150
    v_dot2_f32_bf16 v149, v51, s67, v149
    v_dot2_f32_bf16 v151, v51, v51, v151
    v_dot2_f32_bf16 v148, v52, s67, v148
    v_dot2_f32_bf16 v150, v52, v52, v150
    v_dot2_f32_bf16 v149, v53, s67, v149
    v_dot2_f32_bf16 v151, v53, v53, v151
    v_dot2_f32_bf16 v148, v54, s67, v148
    v_dot2_f32_bf16 v150, v54, v54, v150
    v_dot2_f32_bf16 v149, v55, s67, v149
    v_dot2_f32_bf16 v151, v55, v55, v151
    v_dot2_f32_bf16 v148, v56, s67, v148
    v_dot2_f32_bf16 v150, v56, v56, v150
    v_dot2_f32_bf16 v149, v57, s67, v149
    v_dot2_f32_bf16 v151, v57, v57, v151
    v_dot2_f32_bf16 v148, v58, s67, v148
    v_dot2_f32_bf16 v150, v58, v58, v150
    v_dot2_f32_bf16 v149, v59, s67, v149
    v_dot2_f32_bf16 v151, v59, v59, v151
    v_dot2_f32_bf16 v148, v60, s67, v148
    v_dot2_f32_bf16 v150, v60, v60, v150
    v_dot2_f32_bf16 v149, v61, s67, v149
    v_dot2_f32_bf16 v151, v61, v61, v151
    v_dot2_f32_bf16 v148, v62, s67, v148
    v_dot2_f32_bf16 v150, v62, v62, v150
    v_dot2_f32_bf16 v149, v63, s67, v149
    v_dot2_f32_bf16 v151, v63, v63, v151
    v_dot2_f32_bf16 v148, v64, s67, v148
    v_dot2_f32_bf16 v150, v64, v64, v150
    v_dot2_f32_bf16 v149, v65, s67, v149
    v_dot2_f32_bf16 v151, v65, v65, v151
    v_dot2_f32_bf16 v148, v66, s67, v148
    v_dot2_f32_bf16 v150, v66, v66, v150
    v_dot2_f32_bf16 v149, v67, s67, v149
    v_dot2_f32_bf16 v151, v67, v67, v151
    s_nop 1
    v_add_f32 v148, v148, v149
    v_add_f32 v150, v150, v151
    s_nop 0
    v_add_f32_dpp v149, v148, v148 row_ror:8 row_mask:0xf bank_mask:0xf
    v_add_f32_dpp v151, v150, v150 row_ror:8 row_mask:0xf bank_mask:0xf
    v_mov_b32 v148, v149
    v_mov_b32 v150, v151
    s_nop 0
    v_add_f32_dpp v149, v148, v148 row_ror:4 row_mask:0xf bank_mask:0xf
    v_add_f32_dpp v151, v150, v150 row_ror:4 row_mask:0xf bank_mask:0xf
    v_mov_b32 v148, v149
    v_mov_b32 v150, v151
    s_nop 0
    v_add_f32_dpp v149, v148, v148 row_ror:2 row_mask:0xf bank_mask:0xf
    v_add_f32_dpp v151, v150, v150 row_ror:2 row_mask:0xf bank_mask:0xf
    v_mov_b32 v148, v149
    v_mov_b32 v150, v151
    s_nop 0
    v_add_f32_dpp v149, v148, v148 row_ror:1 row_mask:0xf bank_mask:0xf
    v_add_f32_dpp v151, v150, v150 row_ror:1 row_mask:0xf bank_mask:0xf
    v_mov_b32 v148, v149
    v_mov_b32 v150, v151
    s_mov_b32 s67, 0x3acccccd
    s_mov_b32 s68, 0x3727c5ac
    v_mul_f32 v148, s67, v148
    v_mul_f32 v150, s67, v150
    v_fma_f32 v150, -v148, v148, v150
    v_max_f32 v150, 0, v150
    v_cvt_pk_bf16_f32 v148, v148, v148
    v_lshlrev_b32 v148, 16, v148
    v_cvt_pk_bf16_f32 v150, v150, v150
    v_lshlrev_b32 v150, 16, v150
    v_add_f32 v150, s68, v150
    v_cvt_pk_bf16_f32 v150, v150, v150
    v_lshlrev_b32 v150, 16, v150
    v_sqrt_f32 v150, v150
    s_nop 0
    v_cvt_pk_bf16_f32 v150, v150, v150
    v_lshlrev_b32 v150, 16, v150
    v_rcp_f32 v150, v150
    s_mov_b32 s6, 0
k1k1_rows5:
    s_waitcnt lgkmcnt(4)
    v_mfma_f32_16x16x32_bf16 v[48:51], a[68:71], a[32:35], 0
    v_mfma_f32_16x16x32_bf16 v[64:67], a[68:71], a[48:51], 0
    v_mfma_f32_16x16x32_bf16 v[52:55], a[68:71], a[36:39], 0
    v_mfma_f32_16x16x32_bf16 v[68:71], a[68:71], a[52:55], 0
    v_mfma_f32_16x16x32_bf16 v[56:59], a[72:75], a[32:35], 0
    v_mfma_f32_16x16x32_bf16 v[72:75], a[72:75], a[48:51], 0
    v_mfma_f32_16x16x32_bf16 v[60:63], a[72:75], a[36:39], 0
    v_mfma_f32_16x16x32_bf16 v[76:79], a[72:75], a[52:55], 0
    ds_read_b64_tr_b16 a[68:69], v136 offset:1280
    ds_read_b64_tr_b16 a[70:71], v136 offset:1920
    ds_read_b64_tr_b16 a[72:73], v136 offset:1312
    ds_read_b64_tr_b16 a[74:75], v136 offset:1952
    v_readlane_b32 s4, v148, s6
    v_readlane_b32 s5, v150, s6
    v_add_u32 v136, 1280, v136
    v_fma_f32 v48, -v142, s4, v48
    v_fma_f32 v49, -v142, s4, v49
    v_fma_f32 v50, -v142, s4, v50
    v_fma_f32 v51, -v142, s4, v51
    v_fma_f32 v56, -v142, s4, v56
    v_fma_f32 v57, -v142, s4, v57
    v_fma_f32 v58, -v142, s4, v58
    v_fma_f32 v59, -v142, s4, v59
    v_pk_mul_f32 v[80:81], v[48:49], v[8:9]
    v_pk_mul_f32 v[82:83], v[50:51], v[10:11]
    v_pk_mul_f32 v[84:85], v[52:53], v[12:13]
    v_pk_mul_f32 v[86:87], v[54:55], v[14:15]
    v_pk_mul_f32 v[88:89], v[56:57], v[16:17]
    v_pk_mul_f32 v[90:91], v[58:59], v[18:19]
    v_pk_mul_f32 v[92:93], v[60:61], v[20:21]
    v_pk_mul_f32 v[94:95], v[62:63], v[22:23]
    v_pk_fma_f32 v[80:81], v[64:65], v[24:25], v[80:81]
    v_pk_mul_f32 v[64:65], v[64:65], v[8:9]
    v_pk_fma_f32 v[82:83], v[66:67], v[26:27], v[82:83]
    v_pk_mul_f32 v[66:67], v[66:67], v[10:11]
    v_pk_fma_f32 v[84:85], v[68:69], v[28:29], v[84:85]
    v_pk_mul_f32 v[68:69], v[68:69], v[12:13]
    v_pk_fma_f32 v[86:87], v[70:71], v[30:31], v[86:87]
    v_pk_mul_f32 v[70:71], v[70:71], v[14:15]
    v_pk_fma_f32 v[88:89], v[72:73], v[32:33], v[88:89]
    v_pk_mul_f32 v[72:73], v[72:73], v[16:17]
    v_pk_fma_f32 v[90:91], v[74:75], v[34:35], v[90:91]
    v_pk_mul_f32 v[74:75], v[74:75], v[18:19]
    v_pk_fma_f32 v[92:93], v[76:77], v[36:37], v[92:93]
    v_pk_mul_f32 v[76:77], v[76:77], v[20:21]
    v_pk_fma_f32 v[94:95], v[78:79], v[38:39], v[94:95]
    v_pk_mul_f32 v[78:79], v[78:79], v[22:23]
    v_pk_fma_f32 v[64:65], v[48:49], v[24:25], v[64:65] neg_lo:[1,0,0] neg_hi:[1,0,0]
    v_pk_fma_f32 v[66:67], v[50:51], v[26:27], v[66:67] neg_lo:[1,0,0] neg_hi:[1,0,0]
    v_pk_fma_f32 v[68:69], v[52:53], v[28:29], v[68:69] neg_lo:[1,0,0] neg_hi:[1,0,0]
    v_pk_fma_f32 v[70:71], v[54:55], v[30:31], v[70:71] neg_lo:[1,0,0] neg_hi:[1,0,0]
    v_pk_fma_f32 v[72:73], v[56:57], v[32:33], v[72:73] neg_lo:[1,0,0] neg_hi:[1,0,0]
    v_pk_fma_f32 v[74:75], v[58:59], v[34:35], v[74:75] neg_lo:[1,0,0] neg_hi:[1,0,0]
    v_pk_fma_f32 v[76:77], v[60:61], v[36:37], v[76:77] neg_lo:[1,0,0] neg_hi:[1,0,0]
    v_pk_fma_f32 v[78:79], v[62:63], v[38:39], v[78:79] neg_lo:[1,0,0] neg_hi:[1,0,0]
    v_cvt_pk_bf16_f32 v96, v80, v81
    v_cvt_pk_bf16_f32 v97, v82, v83
    v_cvt_pk_bf16_f32 v98, v88, v89
    v_cvt_pk_bf16_f32 v99, v90, v91
    v_cvt_pk_bf16_f32 v104, v64, v65
    v_cvt_pk_bf16_f32 v105, v66, v67
    v_cvt_pk_bf16_f32 v106, v72, v73
    v_cvt_pk_bf16_f32 v107, v74, v75
    v_cvt_pk_bf16_f32 v100, v84, v85
    v_cvt_pk_bf16_f32 v101, v86, v87
    v_cvt_pk_bf16_f32 v102, v92, v93
    v_cvt_pk_bf16_f32 v103, v94, v95
    v_cvt_pk_bf16_f32 v108, v68, v69
    v_cvt_pk_bf16_f32 v109, v70, v71
    v_cvt_pk_bf16_f32 v110, v76, v77
    v_cvt_pk_bf16_f32 v111, v78, v79
    v_mfma_f32_16x16x32_bf16 v[112:115], v[96:99], a[56:59], 0
    v_mfma_f32_16x16x32_bf16 v[120:123], v[104:107], a[56:59], 0
    v_mfma_f32_16x16x32_bf16 v[116:119], v[100:103], a[56:59], 0
    v_mfma_f32_16x16x32_bf16 v[124:127], v[108:111], a[56:59], 0
    v_mfma_f32_16x16x32_bf16 v[112:115], v[104:107], a[60:63], v[112:115]
    v_mfma_f32_16x16x32_bf16 v[120:123], v[96:99], a[64:67], v[120:123]
    v_mfma_f32_16x16x32_bf16 v[116:119], v[108:111], a[60:63], v[116:119]
    v_mfma_f32_16x16x32_bf16 v[124:127], v[100:103], a[64:67], v[124:127]
    s_add_u32 s6, s6, 16
    s_nop 3
    v_mul_f32 v112, s5, v112
    v_mul_f32 v113, s5, v113
    v_mul_f32 v114, s5, v114
    v_mul_f32 v115, s5, v115
    v_mul_f32 v116, s5, v116
    v_mul_f32 v117, s5, v117
    v_mul_f32 v118, s5, v118
    v_mul_f32 v119, s5, v119
    v_mul_f32 v120, s5, v120
    v_mul_f32 v121, s5, v121
    v_mul_f32 v122, s5, v122
    v_mul_f32 v123, s5, v123
    v_mul_f32 v124, s5, v124
    v_mul_f32 v125, s5, v125
    v_mul_f32 v126, s5, v126
    v_mul_f32 v127, s5, v127
    v_cvt_pk_bf16_f32 v128, v112, v113
    v_cvt_pk_bf16_f32 v129, v114, v115
    v_cvt_pk_bf16_f32 v130, v116, v117
    v_cvt_pk_bf16_f32 v131, v118, v119
    v_cvt_pk_bf16_f32 v132, v120, v121
    v_cvt_pk_bf16_f32 v133, v122, v123
    v_cvt_pk_bf16_f32 v134, v124, v125
    v_cvt_pk_bf16_f32 v135, v126, v127
    s_mov_b64 exec, s[62:63]
    ds_write_b64 v137, v[128:129] offset:0
    ds_write_b64 v137, v[130:131] offset:32
    ds_write_b64 v137, v[132:133] offset:320
    ds_write_b64 v137, v[134:135] offset:352
    s_mov_b64 exec, -1
    v_add_u32 v137, 672, v137
    s_cmp_lt_u32 s6, 64
    s_cbranch_scc1 k1k1_rows5
    s_waitcnt lgkmcnt(0)
    s_barrier
    s_lshr_b32 s67, s64, 1
    s_sub_u32 s67, s67, s64
    s_add_u32 s67, s67, 8
    s_lshl_b32 s67, s67, 5
    v_add_u32 v152, s67, v138
    v_add_u32 v153, s67, v139
    ds_read_b64_tr_b16 v[48:49], v138 offset:0
    ds_read_b64_tr_b16 v[50:51], v138 offset:10752
    ds_read_b64_tr_b16 v[52:53], v138 offset:320
    ds_read_b64_tr_b16 v[54:55], v138 offset:11072
    ds_read_b64_tr_b16 v[56:57], v152 offset:0
    ds_read_b64_tr_b16 v[58:59], v152 offset:10752
    ds_read_b64_tr_b16 v[60:61], v152 offset:320
    ds_read_b64_tr_b16 v[62:63], v152 offset:11072
    s_mov_b32 s69, 0x280000
    s_waitcnt lgkmcnt(0)
    v_mfma_f32_16x16x32_bf16 v[80:83], v[48:51], a[32:35], 0
    v_mfma_f32_16x16x32_bf16 v[96:99], v[48:51], a[48:51], 0
    v_mfma_f32_16x16x32_bf16 v[84:87], v[48:51], a[36:39], 0
    v_mfma_f32_16x16x32_bf16 v[100:103], v[48:51], a[52:55], 0
    v_mfma_f32_16x16x32_bf16 v[80:83], v[52:55], a[40:43], v[80:83]
    v_mfma_f32_16x16x32_bf16 v[96:99], v[52:55], a[32:35], v[96:99]
    v_mfma_f32_16x16x32_bf16 v[84:87], v[52:55], a[44:47], v[84:87]
    v_mfma_f32_16x16x32_bf16 v[100:103], v[52:55], a[36:39], v[100:103]
    s_nop 4
    v_pk_mul_f32 v[112:113], v[80:81], v[40:41]
    v_pk_mul_f32 v[114:115], v[82:83], v[40:41]
    v_pk_mul_f32 v[116:117], v[84:85], v[44:45]
    v_pk_mul_f32 v[118:119], v[86:87], v[44:45]
    v_pk_fma_f32 v[112:113], v[96:97], v[42:43], v[112:113]
    v_pk_mul_f32 v[96:97], v[96:97], v[40:41]
    v_pk_fma_f32 v[114:115], v[98:99], v[42:43], v[114:115]
    v_pk_mul_f32 v[98:99], v[98:99], v[40:41]
    v_pk_fma_f32 v[116:117], v[100:101], v[46:47], v[116:117]
    v_pk_mul_f32 v[100:101], v[100:101], v[44:45]
    v_pk_fma_f32 v[118:119], v[102:103], v[46:47], v[118:119]
    v_pk_mul_f32 v[102:103], v[102:103], v[44:45]
    v_pk_fma_f32 v[96:97], v[80:81], v[42:43], v[96:97] neg_lo:[1,0,0] neg_hi:[1,0,0]
    v_pk_fma_f32 v[98:99], v[82:83], v[42:43], v[98:99] neg_lo:[1,0,0] neg_hi:[1,0,0]
    v_pk_fma_f32 v[100:101], v[84:85], v[46:47], v[100:101] neg_lo:[1,0,0] neg_hi:[1,0,0]
    v_pk_fma_f32 v[102:103], v[86:87], v[46:47], v[102:103] neg_lo:[1,0,0] neg_hi:[1,0,0]
    v_cvt_pk_bf16_f32 v80, v112, v113
    v_cvt_pk_bf16_f32 v81, v114, v115
    v_cvt_pk_bf16_f32 v82, v96, v97
    v_cvt_pk_bf16_f32 v83, v98, v99
    v_cvt_pk_bf16_f32 v84, v116, v117
    v_cvt_pk_bf16_f32 v85, v118, v119
    v_cvt_pk_bf16_f32 v86, v100, v101
    v_cvt_pk_bf16_f32 v87, v102, v103
    v_permlane16_swap_b32 v80, v82
    v_permlane16_swap_b32 v81, v83
    v_permlane16_swap_b32 v84, v86
    v_permlane16_swap_b32 v85, v87
    buffer_store_dwordx4 v[80:83], v139, s[48:51], 0 offen
    buffer_store_dwordx4 v[84:87], v139, s[48:51], s69 offen
    s_cmp_ge_u32 s64, 4
    s_cbranch_scc1 k1k1_ud7
    s_and_b32 s68, s64, 1
    s_cmp_eq_u32 s68, 1
    s_cbranch_scc1 k1k1_u16
    v_mfma_f32_16x16x32_bf16 v[88:91], v[56:59], a[32:35], 0
    v_mfma_f32_16x16x32_bf16 v[104:107], v[56:59], a[48:51], 0
    v_mfma_f32_16x16x32_bf16 v[88:91], v[60:63], a[40:43], v[88:91]
    v_mfma_f32_16x16x32_bf16 v[104:107], v[60:63], a[32:35], v[104:107]
    s_nop 6
    v_pk_mul_f32 v[120:121], v[88:89], v[40:41]
    v_pk_mul_f32 v[122:123], v[90:91], v[40:41]
    v_pk_fma_f32 v[120:121], v[104:105], v[42:43], v[120:121]
    v_pk_mul_f32 v[104:105], v[104:105], v[40:41]
    v_pk_fma_f32 v[122:123], v[106:107], v[42:43], v[122:123]
    v_pk_mul_f32 v[106:107], v[106:107], v[40:41]
    v_pk_fma_f32 v[104:105], v[88:89], v[42:43], v[104:105] neg_lo:[1,0,0] neg_hi:[1,0,0]
    v_pk_fma_f32 v[106:107], v[90:91], v[42:43], v[106:107] neg_lo:[1,0,0] neg_hi:[1,0,0]
    v_cvt_pk_bf16_f32 v88, v120, v121
    v_cvt_pk_bf16_f32 v89, v122, v123
    v_cvt_pk_bf16_f32 v90, v104, v105
    v_cvt_pk_bf16_f32 v91, v106, v107
    s_nop 0
    v_permlane16_swap_b32 v88, v90
    v_permlane16_swap_b32 v89, v91
    buffer_store_dwordx4 v[88:91], v153, s[48:51], 0 offen
    s_branch k1k1_ud7
k1k1_u16:
    v_mfma_f32_16x16x32_bf16 v[88:91], v[56:59], a[36:39], 0
    v_mfma_f32_16x16x32_bf16 v[104:107], v[56:59], a[52:55], 0
    v_mfma_f32_16x16x32_bf16 v[88:91], v[60:63], a[44:47], v[88:91]
    v_mfma_f32_16x16x32_bf16 v[104:107], v[60:63], a[36:39], v[104:107]
    s_nop 6
    v_pk_mul_f32 v[120:121], v[88:89], v[44:45]
    v_pk_mul_f32 v[122:123], v[90:91], v[44:45]
    v_pk_fma_f32 v[120:121], v[104:105], v[46:47], v[120:121]
    v_pk_mul_f32 v[104:105], v[104:105], v[44:45]
    v_pk_fma_f32 v[122:123], v[106:107], v[46:47], v[122:123]
    v_pk_mul_f32 v[106:107], v[106:107], v[44:45]
    v_pk_fma_f32 v[104:105], v[88:89], v[46:47], v[104:105] neg_lo:[1,0,0] neg_hi:[1,0,0]
    v_pk_fma_f32 v[106:107], v[90:91], v[46:47], v[106:107] neg_lo:[1,0,0] neg_hi:[1,0,0]
    v_cvt_pk_bf16_f32 v88, v120, v121
    v_cvt_pk_bf16_f32 v89, v122, v123
    v_cvt_pk_bf16_f32 v90, v104, v105
    v_cvt_pk_bf16_f32 v91, v106, v107
    s_nop 0
    v_permlane16_swap_b32 v88, v90
    v_permlane16_swap_b32 v89, v91
    buffer_store_dwordx4 v[88:91], v153, s[48:51], s69 offen
k1k1_ud7:
    s_cmp_ge_u32 s74, 810
    s_cbranch_scc1 k1k1_noside8
    s_waitcnt vmcnt(2)
    v_accvgpr_read_b32 v8, a0
    v_accvgpr_read_b32 v9, a1
    v_accvgpr_read_b32 v10, a2
    v_accvgpr_read_b32 v11, a3
    v_accvgpr_read_b32 v12, a4
    v_accvgpr_read_b32 v13, a5
    v_accvgpr_read_b32 v14, a6
    v_accvgpr_read_b32 v15, a7
    v_accvgpr_read_b32 v16, a8
    v_accvgpr_read_b32 v17, a9
    v_accvgpr_read_b32 v18, a10
    v_accvgpr_read_b32 v19, a11
    v_accvgpr_read_b32 v20, a12
    v_accvgpr_read_b32 v21, a13
    v_accvgpr_read_b32 v22, a14
    v_accvgpr_read_b32 v23, a15
    v_accvgpr_read_b32 v24, a16
    v_accvgpr_read_b32 v25, a17
    v_accvgpr_read_b32 v26, a18
    v_accvgpr_read_b32 v27, a19
    v_accvgpr_read_b32 v28, a20
    v_accvgpr_read_b32 v29, a21
    v_accvgpr_read_b32 v30, a22
    v_accvgpr_read_b32 v31, a23
    v_accvgpr_read_b32 v32, a24
    v_accvgpr_read_b32 v33, a25
    v_accvgpr_read_b32 v34, a26
    v_accvgpr_read_b32 v35, a27
    v_accvgpr_read_b32 v36, a28
    v_accvgpr_read_b32 v37, a29
    v_accvgpr_read_b32 v38, a30
    v_accvgpr_read_b32 v39, a31
    s_mov_b32 s68, 0x05040100
    s_mov_b32 s69, 0x07060302
    v_perm_b32 v48, v12, v8, s68
    v_perm_b32 v49, v20, v16, s68
    v_perm_b32 v50, v28, v24, s68
    v_perm_b32 v51, v36, v32, s68
    v_perm_b32 v52, v12, v8, s69
    v_perm_b32 v53, v20, v16, s69
    v_perm_b32 v54, v28, v24, s69
    v_perm_b32 v55, v36, v32, s69
    v_perm_b32 v56, v13, v9, s68
    v_perm_b32 v57, v21, v17, s68
    v_perm_b32 v58, v29, v25, s68
    v_perm_b32 v59, v37, v33, s68
    v_perm_b32 v60, v13, v9, s69
    v_perm_b32 v61, v21, v17, s69
    v_perm_b32 v62, v29, v25, s69
    v_perm_b32 v63, v37, v33, s69
    v_perm_b32 v64, v14, v10, s68
    v_perm_b32 v65, v22, v18, s68
    v_perm_b32 v66, v30, v26, s68
    v_perm_b32 v67, v38, v34, s68
    v_perm_b32 v68, v14, v10, s69
    v_perm_b32 v69, v22, v18, s69
    v_perm_b32 v70, v30, v26, s69
    v_perm_b32 v71, v38, v34, s69
    v_perm_b32 v72, v15, v11, s68
    v_perm_b32 v73, v23, v19, s68
    v_perm_b32 v74, v31, v27, s68
    v_perm_b32 v75, v39, v35, s68
    v_perm_b32 v76, v15, v11, s69
    v_perm_b32 v77, v23, v19, s69
    v_perm_b32 v78, v31, v27, s69
    v_perm_b32 v79, v39, v35, s69
    s_mov_b32 s67, 0
    buffer_store_dwordx4 v[48:51], v141, s[56:59], s67 offen
    s_add_u32 s67, s67, s73
    buffer_store_dwordx4 v[52:55], v141, s[56:59], s67 offen
    s_add_u32 s67, s67, s73
    buffer_store_dwordx4 v[56:59], v141, s[56:59], s67 offen
    s_add_u32 s67, s67, s73
    buffer_store_dwordx4 v[60:63], v141, s[56:59], s67 offen
    s_add_u32 s67, s67, s73
    buffer_store_dwordx4 v[64:67], v141, s[56:59], s67 offen
    s_add_u32 s67, s67, s73
    buffer_store_dwordx4 v[68:71], v141, s[56:59], s67 offen
    s_add_u32 s67, s67, s73
    buffer_store_dwordx4 v[72:75], v141, s[56:59], s67 offen
    s_add_u32 s67, s67, s73
    buffer_store_dwordx4 v[76:79], v141, s[56:59], s67 offen
    s_nop 1
k1k1_noside8:
k1k1_end1:
    s_endpgm
.section .rodata,"a"
.p2align 6
.amdhsa_kernel k1_kernel
  .amdhsa_next_free_vgpr 232
  .amdhsa_next_free_sgpr 102
  .amdhsa_accum_offset 156
  .amdhsa_group_segment_fixed_size 0
  .amdhsa_kernarg_size 96
  .amdhsa_user_sgpr_count 2
  .amdhsa_user_sgpr_kernarg_segment_ptr 1
  .amdhsa_system_sgpr_workgroup_id_x 1
.end_amdhsa_kernel
.text
.globl k2_kernel
.p2align 8
.type k2_kernel,@function
k2_kernel:
    s_cmp_ge_u32 s2, 256
    s_cbranch_scc1 k2k2_end1
    s_load_dwordx16 s[16:31], s[0:1], 0
    s_load_dwordx8 s[32:39], s[0:1], 64
    v_readfirstlane_b32 s64, v0
    v_and_b32 v1, 63, v0
    s_lshr_b32 s64, s64, 6
    v_and_b32 v2, 15, v1
    v_lshrrev_b32 v3, 4, v1
    v_lshrrev_b32 v4, 3, v1
    v_and_b32 v6, 7, v1
    v_xor_b32 v5, v6, v4
    v_lshlrev_b32 v5, 4, v5
    s_and_b32 s65, s2, 7
    s_lshl_b32 s65, s65, 2
    s_bfe_u32 s69, s2, 0x20003
    s_add_u32 s65, s65, s69
    s_lshr_b32 s66, s2, 5
    s_mul_i32 s67, s64, 320
    s_mul_i32 s68, s65, 163840
    s_mul_i32 s69, s66, 160
    s_add_u32 s68, s68, s69
    s_mov_b32 s70, 6554
    v_add_u32 v6, s67, v1
    v_mul_u32_u24 v7, s70, v6
    v_lshrrev_b32 v7, 16, v7
    v_mul_u32_u24 v7, 1120, v7
    v_lshl_add_u32 v7, v6, 4, v7
    v_add_u32 v124, s68, v7
    v_add_u32 v6, s67, v1
    v_add_u32 v6, 64, v6
    v_mul_u32_u24 v7, s70, v6
    v_lshrrev_b32 v7, 16, v7
    v_mul_u32_u24 v7, 1120, v7
    v_lshl_add_u32 v7, v6, 4, v7
    v_add_u32 v125, s68, v7
    v_add_u32 v6, s67, v1
    v_add_u32 v6, 128, v6
    v_mul_u32_u24 v7, s70, v6
    v_lshrrev_b32 v7, 16, v7
    v_mul_u32_u24 v7, 1120, v7
    v_lshl_add_u32 v7, v6, 4, v7
    v_add_u32 v126, s68, v7
    v_add_u32 v6, s67, v1
    v_add_u32 v6, 192, v6
    v_mul_u32_u24 v7, s70, v6
    v_lshrrev_b32 v7, 16, v7
    v_mul_u32_u24 v7, 1120, v7
    v_lshl_add_u32 v7, v6, 4, v7
    v_add_u32 v127, s68, v7
    v_add_u32 v6, s67, v1
    v_add_u32 v6, 256, v6
    v_mul_u32_u24 v7, s70, v6
    v_lshrrev_b32 v7, 16, v7
    v_mul_u32_u24 v7, 1120, v7
    v_lshl_add_u32 v7, v6, 4, v7
    v_add_u32 v128, s68, v7
    s_mul_i32 s67, s64, 5120
    s_waitcnt lgkmcnt(0)
    s_mov_b32 s40, s38
    s_mov_b32 s41, s39
    s_and_b32 s41, s41, 0xffff
    s_mov_b32 s42, 0x500000
    s_mov_b32 s43, 0x00020000
    s_add_u32 m0, s67, 0
    s_nop 0
    buffer_load_dwordx4 v124, s[40:43], 0 offen lds
    s_add_u32 m0, s67, 1024
    s_nop 0
    buffer_load_dwordx4 v125, s[40:43], 0 offen lds
    s_add_u32 m0, s67, 2048
    s_nop 0
    buffer_load_dwordx4 v126, s[40:43], 0 offen lds
    s_add_u32 m0, s67, 3072
    s_nop 0
    buffer_load_dwordx4 v127, s[40:43], 0 offen lds
    s_add_u32 m0, s67, 4096
    s_nop 0
    buffer_load_dwordx4 v128, s[40:43], 0 offen lds
    s_getpc_b64 s[44:45]
k2k2_pc2:
    s_add_u32 s44, s44, fnet_tbl-k2k2_pc2
    s_addc_u32 s45, s45, 0
    s_and_b32 s45, s45, 0xffff
    s_mov_b32 s46, 43008
    s_mov_b32 s47, 0x00020000
    v_lshlrev_b32 v148, 4, v1
    s_lshl_b32 s67, s64, 12
    s_add_u32 s67, s67, 26624
    buffer_load_dwordx4 v[108:111], v148, s[44:47], s67 offen offset:0
    buffer_load_dwordx4 v[112:115], v148, s[44:47], s67 offen offset:1024
    buffer_load_dwordx4 v[116:119], v148, s[44:47], s67 offen offset:2048
    buffer_load_dwordx4 v[120:123], v148, s[44:47], s67 offen offset:3072
    s_mov_b32 s48, s16
    s_mov_b32 s49, s17
    s_and_b32 s49, s49, 0xffff
    s_mov_b32 s50, 0x280000
    s_mov_b32 s51, 0x00020000
    s_add_u32 s52, s38, 0x800000
    s_addc_u32 s53, s39, 0
    s_and_b32 s53, s53, 0xffff
    s_mov_b32 s54, 0x280000
    s_mov_b32 s55, 0x00020000
    s_add_u32 s56, s38, 0xc00000
    s_addc_u32 s57, s39, 0
    s_and_b32 s57, s57, 0xffff
    s_mov_b32 s58, 0x20000
    s_mov_b32 s59, 0x00020000
    s_add_u32 s60, s38, 0x1000000
    s_addc_u32 s61, s39, 0
    s_and_b32 s61, s61, 0xffff
    s_mov_b32 s62, 0x438000
    s_mov_b32 s63, 0x00020000
    s_lshl_b32 s67, s64, 9
    s_add_u32 s67, s67, s65
    v_lshl_add_u32 v6, v2, 5, s67
    v_mul_u32_u24 v140, 1280, v6
    v_lshl_add_u32 v140, v3, 3, v140
    s_mul_i32 s68, s66, 160
    v_add_u32 v140, s68, v140
    v_lshlrev_b32 v142, 6, v6
    s_lshl_b32 s68, s66, 3
    v_add_u32 v142, s68, v142
    s_lshl_b32 s67, s2, 4
    s_lshl_b32 s68, s64, 2
    s_add_u32 s67, s67, s68
    v_add_u32 v141, s67, v3
    v_mul_u32_u24 v6, 1280, v141
    v_lshl_add_u32 v6, v2, 4, v6
    v_mov_b32 v145, v6
    v_lshrrev_b32 v6, 2, v2
    v_lshl_add_u32 v6, v3, 2, v6
    v_mul_u32_u24 v143, 160, v6
    v_and_b32 v6, 3, v2
    v_lshl_add_u32 v143, v6, 3, v143
    buffer_load_dwordx2 v[130:131], v140, s[48:51], 0 offen offset:0
    buffer_load_dwordx2 v[132:133], v140, s[48:51], 0 offen offset:32
    buffer_load_dwordx2 v[134:135], v140, s[48:51], 0 offen offset:64
    buffer_load_dwordx2 v[136:137], v140, s[48:51], 0 offen offset:96
    buffer_load_dwordx2 v[138:139], v140, s[48:51], 0 offen offset:128
    buffer_load_dwordx4 v[156:159], v145, s[60:63], 0 offen offset:0
    buffer_load_dwordx4 v[160:163], v145, s[60:63], 0 offen offset:256
    buffer_load_dwordx4 v[164:167], v145, s[60:63], 0 offen offset:512
    buffer_load_dwordx4 v[168:171], v145, s[60:63], 0 offen offset:768
    buffer_load_dwordx4 v[172:175], v145, s[60:63], 0 offen offset:1024
    s_waitcnt vmcnt(10)
    s_barrier
    ds_read_b64_tr_b16 v[28:29], v143 offset:0
    ds_read_b64_tr_b16 v[30:31], v143 offset:2560
    ds_read_b64_tr_b16 v[32:33], v143 offset:32
    ds_read_b64_tr_b16 v[34:35], v143 offset:2592
    ds_read_b64_tr_b16 v[36:37], v143 offset:64
    ds_read_b64_tr_b16 v[38:39], v143 offset:2624
    ds_read_b64_tr_b16 v[40:41], v143 offset:96
    ds_read_b64_tr_b16 v[42:43], v143 offset:2656
    ds_read_b64_tr_b16 v[44:45], v143 offset:128
    ds_read_b64_tr_b16 v[46:47], v143 offset:2688
    ds_read_b64_tr_b16 v[48:49], v143 offset:5120
    ds_read_b64_tr_b16 v[50:51], v143 offset:7680
    ds_read_b64_tr_b16 v[52:53], v143 offset:5152
    ds_read_b64_tr_b16 v[54:55], v143 offset:7712
    ds_read_b64_tr_b16 v[56:57], v143 offset:5184
    ds_read_b64_tr_b16 v[58:59], v143 offset:7744
    ds_read_b64_tr_b16 v[60:61], v143 offset:5216
    ds_read_b64_tr_b16 v[62:63], v143 offset:7776
    ds_read_b64_tr_b16 v[64:65], v143 offset:5248
    ds_read_b64_tr_b16 v[66:67], v143 offset:7808
    ds_read_b64_tr_b16 v[68:69], v143 offset:10240
    ds_read_b64_tr_b16 v[70:71], v143 offset:12800
    ds_read_b64_tr_b16 v[72:73], v143 offset:10272
    ds_read_b64_tr_b16 v[74:75], v143 offset:12832
    ds_read_b64_tr_b16 v[76:77], v143 offset:10304
    ds_read_b64_tr_b16 v[78:79], v143 offset:12864
    ds_read_b64_tr_b16 v[80:81], v143 offset:10336
    ds_read_b64_tr_b16 v[82:83], v143 offset:12896
    ds_read_b64_tr_b16 v[84:85], v143 offset:10368
    ds_read_b64_tr_b16 v[86:87], v143 offset:12928
    ds_read_b64_tr_b16 v[88:89], v143 offset:15360
    ds_read_b64_tr_b16 v[90:91], v143 offset:17920
    ds_read_b64_tr_b16 v[92:93], v143 offset:15392
    ds_read_b64_tr_b16 v[94:95], v143 offset:17952
    ds_read_b64_tr_b16 v[96:97], v143 offset:15424
    ds_read_b64_tr_b16 v[98:99], v143 offset:17984
    ds_read_b64_tr_b16 v[100:101], v143 offset:15456
    ds_read_b64_tr_b16 v[102:103], v143 offset:18016
    ds_read_b64_tr_b16 v[104:105], v143 offset:15488
    ds_read_b64_tr_b16 v[106:107], v143 offset:18048
    s_waitcnt lgkmcnt(15)
    v_mfma_f32_16x16x32_bf16 v[8:11], v[28:31], v[108:111], 0
    v_mfma_f32_16x16x32_bf16 v[12:15], v[32:35], v[108:111], 0
    v_mfma_f32_16x16x32_bf16 v[16:19], v[36:39], v[108:111], 0
    v_mfma_f32_16x16x32_bf16 v[20:23], v[40:43], v[108:111], 0
    v_mfma_f32_16x16x32_bf16 v[24:27], v[44:47], v[108:111], 0
    s_waitcnt lgkmcnt(15)
    v_mfma_f32_16x16x32_bf16 v[8:11], v[48:51], v[112:115], v[8:11]
    v_mfma_f32_16x16x32_bf16 v[12:15], v[52:55], v[112:115], v[12:15]
    v_mfma_f32_16x16x32_bf16 v[16:19], v[56:59], v[112:115], v[16:19]
    v_mfma_f32_16x16x32_bf16 v[20:23], v[60:63], v[112:115], v[20:23]
    v_mfma_f32_16x16x32_bf16 v[24:27], v[64:67], v[112:115], v[24:27]
    s_waitcnt lgkmcnt(10)
    v_mfma_f32_16x16x32_bf16 v[8:11], v[68:71], v[116:119], v[8:11]
    v_mfma_f32_16x16x32_bf16 v[12:15], v[72:75], v[116:119], v[12:15]
    v_mfma_f32_16x16x32_bf16 v[16:19], v[76:79], v[116:119], v[16:19]
    v_mfma_f32_16x16x32_bf16 v[20:23], v[80:83], v[116:119], v[20:23]
    v_mfma_f32_16x16x32_bf16 v[24:27], v[84:87], v[116:119], v[24:27]
    s_waitcnt lgkmcnt(0)
    v_mfma_f32_16x16x32_bf16 v[8:11], v[88:91], v[120:123], v[8:11]
    v_mfma_f32_16x16x32_bf16 v[12:15], v[92:95], v[120:123], v[12:15]
    v_mfma_f32_16x16x32_bf16 v[16:19], v[96:99], v[120:123], v[16:19]
    v_mfma_f32_16x16x32_bf16 v[20:23], v[100:103], v[120:123], v[20:23]
    v_mfma_f32_16x16x32_bf16 v[24:27], v[104:107], v[120:123], v[24:27]
    s_waitcnt vmcnt(5)
    s_mov_b32 s67, 0xffff0000
    v_lshlrev_b32 v150, 16, v130
    v_and_b32 v151, s67, v130
    v_pk_add_f32 v[8:9], v[8:9], v[150:151]
    v_cvt_pk_bf16_f32 v28, v8, v9
    v_lshlrev_b32 v150, 16, v131
    v_and_b32 v151, s67, v131
    v_pk_add_f32 v[10:11], v[10:11], v[150:151]
    v_cvt_pk_bf16_f32 v29, v10, v11
    buffer_store_dwordx2 v[28:29], v140, s[52:55], 0 offen offset:0
    v_lshlrev_b32 v150, 16, v132
    v_and_b32 v151, s67, v132
    v_pk_add_f32 v[12:13], v[12:13], v[150:151]
    v_cvt_pk_bf16_f32 v30, v12, v13
    v_lshlrev_b32 v150, 16, v133
    v_and_b32 v151, s67, v133
    v_pk_add_f32 v[14:15], v[14:15], v[150:151]
    v_cvt_pk_bf16_f32 v31, v14, v15
    buffer_store_dwordx2 v[30:31], v140, s[52:55], 0 offen offset:32
    v_lshlrev_b32 v150, 16, v134
    v_and_b32 v151, s67, v134
    v_pk_add_f32 v[16:17], v[16:17], v[150:151]
    v_cvt_pk_bf16_f32 v32, v16, v17
    v_lshlrev_b32 v150, 16, v135
    v_and_b32 v151, s67, v135
    v_pk_add_f32 v[18:19], v[18:19], v[150:151]
    v_cvt_pk_bf16_f32 v33, v18, v19
    buffer_store_dwordx2 v[32:33], v140, s[52:55], 0 offen offset:64
    v_lshlrev_b32 v150, 16, v136
    v_and_b32 v151, s67, v136
    v_pk_add_f32 v[20:21], v[20:21], v[150:151]
    v_cvt_pk_bf16_f32 v34, v20, v21
    v_lshlrev_b32 v150, 16, v137
    v_and_b32 v151, s67, v137
    v_pk_add_f32 v[22:23], v[22:23], v[150:151]
    v_cvt_pk_bf16_f32 v35, v22, v23
    buffer_store_dwordx2 v[34:35], v140, s[52:55], 0 offen offset:96
    v_lshlrev_b32 v150, 16, v138
    v_and_b32 v151, s67, v138
    v_pk_add_f32 v[24:25], v[24:25], v[150:151]
    v_cvt_pk_bf16_f32 v36, v24, v25
    v_lshlrev_b32 v150, 16, v139
    v_and_b32 v151, s67, v139
    v_pk_add_f32 v[26:27], v[26:27], v[150:151]
    v_cvt_pk_bf16_f32 v37, v26, v27
    buffer_store_dwordx2 v[36:37], v140, s[52:55], 0 offen offset:128
    v_lshlrev_b32 v8, 16, v28
    v_and_b32 v9, s67, v28
    v_lshlrev_b32 v10, 16, v29
    v_and_b32 v11, s67, v29
    v_lshlrev_b32 v12, 16, v30
    v_and_b32 v13, s67, v30
    v_lshlrev_b32 v14, 16, v31
    v_and_b32 v15, s67, v31
    v_lshlrev_b32 v16, 16, v32
    v_and_b32 v17, s67, v32
    v_lshlrev_b32 v18, 16, v33
    v_and_b32 v19, s67, v33
    v_lshlrev_b32 v20, 16, v34
    v_and_b32 v21, s67, v34
    v_lshlrev_b32 v22, 16, v35
    v_and_b32 v23, s67, v35
    v_lshlrev_b32 v24, 16, v36
    v_and_b32 v25, s67, v36
    v_lshlrev_b32 v26, 16, v37
    v_and_b32 v27, s67, v37
    v_pk_add_f32 v[150:151], v[8:9], v[10:11]
    v_pk_add_f32 v[150:151], v[150:151], v[12:13]
    v_pk_add_f32 v[150:151], v[150:151], v[14:15]
    v_pk_add_f32 v[150:151], v[150:151], v[16:17]
    v_pk_add_f32 v[150:151], v[150:151], v[18:19]
    v_pk_add_f32 v[150:151], v[150:151], v[20:21]
    v_pk_add_f32 v[150:151], v[150:151], v[22:23]
    v_pk_add_f32 v[150:151], v[150:151], v[24:25]
    v_pk_add_f32 v[150:151], v[150:151], v[26:27]
    v_add_f32 v152, v150, v151
    v_mov_b32 v154, v152
    s_nop 1
    v_permlane16_swap_b32 v152, v154
    v_add_f32 v152, v152, v154
    v_mov_b32 v154, v152
    s_nop 1
    v_permlane32_swap_b32 v152, v154
    v_add_f32 v152, v152, v154
    v_mul_f32 v154, 0xbc4ccccd, v152
    v_mov_b32 v155, v154
    v_pk_add_f32 v[8:9], v[8:9], v[154:155]
    v_pk_add_f32 v[10:11], v[10:11], v[154:155]
    v_pk_add_f32 v[12:13], v[12:13], v[154:155]
    v_pk_add_f32 v[14:15], v[14:15], v[154:155]
    v_pk_add_f32 v[16:17], v[16:17], v[154:155]
    v_pk_add_f32 v[18:19], v[18:19], v[154:155]
    v_pk_add_f32 v[20:21], v[20:21], v[154:155]
    v_pk_add_f32 v[22:23], v[22:23], v[154:155]
    v_pk_add_f32 v[24:25], v[24:25], v[154:155]
    v_pk_add_f32 v[26:27], v[26:27], v[154:155]
    v_pk_mul_f32 v[150:151], v[8:9], v[8:9]
    v_pk_fma_f32 v[150:151], v[10:11], v[10:11], v[150:151]
    v_pk_fma_f32 v[150:151], v[12:13], v[12:13], v[150:151]
    v_pk_fma_f32 v[150:151], v[14:15], v[14:15], v[150:151]
    v_pk_fma_f32 v[150:151], v[16:17], v[16:17], v[150:151]
    v_pk_fma_f32 v[150:151], v[18:19], v[18:19], v[150:151]
    v_pk_fma_f32 v[150:151], v[20:21], v[20:21], v[150:151]
    v_pk_fma_f32 v[150:151], v[22:23], v[22:23], v[150:151]
    v_pk_fma_f32 v[150:151], v[24:25], v[24:25], v[150:151]
    v_pk_fma_f32 v[150:151], v[26:27], v[26:27], v[150:151]
    v_add_f32 v153, v150, v151
    v_mov_b32 v154, v153
    s_nop 1
    v_permlane16_swap_b32 v153, v154
    v_add_f32 v153, v153, v154
    v_mov_b32 v154, v153
    s_nop 1
    v_permlane32_swap_b32 v153, v154
    v_add_f32 v153, v153, v154
    s_mov_b64 exec, 0xffff
    buffer_store_dwordx2 v[152:153], v142, s[56:59], 0 offen
    s_mov_b64 exec, -1
    s_waitcnt vmcnt(6)
    s_mov_b32 s67, 0x3f803f80
    v_mov_b32 v148, 0
    v_mov_b32 v149, 0
    v_dot2_f32_bf16 v148, v156, s67, v148
    v_dot2_f32_bf16 v149, v157, s67, v149
    v_dot2_f32_bf16 v148, v158, s67, v148
    v_dot2_f32_bf16 v149, v159, s67, v149
    v_dot2_f32_bf16 v148, v160, s67, v148
    v_dot2_f32_bf16 v149, v161, s67, v149
    v_dot2_f32_bf16 v148, v162, s67, v148
    v_dot2_f32_bf16 v149, v163, s67, v149
    v_dot2_f32_bf16 v148, v164, s67, v148
    v_dot2_f32_bf16 v149, v165, s67, v149
    v_dot2_f32_bf16 v148, v166, s67, v148
    v_dot2_f32_bf16 v149, v167, s67, v149
    v_dot2_f32_bf16 v148, v168, s67, v148
    v_dot2_f32_bf16 v149, v169, s67, v149
    v_dot2_f32_bf16 v148, v170, s67, v148
    v_dot2_f32_bf16 v149, v171, s67, v149
    v_dot2_f32_bf16 v148, v172, s67, v148
    v_dot2_f32_bf16 v149, v173, s67, v149
    v_dot2_f32_bf16 v148, v174, s67, v148
    v_dot2_f32_bf16 v149, v175, s67, v149
    s_nop 2
    v_add_f32 v148, v148, v149
    s_nop 1
    v_add_f32_dpp v149, v148, v148 row_ror:8 row_mask:0xf bank_mask:0xf
    v_mov_b32 v148, v149
    s_nop 1
    v_add_f32_dpp v149, v148, v148 row_ror:4 row_mask:0xf bank_mask:0xf
    v_mov_b32 v148, v149
    s_nop 1
    v_add_f32_dpp v149, v148, v148 row_ror:2 row_mask:0xf bank_mask:0xf
    v_mov_b32 v148, v149
    s_nop 1
    v_add_f32_dpp v149, v148, v148 row_ror:1 row_mask:0xf bank_mask:0xf
    v_mov_b32 v148, v149
    s_add_u32 s60, s38, 0xd00000
    s_addc_u32 s61, s39, 0
    s_and_b32 s61, s61, 0xffff
    s_mov_b32 s62, 0x3600
    s_mov_b32 s63, 0x00020000
    v_lshlrev_b32 v141, 2, v141
    buffer_store_dword v148, v141, s[60:63], 0 offen
k2k2_end1:
    s_endpgm
.section .rodata,"a"
.p2align 6
.amdhsa_kernel k2_kernel
  .amdhsa_next_free_vgpr 176
  .amdhsa_next_free_sgpr 102
  .amdhsa_accum_offset 176
  .amdhsa_group_segment_fixed_size 0
  .amdhsa_kernarg_size 96
  .amdhsa_user_sgpr_count 2
  .amdhsa_user_sgpr_kernarg_segment_ptr 1
  .amdhsa_system_sgpr_workgroup_id_x 1
.end_amdhsa_kernel
.text
.globl k3_kernel
.p2align 8
.type k3_kernel,@function
k3_kernel:
    s_cmp_ge_u32 s2, 256
    s_cbranch_scc1 k3k3_end1
    s_load_dwordx16 s[16:31], s[0:1], 0
    s_load_dwordx8 s[32:39], s[0:1], 64
    v_readfirstlane_b32 s64, v0
    v_and_b32 v1, 63, v0
    s_lshr_b32 s64, s64, 6
    v_and_b32 v2, 15, v1
    v_lshrrev_b32 v3, 4, v1
    v_lshrrev_b32 v4, 3, v1
    v_and_b32 v6, 7, v1
    v_xor_b32 v5, v6, v4
    v_lshlrev_b32 v5, 4, v5
    s_and_b32 s65, s2, 1
    s_lshl_b32 s65, s65, 3
    s_bfe_u32 s70, s2, 0x30003
    s_add_u32 s65, s65, s70
    s_bfe_u32 s66, s2, 0x20001
    s_lshl_b32 s66, s66, 2
    s_lshr_b32 s70, s2, 6
    s_add_u32 s66, s66, s70
    s_mul_i32 s74, s66, 112
    s_and_b32 s72, s64, 1
    s_bfe_u32 s73, s64, 0x10001
    s_lshr_b32 s77, s64, 2
    s_lshl_b32 s76, s77, 1
    s_add_u32 s76, s76, s72
    s_mov_b32 s67, 0
    s_cmp_eq_u32 s77, 1
    s_cbranch_scc1 k3k3_hload2
    s_lshl_b32 s68, s72, 3
    s_add_u32 s68, s68, s74
    s_lshl_b32 s69, s73, 6
    s_add_u32 s69, s69, s68
    v_add_u32 v6, s69, v4
    v_mul_u32_u24 v6, 1280, v6
    v_add_u32 v64, v6, v5
    v_add_u32 v65, 0x21c000, v64
    v_add_u32 v66, 0x5000, v64
    v_add_u32 v67, 0x221000, v64
    v_add_u32 v68, 0xa000, v64
    v_add_u32 v69, 0x226000, v64
    s_mul_i32 s69, s73, 2129920
    s_add_u32 s69, s69, 61440
    v_add_u32 v70, s69, v64
    s_mul_i32 s75, s73, 14336
    s_lshl_b32 s68, s72, 10
    s_add_u32 s75, s75, s68
    s_waitcnt lgkmcnt(0)
    s_add_u32 s40, s38, 0x1000000
    s_addc_u32 s41, s39, 0
    s_and_b32 s41, s41, 0xffff
    s_mov_b32 s42, 0x654000
    s_mov_b32 s43, 0x00020000
    s_mov_b32 s5, 0
    s_add_u32 s7, s75, s5
    s_add_u32 m0, s7, 0x0
    s_nop 0
    buffer_load_dwordx4 v64, s[40:43], s67 offen lds
    s_add_u32 m0, s7, 0x800
    s_nop 0
    buffer_load_dwordx4 v65, s[40:43], s67 offen lds
    s_add_u32 m0, s7, 0x1000
    s_nop 0
    buffer_load_dwordx4 v66, s[40:43], s67 offen lds
    s_add_u32 m0, s7, 0x1800
    s_nop 0
    buffer_load_dwordx4 v67, s[40:43], s67 offen lds
    s_add_u32 m0, s7, 0x2000
    s_nop 0
    buffer_load_dwordx4 v68, s[40:43], s67 offen lds
    s_add_u32 m0, s7, 0x2800
    s_nop 0
    buffer_load_dwordx4 v69, s[40:43], s67 offen lds
    s_add_u32 m0, s7, 0x3000
    s_nop 0
    buffer_load_dwordx4 v70, s[40:43], s67 offen lds
    s_add_u32 s67, s67, 128
    s_add_u32 s48, s38, 0xc00000
    s_addc_u32 s49, s39, 0
    s_and_b32 s49, s49, 0xffff
    s_mov_b32 s50, 0x20000
    s_mov_b32 s51, 0x00020000
    s_add_u32 s52, s38, 0xd00000
    s_addc_u32 s53, s39, 0
    s_and_b32 s53, s53, 0xffff
    s_mov_b32 s54, 0x7000
    s_mov_b32 s55, 0x00020000
    s_lshl_b32 s69, s65, 7
    s_lshl_b32 s70, s76, 5
    s_add_u32 s69, s69, s70
    s_xor_b32 s68, s73, 0
    s_lshl_b32 s68, s68, 4
    s_add_u32 s68, s68, s69
    v_add_u32 v7, s68, v2
    v_lshlrev_b32 v6, 6, v7
    v_lshl_add_u32 v6, v3, 4, v6
    buffer_load_dwordx4 v[112:115], v6, s[48:51], 0 offen
    v_mul_u32_u24 v7, 3456, v7
    v_lshl_add_u32 v148, v3, 3, v7
    s_xor_b32 s68, s73, 1
    s_lshl_b32 s68, s68, 4
    s_add_u32 s68, s68, s69
    v_add_u32 v7, s68, v2
    v_lshlrev_b32 v6, 6, v7
    v_lshl_add_u32 v6, v3, 4, v6
    buffer_load_dwordx4 v[116:119], v6, s[48:51], 0 offen
    v_mul_u32_u24 v7, 3456, v7
    v_lshl_add_u32 v149, v3, 3, v7
    s_lshl_b32 s68, s73, 6
    s_add_u32 s68, s68, s74
    s_lshl_b32 s9, s68, 1
    s_add_u32 s10, s74, 48
    s_lshl_b32 s10, s10, 1
    v_lshl_add_u32 v6, v3, 2, s68
    v_lshlrev_b32 v6, 2, v6
    s_mov_b32 s69, 6912
    s_mul_i32 s68, s73, 6656
    buffer_load_dwordx4 v[84:87], v6, s[52:55], 0 offen offset:0
    buffer_load_dwordx4 v[88:91], v6, s[52:55], s69 offen offset:0
    buffer_load_dwordx4 v[92:95], v6, s[52:55], 0 offen offset:64
    buffer_load_dwordx4 v[96:99], v6, s[52:55], s69 offen offset:64
    buffer_load_dwordx4 v[100:103], v6, s[52:55], 0 offen offset:128
    buffer_load_dwordx4 v[104:107], v6, s[52:55], s69 offen offset:128
    buffer_load_dwordx4 v[108:111], v6, s[52:55], s68 offen offset:192
    s_mov_b32 s5, 45056
    s_add_u32 s7, s75, s5
    s_add_u32 m0, s7, 0x0
    s_nop 0
    buffer_load_dwordx4 v64, s[40:43], s67 offen lds
    s_add_u32 m0, s7, 0x800
    s_nop 0
    buffer_load_dwordx4 v65, s[40:43], s67 offen lds
    s_add_u32 m0, s7, 0x1000
    s_nop 0
    buffer_load_dwordx4 v66, s[40:43], s67 offen lds
    s_add_u32 m0, s7, 0x1800
    s_nop 0
    buffer_load_dwordx4 v67, s[40:43], s67 offen lds
    s_add_u32 m0, s7, 0x2000
    s_nop 0
    buffer_load_dwordx4 v68, s[40:43], s67 offen lds
    s_add_u32 m0, s7, 0x2800
    s_nop 0
    buffer_load_dwordx4 v69, s[40:43], s67 offen lds
    s_add_u32 m0, s7, 0x3000
    s_nop 0
    buffer_load_dwordx4 v70, s[40:43], s67 offen lds
    s_add_u32 s67, s67, 128
    s_mov_b32 s5, 90112
    s_add_u32 s7, s75, s5
    s_add_u32 m0, s7, 0x0
    s_nop 0
    buffer_load_dwordx4 v64, s[40:43], s67 offen lds
    s_add_u32 m0, s7, 0x800
    s_nop 0
    buffer_load_dwordx4 v65, s[40:43], s67 offen lds
    s_add_u32 m0, s7, 0x1000
    s_nop 0
    buffer_load_dwordx4 v66, s[40:43], s67 offen lds
    s_add_u32 m0, s7, 0x1800
    s_nop 0
    buffer_load_dwordx4 v67, s[40:43], s67 offen lds
    s_add_u32 s56, s38, 0x2000000
    s_addc_u32 s57, s39, 0
    s_and_b32 s57, s57, 0xffff
    s_mov_b32 s58, 0x6c0000
    s_mov_b32 s59, 0x00020000
    s_mul_i32 s68, s73, 14336
    v_and_b32 v6, 7, v2
    v_add_u32 v7, 0, v3
    v_xor_b32 v6, v6, v7
    v_lshlrev_b32 v6, 4, v6
    v_lshl_add_u32 v6, v2, 7, v6
    v_add_u32 v71, s68, v6
    s_lshl_b32 s69, s76, 12
    s_sub_u32 s69, s69, s68
    s_add_u32 s69, s69, 28672
    s_lshl_b32 s70, s73, 11
    s_add_u32 s71, s69, s70
    v_add_u32 v72, s71, v71
    s_sub_u32 s71, s69, s70
    s_add_u32 s71, s71, 2048
    v_add_u32 v73, s71, v71
    s_mul_i32 s68, s73, 14336
    v_and_b32 v6, 7, v2
    v_add_u32 v7, 4, v3
    v_xor_b32 v6, v6, v7
    v_lshlrev_b32 v6, 4, v6
    v_lshl_add_u32 v6, v2, 7, v6
    v_add_u32 v74, s68, v6
    s_lshl_b32 s69, s76, 12
    s_sub_u32 s69, s69, s68
    s_add_u32 s69, s69, 28672
    s_lshl_b32 s70, s73, 11
    s_add_u32 s71, s69, s70
    v_add_u32 v75, s71, v74
    s_sub_u32 s71, s69, s70
    s_add_u32 s71, s71, 2048
    v_add_u32 v76, s71, v74
    v_lshlrev_b32 v6, 4, v1
    s_lshl_b32 s68, s64, 10
    v_add_u32 v150, s68, v6
    s_xor_b32 s68, s68, 2048
    v_add_u32 v151, s68, v6
    s_cmp_eq_u32 s73, 1
    s_cselect_b64 s[78:79], -1, 0
    s_mov_b32 s4, 0
    s_mov_b32 s5, 0
    v_add_u32 v77, s5, v71
    v_add_u32 v78, s5, v72
    v_add_u32 v79, s5, v73
    s_waitcnt vmcnt(20)
    s_barrier
    ds_read_b128 a[56:59], v78
    ds_read_b128 a[60:63], v79
    ds_read_b128 a[0:3], v77 offset:0
    ds_read_b128 a[4:7], v77 offset:2048
    ds_read_b128 a[8:11], v77 offset:4096
    ds_read_b128 a[12:15], v77 offset:6144
    ds_read_b128 a[16:19], v77 offset:8192
    ds_read_b128 a[20:23], v77 offset:10240
    ds_read_b128 a[24:27], v77 offset:12288
    s_waitcnt lgkmcnt(0)
    v_add_u32 v80, s5, v74
    v_add_u32 v81, s5, v75
    v_add_u32 v82, s5, v76
    v_mfma_f32_16x16x32_bf16 v[8:11], a[0:3], a[56:59], 0
    ds_read_b128 a[64:67], v81
    ds_read_b128 a[68:71], v82
    v_mfma_f32_16x16x32_bf16 v[12:15], a[0:3], a[60:63], 0
    ds_read_b128 a[28:31], v80 offset:0
    ds_read_b128 a[32:35], v80 offset:2048
    v_mfma_f32_16x16x32_bf16 v[16:19], a[4:7], a[56:59], 0
    ds_read_b128 a[36:39], v80 offset:4096
    ds_read_b128 a[40:43], v80 offset:6144
    v_mfma_f32_16x16x32_bf16 v[20:23], a[4:7], a[60:63], 0
    ds_read_b128 a[44:47], v80 offset:8192
    ds_read_b128 a[48:51], v80 offset:10240
    v_mfma_f32_16x16x32_bf16 v[24:27], a[8:11], a[56:59], 0
    ds_read_b128 a[52:55], v80 offset:12288
    s_add_u32 m0, s7, 0x2000
    v_mfma_f32_16x16x32_bf16 v[28:31], a[8:11], a[60:63], 0
    buffer_load_dwordx4 v68, s[40:43], s67 offen lds
    s_add_u32 m0, s7, 0x2800
    v_mfma_f32_16x16x32_bf16 v[32:35], a[12:15], a[56:59], 0
    buffer_load_dwordx4 v69, s[40:43], s67 offen lds
    s_add_u32 m0, s7, 0x3000
    v_mfma_f32_16x16x32_bf16 v[36:39], a[12:15], a[60:63], 0
    buffer_load_dwordx4 v70, s[40:43], s67 offen lds
    s_add_u32 s67, s67, 128
    v_mfma_f32_16x16x32_bf16 v[40:43], a[16:19], a[56:59], 0
    s_add_u32 s6, s5, 45056
    s_cmp_eq_u32 s6, 135168
    s_cselect_b32 s6, 0, s6
    v_mfma_f32_16x16x32_bf16 v[44:47], a[16:19], a[60:63], 0
    v_mfma_f32_16x16x32_bf16 v[48:51], a[20:23], a[56:59], 0
    v_mfma_f32_16x16x32_bf16 v[52:55], a[20:23], a[60:63], 0
    v_mfma_f32_16x16x32_bf16 v[56:59], a[24:27], a[56:59], 0
    v_mfma_f32_16x16x32_bf16 v[60:63], a[24:27], a[60:63], 0
    s_waitcnt lgkmcnt(0)
    v_mfma_f32_16x16x32_bf16 v[8:11], a[28:31], a[64:67], v[8:11]
    v_mfma_f32_16x16x32_bf16 v[12:15], a[28:31], a[68:71], v[12:15]
    v_add_u32 v77, s6, v71
    v_add_u32 v78, s6, v72
    v_add_u32 v79, s6, v73
    s_waitcnt vmcnt(7)
    s_barrier
    ds_read_b128 a[56:59], v78
    v_mfma_f32_16x16x32_bf16 v[16:19], a[32:35], a[64:67], v[16:19]
    ds_read_b128 a[60:63], v79
    ds_read_b128 a[0:3], v77 offset:0
    ds_read_b128 a[4:7], v77 offset:2048
    ds_read_b128 a[8:11], v77 offset:4096
    ds_read_b128 a[12:15], v77 offset:6144
    ds_read_b128 a[16:19], v77 offset:8192
    ds_read_b128 a[20:23], v77 offset:10240
    ds_read_b128 a[24:27], v77 offset:12288
    s_add_u32 s7, s75, s5
    v_mfma_f32_16x16x32_bf16 v[20:23], a[32:35], a[68:71], v[20:23]
    s_add_u32 m0, s7, 0x0
    s_nop 0
    buffer_load_dwordx4 v64, s[40:43], s67 offen lds
    s_add_u32 m0, s7, 0x800
    s_nop 0
    buffer_load_dwordx4 v65, s[40:43], s67 offen lds
    s_add_u32 m0, s7, 0x1000
    s_nop 0
    buffer_load_dwordx4 v66, s[40:43], s67 offen lds
    s_add_u32 m0, s7, 0x1800
    s_nop 0
    buffer_load_dwordx4 v67, s[40:43], s67 offen lds
    s_mov_b32 s5, s6
    v_mfma_f32_16x16x32_bf16 v[24:27], a[36:39], a[64:67], v[24:27]
    s_mov_b32 s68, 0x3acccccd
    s_mov_b32 s69, 0x3c4ccccd
    s_mov_b32 s70, 0x42a00000
    s_mov_b32 s71, 0x3727c5ac
    v_add_f32 v136, v112, v114
    v_mov_b32 v137, v136
    s_nop 1
    v_permlane16_swap_b32 v136, v137
    v_add_f32 v136, v136, v137
    v_mov_b32 v137, v136
    v_mfma_f32_16x16x32_bf16 v[28:31], a[36:39], a[68:71], v[28:31]
    s_nop 0
    v_permlane32_swap_b32 v136, v137
    v_add_f32 v136, v136, v137
    v_mul_f32 v136, s68, v136
    v_fma_f32 v112, v112, s69, -v136
    v_fma_f32 v114, v114, s69, -v136
    v_mul_f32 v112, v112, v112
    v_fmac_f32 v112, v114, v114
    v_add_f32 v113, v113, v115
    v_fma_f32 v113, v112, s70, v113
    v_mfma_f32_16x16x32_bf16 v[32:35], a[40:43], a[64:67], v[32:35]
    v_mov_b32 v137, v113
    s_nop 1
    v_permlane16_swap_b32 v113, v137
    v_add_f32 v113, v113, v137
    v_mov_b32 v137, v113
    s_nop 1
    v_permlane32_swap_b32 v113, v137
    v_add_f32 v113, v113, v137
    v_mul_f32 v113, s68, v113
    v_cvt_pk_bf16_f32 v136, v136, v136
    v_lshlrev_b32 v136, 16, v136
    v_mfma_f32_16x16x32_bf16 v[36:39], a[40:43], a[68:71], v[36:39]
    v_sub_f32 v120, 0, v136
    v_sub_f32 v121, 0, v136
    v_cvt_pk_bf16_f32 v113, v113, v113
    v_lshlrev_b32 v113, 16, v113
    v_add_f32 v113, s71, v113
    v_cvt_pk_bf16_f32 v113, v113, v113
    v_lshlrev_b32 v113, 16, v113
    v_sqrt_f32 v113, v113
    s_nop 0
    v_cvt_pk_bf16_f32 v113, v113, v113
    v_mfma_f32_16x16x32_bf16 v[40:43], a[44:47], a[64:67], v[40:43]
    v_lshlrev_b32 v113, 16, v113
    v_rcp_f32 v124, v113
    v_rcp_f32 v125, v113
    v_mul_f32 v128, 0xbfb8aa3b, v124
    v_cndmask_b32 v132, v128, v124, s[78:79]
    v_mul_f32 v129, 0xbfb8aa3b, v124
    v_cndmask_b32 v133, v129, v124, s[78:79]
    v_add_f32 v136, v116, v118
    v_mov_b32 v137, v136
    v_mfma_f32_16x16x32_bf16 v[44:47], a[44:47], a[68:71], v[44:47]
    s_nop 0
    v_permlane16_swap_b32 v136, v137
    v_add_f32 v136, v136, v137
    v_mov_b32 v137, v136
    s_nop 1
    v_permlane32_swap_b32 v136, v137
    v_add_f32 v136, v136, v137
    v_mul_f32 v136, s68, v136
    v_fma_f32 v116, v116, s69, -v136
    v_fma_f32 v118, v118, s69, -v136
    v_mul_f32 v116, v116, v116
    v_mfma_f32_16x16x32_bf16 v[48:51], a[48:51], a[64:67], v[48:51]
    v_fmac_f32 v116, v118, v118
    v_add_f32 v117, v117, v119
    v_fma_f32 v117, v116, s70, v117
    v_mov_b32 v137, v117
    s_nop 1
    v_permlane16_swap_b32 v117, v137
    v_add_f32 v117, v117, v137
    v_mov_b32 v137, v117
    s_nop 1
    v_permlane32_swap_b32 v117, v137
    v_add_f32 v117, v117, v137
    v_mfma_f32_16x16x32_bf16 v[52:55], a[48:51], a[68:71], v[52:55]
    v_mul_f32 v117, s68, v117
    v_cvt_pk_bf16_f32 v136, v136, v136
    v_lshlrev_b32 v136, 16, v136
    v_sub_f32 v122, 0, v136
    v_sub_f32 v123, 0, v136
    v_cvt_pk_bf16_f32 v117, v117, v117
    v_lshlrev_b32 v117, 16, v117
    v_add_f32 v117, s71, v117
    v_cvt_pk_bf16_f32 v117, v117, v117
    v_mfma_f32_16x16x32_bf16 v[56:59], a[52:55], a[64:67], v[56:59]
    v_lshlrev_b32 v117, 16, v117
    v_sqrt_f32 v117, v117
    s_nop 0
    v_cvt_pk_bf16_f32 v117, v117, v117
    v_lshlrev_b32 v117, 16, v117
    v_rcp_f32 v126, v117
    v_rcp_f32 v127, v117
    v_mul_f32 v130, 0xbfb8aa3b, v126
    v_cndmask_b32 v134, v130, v126, s[78:79]
    v_mul_f32 v131, 0xbfb8aa3b, v126
    v_mfma_f32_16x16x32_bf16 v[60:63], a[52:55], a[68:71], v[60:63]
    v_cndmask_b32 v135, v131, v126, s[78:79]
    s_mov_b32 s4, 1
k3k3_loop4:
    s_waitcnt lgkmcnt(0)
    v_add_u32 v80, s5, v74
    v_add_u32 v81, s5, v75
    v_add_u32 v82, s5, v76
    v_mfma_f32_16x16x32_bf16 v[8:11], a[0:3], a[56:59], v[8:11]
    ds_read_b128 a[64:67], v81
    ds_read_b128 a[68:71], v82
    v_mfma_f32_16x16x32_bf16 v[12:15], a[0:3], a[60:63], v[12:15]
    ds_read_b128 a[28:31], v80 offset:0
    ds_read_b128 a[32:35], v80 offset:2048
    v_mfma_f32_16x16x32_bf16 v[16:19], a[4:7], a[56:59], v[16:19]
    ds_read_b128 a[36:39], v80 offset:4096
    ds_read_b128 a[40:43], v80 offset:6144
    v_mfma_f32_16x16x32_bf16 v[20:23], a[4:7], a[60:63], v[20:23]
    ds_read_b128 a[44:47], v80 offset:8192
    ds_read_b128 a[48:51], v80 offset:10240
    v_mfma_f32_16x16x32_bf16 v[24:27], a[8:11], a[56:59], v[24:27]
    ds_read_b128 a[52:55], v80 offset:12288
    s_add_u32 m0, s7, 0x2000
    v_mfma_f32_16x16x32_bf16 v[28:31], a[8:11], a[60:63], v[28:31]
    buffer_load_dwordx4 v68, s[40:43], s67 offen lds
    s_add_u32 m0, s7, 0x2800
    v_mfma_f32_16x16x32_bf16 v[32:35], a[12:15], a[56:59], v[32:35]
    buffer_load_dwordx4 v69, s[40:43], s67 offen lds
    s_add_u32 m0, s7, 0x3000
    v_mfma_f32_16x16x32_bf16 v[36:39], a[12:15], a[60:63], v[36:39]
    buffer_load_dwordx4 v70, s[40:43], s67 offen lds
    s_add_u32 s67, s67, 128
    v_mfma_f32_16x16x32_bf16 v[40:43], a[16:19], a[56:59], v[40:43]
    s_add_u32 s6, s5, 45056
    s_cmp_eq_u32 s6, 135168
    s_cselect_b32 s6, 0, s6
    v_mfma_f32_16x16x32_bf16 v[44:47], a[16:19], a[60:63], v[44:47]
    v_mfma_f32_16x16x32_bf16 v[48:51], a[20:23], a[56:59], v[48:51]
    v_mfma_f32_16x16x32_bf16 v[52:55], a[20:23], a[60:63], v[52:55]
    v_mfma_f32_16x16x32_bf16 v[56:59], a[24:27], a[56:59], v[56:59]
    v_mfma_f32_16x16x32_bf16 v[60:63], a[24:27], a[60:63], v[60:63]
    s_waitcnt lgkmcnt(0)
    v_mfma_f32_16x16x32_bf16 v[8:11], a[28:31], a[64:67], v[8:11]
    v_mfma_f32_16x16x32_bf16 v[12:15], a[28:31], a[68:71], v[12:15]
    v_add_u32 v77, s6, v71
    v_add_u32 v78, s6, v72
    v_add_u32 v79, s6, v73
    s_waitcnt vmcnt(7)
    s_barrier
    ds_read_b128 a[56:59], v78
    v_mfma_f32_16x16x32_bf16 v[16:19], a[32:35], a[64:67], v[16:19]
    ds_read_b128 a[60:63], v79
    ds_read_b128 a[0:3], v77 offset:0
    v_mfma_f32_16x16x32_bf16 v[20:23], a[32:35], a[68:71], v[20:23]
    ds_read_b128 a[4:7], v77 offset:2048
    ds_read_b128 a[8:11], v77 offset:4096
    v_mfma_f32_16x16x32_bf16 v[24:27], a[36:39], a[64:67], v[24:27]
    ds_read_b128 a[12:15], v77 offset:6144
    ds_read_b128 a[16:19], v77 offset:8192
    v_mfma_f32_16x16x32_bf16 v[28:31], a[36:39], a[68:71], v[28:31]
    ds_read_b128 a[20:23], v77 offset:10240
    ds_read_b128 a[24:27], v77 offset:12288
    v_mfma_f32_16x16x32_bf16 v[32:35], a[40:43], a[64:67], v[32:35]
    s_add_u32 s7, s75, s5
    s_add_u32 m0, s7, 0x0
    v_mfma_f32_16x16x32_bf16 v[36:39], a[40:43], a[68:71], v[36:39]
    buffer_load_dwordx4 v64, s[40:43], s67 offen lds
    s_add_u32 m0, s7, 0x800
    v_mfma_f32_16x16x32_bf16 v[40:43], a[44:47], a[64:67], v[40:43]
    buffer_load_dwordx4 v65, s[40:43], s67 offen lds
    s_add_u32 m0, s7, 0x1000
    v_mfma_f32_16x16x32_bf16 v[44:47], a[44:47], a[68:71], v[44:47]
    buffer_load_dwordx4 v66, s[40:43], s67 offen lds
    s_add_u32 m0, s7, 0x1800
    v_mfma_f32_16x16x32_bf16 v[48:51], a[48:51], a[64:67], v[48:51]
    buffer_load_dwordx4 v67, s[40:43], s67 offen lds
    s_mov_b32 s5, s6
    v_mfma_f32_16x16x32_bf16 v[52:55], a[48:51], a[68:71], v[52:55]
    v_mfma_f32_16x16x32_bf16 v[56:59], a[52:55], a[64:67], v[56:59]
    v_mfma_f32_16x16x32_bf16 v[60:63], a[52:55], a[68:71], v[60:63]
    s_add_u32 s4, s4, 1
    s_cmp_lt_u32 s4, 7
    s_cbranch_scc1 k3k3_loop4
    s_waitcnt lgkmcnt(0)
    v_add_u32 v80, s5, v74
    v_add_u32 v81, s5, v75
    v_add_u32 v82, s5, v76
    v_mfma_f32_16x16x32_bf16 v[8:11], a[0:3], a[56:59], v[8:11]
    ds_read_b128 a[64:67], v81
    ds_read_b128 a[68:71], v82
    v_mfma_f32_16x16x32_bf16 v[12:15], a[0:3], a[60:63], v[12:15]
    ds_read_b128 a[28:31], v80 offset:0
    ds_read_b128 a[32:35], v80 offset:2048
    v_mfma_f32_16x16x32_bf16 v[16:19], a[4:7], a[56:59], v[16:19]
    ds_read_b128 a[36:39], v80 offset:4096
    ds_read_b128 a[40:43], v80 offset:6144
    v_mfma_f32_16x16x32_bf16 v[20:23], a[4:7], a[60:63], v[20:23]
    ds_read_b128 a[44:47], v80 offset:8192
    ds_read_b128 a[48:51], v80 offset:10240
    v_mfma_f32_16x16x32_bf16 v[24:27], a[8:11], a[56:59], v[24:27]
    ds_read_b128 a[52:55], v80 offset:12288
    s_add_u32 m0, s7, 0x2000
    v_mfma_f32_16x16x32_bf16 v[28:31], a[8:11], a[60:63], v[28:31]
    buffer_load_dwordx4 v68, s[40:43], s67 offen lds
    s_add_u32 m0, s7, 0x2800
    v_mfma_f32_16x16x32_bf16 v[32:35], a[12:15], a[56:59], v[32:35]
    buffer_load_dwordx4 v69, s[40:43], s67 offen lds
    s_add_u32 m0, s7, 0x3000
    v_mfma_f32_16x16x32_bf16 v[36:39], a[12:15], a[60:63], v[36:39]
    buffer_load_dwordx4 v70, s[40:43], s67 offen lds
    s_add_u32 s67, s67, 128
    v_mfma_f32_16x16x32_bf16 v[40:43], a[16:19], a[56:59], v[40:43]
    s_add_u32 s6, s5, 45056
    s_cmp_eq_u32 s6, 135168
    s_cselect_b32 s6, 0, s6
    v_mfma_f32_16x16x32_bf16 v[44:47], a[16:19], a[60:63], v[44:47]
    v_mfma_f32_16x16x32_bf16 v[48:51], a[20:23], a[56:59], v[48:51]
    v_mfma_f32_16x16x32_bf16 v[52:55], a[20:23], a[60:63], v[52:55]
    v_mfma_f32_16x16x32_bf16 v[56:59], a[24:27], a[56:59], v[56:59]
    v_mfma_f32_16x16x32_bf16 v[60:63], a[24:27], a[60:63], v[60:63]
    s_waitcnt lgkmcnt(0)
    v_mfma_f32_16x16x32_bf16 v[8:11], a[28:31], a[64:67], v[8:11]
    v_mfma_f32_16x16x32_bf16 v[12:15], a[28:31], a[68:71], v[12:15]
    v_add_u32 v77, s6, v71
    v_add_u32 v78, s6, v72
    v_add_u32 v79, s6, v73
    s_waitcnt vmcnt(7)
    s_barrier
    ds_read_b128 a[56:59], v78
    v_mfma_f32_16x16x32_bf16 v[16:19], a[32:35], a[64:67], v[16:19]
    ds_read_b128 a[60:63], v79
    v_mfma_f32_16x16x32_bf16 v[20:23], a[32:35], a[68:71], v[20:23]
    ds_read_b128 a[0:3], v77 offset:0
    v_mfma_f32_16x16x32_bf16 v[24:27], a[36:39], a[64:67], v[24:27]
    ds_read_b128 a[4:7], v77 offset:2048
    v_mfma_f32_16x16x32_bf16 v[28:31], a[36:39], a[68:71], v[28:31]
    ds_read_b128 a[8:11], v77 offset:4096
    v_mfma_f32_16x16x32_bf16 v[32:35], a[40:43], a[64:67], v[32:35]
    ds_read_b128 a[12:15], v77 offset:6144
    v_mfma_f32_16x16x32_bf16 v[36:39], a[40:43], a[68:71], v[36:39]
    ds_read_b128 a[16:19], v77 offset:8192
    v_mfma_f32_16x16x32_bf16 v[40:43], a[44:47], a[64:67], v[40:43]
    ds_read_b128 a[20:23], v77 offset:10240
    v_mfma_f32_16x16x32_bf16 v[44:47], a[44:47], a[68:71], v[44:47]
    ds_read_b128 a[24:27], v77 offset:12288
    v_mfma_f32_16x16x32_bf16 v[48:51], a[48:51], a[64:67], v[48:51]
    s_mov_b32 s5, s6
    v_mfma_f32_16x16x32_bf16 v[52:55], a[48:51], a[68:71], v[52:55]
    v_mfma_f32_16x16x32_bf16 v[56:59], a[52:55], a[64:67], v[56:59]
    v_mfma_f32_16x16x32_bf16 v[60:63], a[52:55], a[68:71], v[60:63]
    s_waitcnt lgkmcnt(0)
    v_add_u32 v80, s5, v74
    v_add_u32 v81, s5, v75
    v_add_u32 v82, s5, v76
    v_mfma_f32_16x16x32_bf16 v[8:11], a[0:3], a[56:59], v[8:11]
    ds_read_b128 a[64:67], v81
    v_mfma_f32_16x16x32_bf16 v[12:15], a[0:3], a[60:63], v[12:15]
    ds_read_b128 a[68:71], v82
    v_mfma_f32_16x16x32_bf16 v[16:19], a[4:7], a[56:59], v[16:19]
    ds_read_b128 a[28:31], v80 offset:0
    v_mfma_f32_16x16x32_bf16 v[20:23], a[4:7], a[60:63], v[20:23]
    ds_read_b128 a[32:35], v80 offset:2048
    v_mfma_f32_16x16x32_bf16 v[24:27], a[8:11], a[56:59], v[24:27]
    ds_read_b128 a[36:39], v80 offset:4096
    v_mfma_f32_16x16x32_bf16 v[28:31], a[8:11], a[60:63], v[28:31]
    ds_read_b128 a[40:43], v80 offset:6144
    v_mfma_f32_16x16x32_bf16 v[32:35], a[12:15], a[56:59], v[32:35]
    ds_read_b128 a[44:47], v80 offset:8192
    v_mfma_f32_16x16x32_bf16 v[36:39], a[12:15], a[60:63], v[36:39]
    ds_read_b128 a[48:51], v80 offset:10240
    v_mfma_f32_16x16x32_bf16 v[40:43], a[16:19], a[56:59], v[40:43]
    ds_read_b128 a[52:55], v80 offset:12288
    v_mfma_f32_16x16x32_bf16 v[44:47], a[16:19], a[60:63], v[44:47]
    s_add_u32 s6, s5, 45056
    v_mfma_f32_16x16x32_bf16 v[48:51], a[20:23], a[56:59], v[48:51]
    s_cmp_eq_u32 s6, 135168
    s_cselect_b32 s6, 0, s6
    v_mfma_f32_16x16x32_bf16 v[52:55], a[20:23], a[60:63], v[52:55]
    v_mfma_f32_16x16x32_bf16 v[56:59], a[24:27], a[56:59], v[56:59]
    v_mfma_f32_16x16x32_bf16 v[60:63], a[24:27], a[60:63], v[60:63]
    s_waitcnt lgkmcnt(0)
    v_mfma_f32_16x16x32_bf16 v[8:11], a[28:31], a[64:67], v[8:11]
    v_mfma_f32_16x16x32_bf16 v[12:15], a[28:31], a[68:71], v[12:15]
    v_add_u32 v77, s6, v71
    v_add_u32 v78, s6, v72
    v_add_u32 v79, s6, v73
    s_waitcnt vmcnt(0)
    s_barrier
    ds_read_b128 a[56:59], v78
    v_mfma_f32_16x16x32_bf16 v[16:19], a[32:35], a[64:67], v[16:19]
    ds_read_b128 a[60:63], v79
    v_mfma_f32_16x16x32_bf16 v[20:23], a[32:35], a[68:71], v[20:23]
    ds_read_b128 a[0:3], v77 offset:0
    v_mfma_f32_16x16x32_bf16 v[24:27], a[36:39], a[64:67], v[24:27]
    ds_read_b128 a[4:7], v77 offset:2048
    v_mfma_f32_16x16x32_bf16 v[28:31], a[36:39], a[68:71], v[28:31]
    ds_read_b128 a[8:11], v77 offset:4096
    v_mfma_f32_16x16x32_bf16 v[32:35], a[40:43], a[64:67], v[32:35]
    ds_read_b128 a[12:15], v77 offset:6144
    v_mfma_f32_16x16x32_bf16 v[36:39], a[40:43], a[68:71], v[36:39]
    ds_read_b128 a[16:19], v77 offset:8192
    v_mfma_f32_16x16x32_bf16 v[40:43], a[44:47], a[64:67], v[40:43]
    ds_read_b128 a[20:23], v77 offset:10240
    v_mfma_f32_16x16x32_bf16 v[44:47], a[44:47], a[68:71], v[44:47]
    ds_read_b128 a[24:27], v77 offset:12288
    v_mfma_f32_16x16x32_bf16 v[48:51], a[48:51], a[64:67], v[48:51]
    s_mov_b32 s5, s6
    v_mfma_f32_16x16x32_bf16 v[52:55], a[48:51], a[68:71], v[52:55]
    v_mfma_f32_16x16x32_bf16 v[56:59], a[52:55], a[64:67], v[56:59]
    v_mfma_f32_16x16x32_bf16 v[60:63], a[52:55], a[68:71], v[60:63]
    s_waitcnt lgkmcnt(0)
    v_add_u32 v80, s5, v74
    v_add_u32 v81, s5, v75
    v_add_u32 v82, s5, v76
    v_mfma_f32_16x16x32_bf16 v[8:11], a[0:3], a[56:59], v[8:11]
    ds_read_b128 a[64:67], v81
    v_mfma_f32_16x16x32_bf16 v[12:15], a[0:3], a[60:63], v[12:15]
    ds_read_b128 a[68:71], v82
    v_mfma_f32_16x16x32_bf16 v[16:19], a[4:7], a[56:59], v[16:19]
    ds_read_b128 a[28:31], v80 offset:0
    v_mfma_f32_16x16x32_bf16 v[20:23], a[4:7], a[60:63], v[20:23]
    ds_read_b128 a[32:35], v80 offset:2048
    v_mfma_f32_16x16x32_bf16 v[24:27], a[8:11], a[56:59], v[24:27]
    ds_read_b128 a[36:39], v80 offset:4096
    v_mfma_f32_16x16x32_bf16 v[28:31], a[8:11], a[60:63], v[28:31]
    ds_read_b128 a[40:43], v80 offset:6144
    v_mfma_f32_16x16x32_bf16 v[32:35], a[12:15], a[56:59], v[32:35]
    ds_read_b128 a[44:47], v80 offset:8192
    v_mfma_f32_16x16x32_bf16 v[36:39], a[12:15], a[60:63], v[36:39]
    ds_read_b128 a[48:51], v80 offset:10240
    v_mfma_f32_16x16x32_bf16 v[40:43], a[16:19], a[56:59], v[40:43]
    ds_read_b128 a[52:55], v80 offset:12288
    v_mfma_f32_16x16x32_bf16 v[44:47], a[16:19], a[60:63], v[44:47]
    s_add_u32 s6, s5, 45056
    v_mfma_f32_16x16x32_bf16 v[48:51], a[20:23], a[56:59], v[48:51]
    s_cmp_eq_u32 s6, 135168
    s_cselect_b32 s6, 0, s6
    v_mfma_f32_16x16x32_bf16 v[52:55], a[20:23], a[60:63], v[52:55]
    v_mfma_f32_16x16x32_bf16 v[56:59], a[24:27], a[56:59], v[56:59]
    v_mfma_f32_16x16x32_bf16 v[60:63], a[24:27], a[60:63], v[60:63]
    s_waitcnt lgkmcnt(0)
    v_mfma_f32_16x16x32_bf16 v[8:11], a[28:31], a[64:67], v[8:11]
    v_mfma_f32_16x16x32_bf16 v[12:15], a[28:31], a[68:71], v[12:15]
    v_mfma_f32_16x16x32_bf16 v[16:19], a[32:35], a[64:67], v[16:19]
    v_mfma_f32_16x16x32_bf16 v[20:23], a[32:35], a[68:71], v[20:23]
    v_mfma_f32_16x16x32_bf16 v[24:27], a[36:39], a[64:67], v[24:27]
    v_mfma_f32_16x16x32_bf16 v[28:31], a[36:39], a[68:71], v[28:31]
    v_mfma_f32_16x16x32_bf16 v[32:35], a[40:43], a[64:67], v[32:35]
    v_mfma_f32_16x16x32_bf16 v[36:39], a[40:43], a[68:71], v[36:39]
    v_mfma_f32_16x16x32_bf16 v[40:43], a[44:47], a[64:67], v[40:43]
    v_mfma_f32_16x16x32_bf16 v[44:47], a[44:47], a[68:71], v[44:47]
    v_mfma_f32_16x16x32_bf16 v[48:51], a[48:51], a[64:67], v[48:51]
    v_mfma_f32_16x16x32_bf16 v[52:55], a[48:51], a[68:71], v[52:55]
    v_mfma_f32_16x16x32_bf16 v[56:59], a[52:55], a[64:67], v[56:59]
    v_mfma_f32_16x16x32_bf16 v[60:63], a[52:55], a[68:71], v[60:63]
    s_nop 7
    s_nop 7
    s_branch k3k3_epi3
k3k3_hload2:
    s_and_b32 s70, s64, 3
    s_lshl_b32 s68, s65, 7
    s_lshl_b32 s69, s70, 5
    s_add_u32 s68, s68, s69
    v_add_u32 v6, s68, v4
    v_mul_u32_u24 v6, 1280, v6
    v_add_u32 v64, v6, v5
    v_add_u32 v65, 0x2800, v64
    v_add_u32 v66, 0x5000, v64
    v_add_u32 v67, 0x7800, v64
    s_lshl_b32 s75, s70, 12
    s_add_u32 s75, s75, 28672
    s_waitcnt lgkmcnt(0)
    s_add_u32 s40, s38, 0x800000
    s_addc_u32 s41, s39, 0
    s_and_b32 s41, s41, 0xffff
    s_mov_b32 s42, 0x280000
    s_mov_b32 s43, 0x00020000
    s_mov_b32 s5, 0
    s_add_u32 s7, s75, s5
    s_add_u32 m0, s7, 0x0
    s_nop 0
    buffer_load_dwordx4 v64, s[40:43], s67 offen lds
    s_add_u32 m0, s7, 0x400
    s_nop 0
    buffer_load_dwordx4 v65, s[40:43], s67 offen lds
    s_add_u32 m0, s7, 0x800
    s_nop 0
    buffer_load_dwordx4 v66, s[40:43], s67 offen lds
    s_add_u32 m0, s7, 0xc00
    s_nop 0
    buffer_load_dwordx4 v67, s[40:43], s67 offen lds
    s_add_u32 s67, s67, 128
    s_add_u32 s48, s38, 0xc00000
    s_addc_u32 s49, s39, 0
    s_and_b32 s49, s49, 0xffff
    s_mov_b32 s50, 0x20000
    s_mov_b32 s51, 0x00020000
    s_add_u32 s52, s38, 0xd00000
    s_addc_u32 s53, s39, 0
    s_and_b32 s53, s53, 0xffff
    s_mov_b32 s54, 0x7000
    s_mov_b32 s55, 0x00020000
    s_lshl_b32 s69, s65, 7
    s_lshl_b32 s70, s76, 5
    s_add_u32 s69, s69, s70
    s_xor_b32 s68, s73, 0
    s_lshl_b32 s68, s68, 4
    s_add_u32 s68, s68, s69
    v_add_u32 v7, s68, v2
    v_lshlrev_b32 v6, 6, v7
    v_lshl_add_u32 v6, v3, 4, v6
    buffer_load_dwordx4 v[112:115], v6, s[48:51], 0 offen
    v_mul_u32_u24 v7, 3456, v7
    v_lshl_add_u32 v148, v3, 3, v7
    s_xor_b32 s68, s73, 1
    s_lshl_b32 s68, s68, 4
    s_add_u32 s68, s68, s69
    v_add_u32 v7, s68, v2
    v_lshlrev_b32 v6, 6, v7
    v_lshl_add_u32 v6, v3, 4, v6
    buffer_load_dwordx4 v[116:119], v6, s[48:51], 0 offen
    v_mul_u32_u24 v7, 3456, v7
    v_lshl_add_u32 v149, v3, 3, v7
    s_lshl_b32 s68, s73, 6
    s_add_u32 s68, s68, s74
    s_lshl_b32 s9, s68, 1
    s_add_u32 s10, s74, 48
    s_lshl_b32 s10, s10, 1
    v_lshl_add_u32 v6, v3, 2, s68
    v_lshlrev_b32 v6, 2, v6
    s_mov_b32 s69, 6912
    s_mul_i32 s68, s73, 6656
    buffer_load_dwordx4 v[84:87], v6, s[52:55], 0 offen offset:0
    buffer_load_dwordx4 v[88:91], v6, s[52:55], s69 offen offset:0
    buffer_load_dwordx4 v[92:95], v6, s[52:55], 0 offen offset:64
    buffer_load_dwordx4 v[96:99], v6, s[52:55], s69 offen offset:64
    buffer_load_dwordx4 v[100:103], v6, s[52:55], 0 offen offset:128
    buffer_load_dwordx4 v[104:107], v6, s[52:55], s69 offen offset:128
    buffer_load_dwordx4 v[108:111], v6, s[52:55], s68 offen offset:192
    s_mov_b32 s5, 45056
    s_add_u32 s7, s75, s5
    s_add_u32 m0, s7, 0x0
    s_nop 0
    buffer_load_dwordx4 v64, s[40:43], s67 offen lds
    s_add_u32 m0, s7, 0x400
    s_nop 0
    buffer_load_dwordx4 v65, s[40:43], s67 offen lds
    s_add_u32 m0, s7, 0x800
    s_nop 0
    buffer_load_dwordx4 v66, s[40:43], s67 offen lds
    s_add_u32 m0, s7, 0xc00
    s_nop 0
    buffer_load_dwordx4 v67, s[40:43], s67 offen lds
    s_add_u32 s67, s67, 128
    s_mov_b32 s5, 90112
    s_add_u32 s7, s75, s5
    s_add_u32 m0, s7, 0x0
    s_nop 0
    buffer_load_dwordx4 v64, s[40:43], s67 offen lds
    s_add_u32 m0, s7, 0x400
    s_nop 0
    buffer_load_dwordx4 v65, s[40:43], s67 offen lds
    s_add_u32 s56, s38, 0x2000000
    s_addc_u32 s57, s39, 0
    s_and_b32 s57, s57, 0xffff
    s_mov_b32 s58, 0x6c0000
    s_mov_b32 s59, 0x00020000
    s_mul_i32 s68, s73, 14336
    v_and_b32 v6, 7, v2
    v_add_u32 v7, 0, v3
    v_xor_b32 v6, v6, v7
    v_lshlrev_b32 v6, 4, v6
    v_lshl_add_u32 v6, v2, 7, v6
    v_add_u32 v71, s68, v6
    s_lshl_b32 s69, s76, 12
    s_sub_u32 s69, s69, s68
    s_add_u32 s69, s69, 28672
    s_lshl_b32 s70, s73, 11
    s_add_u32 s71, s69, s70
    v_add_u32 v72, s71, v71
    s_sub_u32 s71, s69, s70
    s_add_u32 s71, s71, 2048
    v_add_u32 v73, s71, v71
    s_mul_i32 s68, s73, 14336
    v_and_b32 v6, 7, v2
    v_add_u32 v7, 4, v3
    v_xor_b32 v6, v6, v7
    v_lshlrev_b32 v6, 4, v6
    v_lshl_add_u32 v6, v2, 7, v6
    v_add_u32 v74, s68, v6
    s_lshl_b32 s69, s76, 12
    s_sub_u32 s69, s69, s68
    s_add_u32 s69, s69, 28672
    s_lshl_b32 s70, s73, 11
    s_add_u32 s71, s69, s70
    v_add_u32 v75, s71, v74
    s_sub_u32 s71, s69, s70
    s_add_u32 s71, s71, 2048
    v_add_u32 v76, s71, v74
    v_lshlrev_b32 v6, 4, v1
    s_lshl_b32 s68, s64, 10
    v_add_u32 v150, s68, v6
    s_xor_b32 s68, s68, 2048
    v_add_u32 v151, s68, v6
    s_cmp_eq_u32 s73, 1
    s_cselect_b64 s[78:79], -1, 0
    s_mov_b32 s4, 0
    s_mov_b32 s5, 0
    v_add_u32 v77, s5, v71
    v_add_u32 v78, s5, v72
    v_add_u32 v79, s5, v73
    s_waitcnt vmcnt(15)
    s_barrier
    ds_read_b128 a[56:59], v78
    ds_read_b128 a[60:63], v79
    ds_read_b128 a[0:3], v77 offset:0
    ds_read_b128 a[4:7], v77 offset:2048
    ds_read_b128 a[8:11], v77 offset:4096
    ds_read_b128 a[12:15], v77 offset:6144
    ds_read_b128 a[16:19], v77 offset:8192
    ds_read_b128 a[20:23], v77 offset:10240
    ds_read_b128 a[24:27], v77 offset:12288
    s_waitcnt lgkmcnt(0)
    v_add_u32 v80, s5, v74
    v_add_u32 v81, s5, v75
    v_add_u32 v82, s5, v76
    v_mfma_f32_16x16x32_bf16 v[8:11], a[0:3], a[56:59], 0
    ds_read_b128 a[64:67], v81
    ds_read_b128 a[68:71], v82
    v_mfma_f32_16x16x32_bf16 v[12:15], a[0:3], a[60:63], 0
    ds_read_b128 a[28:31], v80 offset:0
    ds_read_b128 a[32:35], v80 offset:2048
    v_mfma_f32_16x16x32_bf16 v[16:19], a[4:7], a[56:59], 0
    ds_read_b128 a[36:39], v80 offset:4096
    ds_read_b128 a[40:43], v80 offset:6144
    v_mfma_f32_16x16x32_bf16 v[20:23], a[4:7], a[60:63], 0
    ds_read_b128 a[44:47], v80 offset:8192
    ds_read_b128 a[48:51], v80 offset:10240
    v_mfma_f32_16x16x32_bf16 v[24:27], a[8:11], a[56:59], 0
    ds_read_b128 a[52:55], v80 offset:12288
    s_add_u32 m0, s7, 0x800
    v_mfma_f32_16x16x32_bf16 v[28:31], a[8:11], a[60:63], 0
    buffer_load_dwordx4 v66, s[40:43], s67 offen lds
    s_add_u32 m0, s7, 0xc00
    v_mfma_f32_16x16x32_bf16 v[32:35], a[12:15], a[56:59], 0
    buffer_load_dwordx4 v67, s[40:43], s67 offen lds
    s_add_u32 s67, s67, 128
    v_mfma_f32_16x16x32_bf16 v[36:39], a[12:15], a[60:63], 0
    s_add_u32 s6, s5, 45056
    s_cmp_eq_u32 s6, 135168
    s_cselect_b32 s6, 0, s6
    v_mfma_f32_16x16x32_bf16 v[40:43], a[16:19], a[56:59], 0
    v_mfma_f32_16x16x32_bf16 v[44:47], a[16:19], a[60:63], 0
    v_mfma_f32_16x16x32_bf16 v[48:51], a[20:23], a[56:59], 0
    v_mfma_f32_16x16x32_bf16 v[52:55], a[20:23], a[60:63], 0
    v_mfma_f32_16x16x32_bf16 v[56:59], a[24:27], a[56:59], 0
    v_mfma_f32_16x16x32_bf16 v[60:63], a[24:27], a[60:63], 0
    s_waitcnt lgkmcnt(0)
    v_mfma_f32_16x16x32_bf16 v[8:11], a[28:31], a[64:67], v[8:11]
    v_mfma_f32_16x16x32_bf16 v[12:15], a[28:31], a[68:71], v[12:15]
    v_add_u32 v77, s6, v71
    v_add_u32 v78, s6, v72
    v_add_u32 v79, s6, v73
    s_waitcnt vmcnt(4)
    s_barrier
    ds_read_b128 a[56:59], v78
    v_mfma_f32_16x16x32_bf16 v[16:19], a[32:35], a[64:67], v[16:19]
    ds_read_b128 a[60:63], v79
    ds_read_b128 a[0:3], v77 offset:0
    ds_read_b128 a[4:7], v77 offset:2048
    ds_read_b128 a[8:11], v77 offset:4096
    ds_read_b128 a[12:15], v77 offset:6144
    ds_read_b128 a[16:19], v77 offset:8192
    ds_read_b128 a[20:23], v77 offset:10240
    ds_read_b128 a[24:27], v77 offset:12288
    v_mfma_f32_16x16x32_bf16 v[20:23], a[32:35], a[68:71], v[20:23]
    s_add_u32 s7, s75, s5
    s_add_u32 m0, s7, 0x0
    s_nop 0
    buffer_load_dwordx4 v64, s[40:43], s67 offen lds
    s_add_u32 m0, s7, 0x400
    s_nop 0
    buffer_load_dwordx4 v65, s[40:43], s67 offen lds
    s_mov_b32 s5, s6
    s_mov_b32 s68, 0x3acccccd
    s_mov_b32 s69, 0x3c4ccccd
    v_mfma_f32_16x16x32_bf16 v[24:27], a[36:39], a[64:67], v[24:27]
    s_mov_b32 s70, 0x42a00000
    s_mov_b32 s71, 0x3727c5ac
    v_add_f32 v136, v112, v114
    v_mov_b32 v137, v136
    s_nop 1
    v_permlane16_swap_b32 v136, v137
    v_add_f32 v136, v136, v137
    v_mov_b32 v137, v136
    s_nop 1
    v_permlane32_swap_b32 v136, v137
    v_mfma_f32_16x16x32_bf16 v[28:31], a[36:39], a[68:71], v[28:31]
    v_add_f32 v136, v136, v137
    v_mul_f32 v136, s68, v136
    v_fma_f32 v112, v112, s69, -v136
    v_fma_f32 v114, v114, s69, -v136
    v_mul_f32 v112, v112, v112
    v_fmac_f32 v112, v114, v114
    v_add_f32 v113, v113, v115
    v_fma_f32 v113, v112, s70, v113
    v_mfma_f32_16x16x32_bf16 v[32:35], a[40:43], a[64:67], v[32:35]
    v_mov_b32 v137, v113
    s_nop 1
    v_permlane16_swap_b32 v113, v137
    v_add_f32 v113, v113, v137
    v_mov_b32 v137, v113
    s_nop 1
    v_permlane32_swap_b32 v113, v137
    v_add_f32 v113, v113, v137
    v_mul_f32 v113, s68, v113
    v_cvt_pk_bf16_f32 v136, v136, v136
    v_mfma_f32_16x16x32_bf16 v[36:39], a[40:43], a[68:71], v[36:39]
    v_lshlrev_b32 v136, 16, v136
    v_sub_f32 v120, 0, v136
    v_sub_f32 v121, 0, v136
    v_cvt_pk_bf16_f32 v113, v113, v113
    v_lshlrev_b32 v113, 16, v113
    v_add_f32 v113, s71, v113
    v_cvt_pk_bf16_f32 v113, v113, v113
    v_lshlrev_b32 v113, 16, v113
    v_mfma_f32_16x16x32_bf16 v[40:43], a[44:47], a[64:67], v[40:43]
    v_sqrt_f32 v113, v113
    s_nop 0
    v_cvt_pk_bf16_f32 v113, v113, v113
    v_lshlrev_b32 v113, 16, v113
    v_rcp_f32 v124, v113
    v_rcp_f32 v125, v113
    v_mul_f32 v128, 0xbfb8aa3b, v124
    v_cndmask_b32 v132, v128, v124, s[78:79]
    v_mul_f32 v129, 0xbfb8aa3b, v124
    v_mfma_f32_16x16x32_bf16 v[44:47], a[44:47], a[68:71], v[44:47]
    v_cndmask_b32 v133, v129, v124, s[78:79]
    v_add_f32 v136, v116, v118
    v_mov_b32 v137, v136
    s_nop 1
    v_permlane16_swap_b32 v136, v137
    v_add_f32 v136, v136, v137
    v_mov_b32 v137, v136
    s_nop 1
    v_permlane32_swap_b32 v136, v137
    v_add_f32 v136, v136, v137
    v_mfma_f32_16x16x32_bf16 v[48:51], a[48:51], a[64:67], v[48:51]
    v_mul_f32 v136, s68, v136
    v_fma_f32 v116, v116, s69, -v136
    v_fma_f32 v118, v118, s69, -v136
    v_mul_f32 v116, v116, v116
    v_fmac_f32 v116, v118, v118
    v_add_f32 v117, v117, v119
    v_fma_f32 v117, v116, s70, v117
    v_mov_b32 v137, v117
    v_mfma_f32_16x16x32_bf16 v[52:55], a[48:51], a[68:71], v[52:55]
    s_nop 0
    v_permlane16_swap_b32 v117, v137
    v_add_f32 v117, v117, v137
    v_mov_b32 v137, v117
    s_nop 1
    v_permlane32_swap_b32 v117, v137
    v_add_f32 v117, v117, v137
    v_mul_f32 v117, s68, v117
    v_cvt_pk_bf16_f32 v136, v136, v136
    v_lshlrev_b32 v136, 16, v136
    v_mfma_f32_16x16x32_bf16 v[56:59], a[52:55], a[64:67], v[56:59]
    v_sub_f32 v122, 0, v136
    v_sub_f32 v123, 0, v136
    v_cvt_pk_bf16_f32 v117, v117, v117
    v_lshlrev_b32 v117, 16, v117
    v_add_f32 v117, s71, v117
    v_cvt_pk_bf16_f32 v117, v117, v117
    v_lshlrev_b32 v117, 16, v117
    v_sqrt_f32 v117, v117
    v_mfma_f32_16x16x32_bf16 v[60:63], a[52:55], a[68:71], v[60:63]
    v_cvt_pk_bf16_f32 v117, v117, v117
    v_lshlrev_b32 v117, 16, v117
    v_rcp_f32 v126, v117
    v_rcp_f32 v127, v117
    v_mul_f32 v130, 0xbfb8aa3b, v126
    v_cndmask_b32 v134, v130, v126, s[78:79]
    v_mul_f32 v131, 0xbfb8aa3b, v126
    v_cndmask_b32 v135, v131, v126, s[78:79]
    s_mov_b32 s4, 1
k3k3_loop5:
    s_waitcnt lgkmcnt(0)
    v_add_u32 v80, s5, v74
    v_add_u32 v81, s5, v75
    v_add_u32 v82, s5, v76
    v_mfma_f32_16x16x32_bf16 v[8:11], a[0:3], a[56:59], v[8:11]
    ds_read_b128 a[64:67], v81
    ds_read_b128 a[68:71], v82
    v_mfma_f32_16x16x32_bf16 v[12:15], a[0:3], a[60:63], v[12:15]
    ds_read_b128 a[28:31], v80 offset:0
    ds_read_b128 a[32:35], v80 offset:2048
    v_mfma_f32_16x16x32_bf16 v[16:19], a[4:7], a[56:59], v[16:19]
    ds_read_b128 a[36:39], v80 offset:4096
    ds_read_b128 a[40:43], v80 offset:6144
    v_mfma_f32_16x16x32_bf16 v[20:23], a[4:7], a[60:63], v[20:23]
    ds_read_b128 a[44:47], v80 offset:8192
    ds_read_b128 a[48:51], v80 offset:10240
    v_mfma_f32_16x16x32_bf16 v[24:27], a[8:11], a[56:59], v[24:27]
    ds_read_b128 a[52:55], v80 offset:12288
    s_add_u32 m0, s7, 0x800
    v_mfma_f32_16x16x32_bf16 v[28:31], a[8:11], a[60:63], v[28:31]
    buffer_load_dwordx4 v66, s[40:43], s67 offen lds
    s_add_u32 m0, s7, 0xc00
    v_mfma_f32_16x16x32_bf16 v[32:35], a[12:15], a[56:59], v[32:35]
    buffer_load_dwordx4 v67, s[40:43], s67 offen lds
    s_add_u32 s67, s67, 128
    v_mfma_f32_16x16x32_bf16 v[36:39], a[12:15], a[60:63], v[36:39]
    s_add_u32 s6, s5, 45056
    s_cmp_eq_u32 s6, 135168
    s_cselect_b32 s6, 0, s6
    v_mfma_f32_16x16x32_bf16 v[40:43], a[16:19], a[56:59], v[40:43]
    v_mfma_f32_16x16x32_bf16 v[44:47], a[16:19], a[60:63], v[44:47]
    v_mfma_f32_16x16x32_bf16 v[48:51], a[20:23], a[56:59], v[48:51]
    v_mfma_f32_16x16x32_bf16 v[52:55], a[20:23], a[60:63], v[52:55]
    v_mfma_f32_16x16x32_bf16 v[56:59], a[24:27], a[56:59], v[56:59]
    v_mfma_f32_16x16x32_bf16 v[60:63], a[24:27], a[60:63], v[60:63]
    s_waitcnt lgkmcnt(0)
    v_mfma_f32_16x16x32_bf16 v[8:11], a[28:31], a[64:67], v[8:11]
    v_mfma_f32_16x16x32_bf16 v[12:15], a[28:31], a[68:71], v[12:15]
    v_add_u32 v77, s6, v71
    v_add_u32 v78, s6, v72
    v_add_u32 v79, s6, v73
    s_waitcnt vmcnt(4)
    s_barrier
    ds_read_b128 a[56:59], v78
    v_mfma_f32_16x16x32_bf16 v[16:19], a[32:35], a[64:67], v[16:19]
    ds_read_b128 a[60:63], v79
    ds_read_b128 a[0:3], v77 offset:0
    v_mfma_f32_16x16x32_bf16 v[20:23], a[32:35], a[68:71], v[20:23]
    ds_read_b128 a[4:7], v77 offset:2048
    ds_read_b128 a[8:11], v77 offset:4096
    v_mfma_f32_16x16x32_bf16 v[24:27], a[36:39], a[64:67], v[24:27]
    ds_read_b128 a[12:15], v77 offset:6144
    ds_read_b128 a[16:19], v77 offset:8192
    v_mfma_f32_16x16x32_bf16 v[28:31], a[36:39], a[68:71], v[28:31]
    ds_read_b128 a[20:23], v77 offset:10240
    ds_read_b128 a[24:27], v77 offset:12288
    v_mfma_f32_16x16x32_bf16 v[32:35], a[40:43], a[64:67], v[32:35]
    s_add_u32 s7, s75, s5
    s_add_u32 m0, s7, 0x0
    v_mfma_f32_16x16x32_bf16 v[36:39], a[40:43], a[68:71], v[36:39]
    buffer_load_dwordx4 v64, s[40:43], s67 offen lds
    s_add_u32 m0, s7, 0x400
    v_mfma_f32_16x16x32_bf16 v[40:43], a[44:47], a[64:67], v[40:43]
    buffer_load_dwordx4 v65, s[40:43], s67 offen lds
    s_mov_b32 s5, s6
    v_mfma_f32_16x16x32_bf16 v[44:47], a[44:47], a[68:71], v[44:47]
    v_mfma_f32_16x16x32_bf16 v[48:51], a[48:51], a[64:67], v[48:51]
    v_mfma_f32_16x16x32_bf16 v[52:55], a[48:51], a[68:71], v[52:55]
    v_mfma_f32_16x16x32_bf16 v[56:59], a[52:55], a[64:67], v[56:59]
    v_mfma_f32_16x16x32_bf16 v[60:63], a[52:55], a[68:71], v[60:63]
    s_add_u32 s4, s4, 1
    s_cmp_lt_u32 s4, 7
    s_cbranch_scc1 k3k3_loop5
    s_waitcnt lgkmcnt(0)
    v_add_u32 v80, s5, v74
    v_add_u32 v81, s5, v75
    v_add_u32 v82, s5, v76
    v_mfma_f32_16x16x32_bf16 v[8:11], a[0:3], a[56:59], v[8:11]
    ds_read_b128 a[64:67], v81
    ds_read_b128 a[68:71], v82
    v_mfma_f32_16x16x32_bf16 v[12:15], a[0:3], a[60:63], v[12:15]
    ds_read_b128 a[28:31], v80 offset:0
    ds_read_b128 a[32:35], v80 offset:2048
    v_mfma_f32_16x16x32_bf16 v[16:19], a[4:7], a[56:59], v[16:19]
    ds_read_b128 a[36:39], v80 offset:4096
    ds_read_b128 a[40:43], v80 offset:6144
    v_mfma_f32_16x16x32_bf16 v[20:23], a[4:7], a[60:63], v[20:23]
    ds_read_b128 a[44:47], v80 offset:8192
    ds_read_b128 a[48:51], v80 offset:10240
    v_mfma_f32_16x16x32_bf16 v[24:27], a[8:11], a[56:59], v[24:27]
    ds_read_b128 a[52:55], v80 offset:12288
    s_add_u32 m0, s7, 0x800
    v_mfma_f32_16x16x32_bf16 v[28:31], a[8:11], a[60:63], v[28:31]
    buffer_load_dwordx4 v66, s[40:43], s67 offen lds
    s_add_u32 m0, s7, 0xc00
    v_mfma_f32_16x16x32_bf16 v[32:35], a[12:15], a[56:59], v[32:35]
    buffer_load_dwordx4 v67, s[40:43], s67 offen lds
    s_add_u32 s67, s67, 128
    v_mfma_f32_16x16x32_bf16 v[36:39], a[12:15], a[60:63], v[36:39]
    s_add_u32 s6, s5, 45056
    s_cmp_eq_u32 s6, 135168
    s_cselect_b32 s6, 0, s6
    v_mfma_f32_16x16x32_bf16 v[40:43], a[16:19], a[56:59], v[40:43]
    v_mfma_f32_16x16x32_bf16 v[44:47], a[16:19], a[60:63], v[44:47]
    v_mfma_f32_16x16x32_bf16 v[48:51], a[20:23], a[56:59], v[48:51]
    v_mfma_f32_16x16x32_bf16 v[52:55], a[20:23], a[60:63], v[52:55]
    v_mfma_f32_16x16x32_bf16 v[56:59], a[24:27], a[56:59], v[56:59]
    v_mfma_f32_16x16x32_bf16 v[60:63], a[24:27], a[60:63], v[60:63]
    s_waitcnt lgkmcnt(0)
    v_mfma_f32_16x16x32_bf16 v[8:11], a[28:31], a[64:67], v[8:11]
    v_mfma_f32_16x16x32_bf16 v[12:15], a[28:31], a[68:71], v[12:15]
    v_add_u32 v77, s6, v71
    v_add_u32 v78, s6, v72
    v_add_u32 v79, s6, v73
    s_waitcnt vmcnt(4)
    s_barrier
    ds_read_b128 a[56:59], v78
    v_mfma_f32_16x16x32_bf16 v[16:19], a[32:35], a[64:67], v[16:19]
    ds_read_b128 a[60:63], v79
    v_mfma_f32_16x16x32_bf16 v[20:23], a[32:35], a[68:71], v[20:23]
    ds_read_b128 a[0:3], v77 offset:0
    v_mfma_f32_16x16x32_bf16 v[24:27], a[36:39], a[64:67], v[24:27]
    ds_read_b128 a[4:7], v77 offset:2048
    v_mfma_f32_16x16x32_bf16 v[28:31], a[36:39], a[68:71], v[28:31]
    ds_read_b128 a[8:11], v77 offset:4096
    v_mfma_f32_16x16x32_bf16 v[32:35], a[40:43], a[64:67], v[32:35]
    ds_read_b128 a[12:15], v77 offset:6144
    v_mfma_f32_16x16x32_bf16 v[36:39], a[40:43], a[68:71], v[36:39]
    ds_read_b128 a[16:19], v77 offset:8192
    v_mfma_f32_16x16x32_bf16 v[40:43], a[44:47], a[64:67], v[40:43]
    ds_read_b128 a[20:23], v77 offset:10240
    v_mfma_f32_16x16x32_bf16 v[44:47], a[44:47], a[68:71], v[44:47]
    ds_read_b128 a[24:27], v77 offset:12288
    v_mfma_f32_16x16x32_bf16 v[48:51], a[48:51], a[64:67], v[48:51]
    s_mov_b32 s5, s6
    v_mfma_f32_16x16x32_bf16 v[52:55], a[48:51], a[68:71], v[52:55]
    v_mfma_f32_16x16x32_bf16 v[56:59], a[52:55], a[64:67], v[56:59]
    v_mfma_f32_16x16x32_bf16 v[60:63], a[52:55], a[68:71], v[60:63]
    s_waitcnt lgkmcnt(0)
    v_add_u32 v80, s5, v74
    v_add_u32 v81, s5, v75
    v_add_u32 v82, s5, v76
    v_mfma_f32_16x16x32_bf16 v[8:11], a[0:3], a[56:59], v[8:11]
    ds_read_b128 a[64:67], v81
    v_mfma_f32_16x16x32_bf16 v[12:15], a[0:3], a[60:63], v[12:15]
    ds_read_b128 a[68:71], v82
    v_mfma_f32_16x16x32_bf16 v[16:19], a[4:7], a[56:59], v[16:19]
    ds_read_b128 a[28:31], v80 offset:0
    v_mfma_f32_16x16x32_bf16 v[20:23], a[4:7], a[60:63], v[20:23]
    ds_read_b128 a[32:35], v80 offset:2048
    v_mfma_f32_16x16x32_bf16 v[24:27], a[8:11], a[56:59], v[24:27]
    ds_read_b128 a[36:39], v80 offset:4096
    v_mfma_f32_16x16x32_bf16 v[28:31], a[8:11], a[60:63], v[28:31]
    ds_read_b128 a[40:43], v80 offset:6144
    v_mfma_f32_16x16x32_bf16 v[32:35], a[12:15], a[56:59], v[32:35]
    ds_read_b128 a[44:47], v80 offset:8192
    v_mfma_f32_16x16x32_bf16 v[36:39], a[12:15], a[60:63], v[36:39]
    ds_read_b128 a[48:51], v80 offset:10240
    v_mfma_f32_16x16x32_bf16 v[40:43], a[16:19], a[56:59], v[40:43]
    ds_read_b128 a[52:55], v80 offset:12288
    v_mfma_f32_16x16x32_bf16 v[44:47], a[16:19], a[60:63], v[44:47]
    s_add_u32 s6, s5, 45056
    v_mfma_f32_16x16x32_bf16 v[48:51], a[20:23], a[56:59], v[48:51]
    s_cmp_eq_u32 s6, 135168
    s_cselect_b32 s6, 0, s6
    v_mfma_f32_16x16x32_bf16 v[52:55], a[20:23], a[60:63], v[52:55]
    v_mfma_f32_16x16x32_bf16 v[56:59], a[24:27], a[56:59], v[56:59]
    v_mfma_f32_16x16x32_bf16 v[60:63], a[24:27], a[60:63], v[60:63]
    s_waitcnt lgkmcnt(0)
    v_mfma_f32_16x16x32_bf16 v[8:11], a[28:31], a[64:67], v[8:11]
    v_mfma_f32_16x16x32_bf16 v[12:15], a[28:31], a[68:71], v[12:15]
    v_add_u32 v77, s6, v71
    v_add_u32 v78, s6, v72
    v_add_u32 v79, s6, v73
    s_waitcnt vmcnt(0)
    s_barrier
    ds_read_b128 a[56:59], v78
    v_mfma_f32_16x16x32_bf16 v[16:19], a[32:35], a[64:67], v[16:19]
    ds_read_b128 a[60:63], v79
    v_mfma_f32_16x16x32_bf16 v[20:23], a[32:35], a[68:71], v[20:23]
    ds_read_b128 a[0:3], v77 offset:0
    v_mfma_f32_16x16x32_bf16 v[24:27], a[36:39], a[64:67], v[24:27]
    ds_read_b128 a[4:7], v77 offset:2048
    v_mfma_f32_16x16x32_bf16 v[28:31], a[36:39], a[68:71], v[28:31]
    ds_read_b128 a[8:11], v77 offset:4096
    v_mfma_f32_16x16x32_bf16 v[32:35], a[40:43], a[64:67], v[32:35]
    ds_read_b128 a[12:15], v77 offset:6144
    v_mfma_f32_16x16x32_bf16 v[36:39], a[40:43], a[68:71], v[36:39]
    ds_read_b128 a[16:19], v77 offset:8192
    v_mfma_f32_16x16x32_bf16 v[40:43], a[44:47], a[64:67], v[40:43]
    ds_read_b128 a[20:23], v77 offset:10240
    v_mfma_f32_16x16x32_bf16 v[44:47], a[44:47], a[68:71], v[44:47]
    ds_read_b128 a[24:27], v77 offset:12288
    v_mfma_f32_16x16x32_bf16 v[48:51], a[48:51], a[64:67], v[48:51]
    s_mov_b32 s5, s6
    v_mfma_f32_16x16x32_bf16 v[52:55], a[48:51], a[68:71], v[52:55]
    v_mfma_f32_16x16x32_bf16 v[56:59], a[52:55], a[64:67], v[56:59]
    v_mfma_f32_16x16x32_bf16 v[60:63], a[52:55], a[68:71], v[60:63]
    s_waitcnt lgkmcnt(0)
    v_add_u32 v80, s5, v74
    v_add_u32 v81, s5, v75
    v_add_u32 v82, s5, v76
    v_mfma_f32_16x16x32_bf16 v[8:11], a[0:3], a[56:59], v[8:11]
    ds_read_b128 a[64:67], v81
    v_mfma_f32_16x16x32_bf16 v[12:15], a[0:3], a[60:63], v[12:15]
    ds_read_b128 a[68:71], v82
    v_mfma_f32_16x16x32_bf16 v[16:19], a[4:7], a[56:59], v[16:19]
    ds_read_b128 a[28:31], v80 offset:0
    v_mfma_f32_16x16x32_bf16 v[20:23], a[4:7], a[60:63], v[20:23]
    ds_read_b128 a[32:35], v80 offset:2048
    v_mfma_f32_16x16x32_bf16 v[24:27], a[8:11], a[56:59], v[24:27]
    ds_read_b128 a[36:39], v80 offset:4096
    v_mfma_f32_16x16x32_bf16 v[28:31], a[8:11], a[60:63], v[28:31]
    ds_read_b128 a[40:43], v80 offset:6144
    v_mfma_f32_16x16x32_bf16 v[32:35], a[12:15], a[56:59], v[32:35]
    ds_read_b128 a[44:47], v80 offset:8192
    v_mfma_f32_16x16x32_bf16 v[36:39], a[12:15], a[60:63], v[36:39]
    ds_read_b128 a[48:51], v80 offset:10240
    v_mfma_f32_16x16x32_bf16 v[40:43], a[16:19], a[56:59], v[40:43]
    ds_read_b128 a[52:55], v80 offset:12288
    v_mfma_f32_16x16x32_bf16 v[44:47], a[16:19], a[60:63], v[44:47]
    s_add_u32 s6, s5, 45056
    v_mfma_f32_16x16x32_bf16 v[48:51], a[20:23], a[56:59], v[48:51]
    s_cmp_eq_u32 s6, 135168
    s_cselect_b32 s6, 0, s6
    v_mfma_f32_16x16x32_bf16 v[52:55], a[20:23], a[60:63], v[52:55]
    v_mfma_f32_16x16x32_bf16 v[56:59], a[24:27], a[56:59], v[56:59]
    v_mfma_f32_16x16x32_bf16 v[60:63], a[24:27], a[60:63], v[60:63]
    s_waitcnt lgkmcnt(0)
    v_mfma_f32_16x16x32_bf16 v[8:11], a[28:31], a[64:67], v[8:11]
    v_mfma_f32_16x16x32_bf16 v[12:15], a[28:31], a[68:71], v[12:15]
    v_mfma_f32_16x16x32_bf16 v[16:19], a[32:35], a[64:67], v[16:19]
    v_mfma_f32_16x16x32_bf16 v[20:23], a[32:35], a[68:71], v[20:23]
    v_mfma_f32_16x16x32_bf16 v[24:27], a[36:39], a[64:67], v[24:27]
    v_mfma_f32_16x16x32_bf16 v[28:31], a[36:39], a[68:71], v[28:31]
    v_mfma_f32_16x16x32_bf16 v[32:35], a[40:43], a[64:67], v[32:35]
    v_mfma_f32_16x16x32_bf16 v[36:39], a[40:43], a[68:71], v[36:39]
    v_mfma_f32_16x16x32_bf16 v[40:43], a[44:47], a[64:67], v[40:43]
    v_mfma_f32_16x16x32_bf16 v[44:47], a[44:47], a[68:71], v[44:47]
    v_mfma_f32_16x16x32_bf16 v[48:51], a[48:51], a[64:67], v[48:51]
    v_mfma_f32_16x16x32_bf16 v[52:55], a[48:51], a[68:71], v[52:55]
    v_mfma_f32_16x16x32_bf16 v[56:59], a[52:55], a[64:67], v[56:59]
    v_mfma_f32_16x16x32_bf16 v[60:63], a[52:55], a[68:71], v[60:63]
    s_nop 7
    s_nop 7
k3k3_epi3:
    v_pk_fma_f32 v[56:57], v[120:121], v[108:109], v[56:57]
    v_pk_fma_f32 v[58:59], v[120:121], v[110:111], v[58:59]
    v_pk_fma_f32 v[60:61], v[122:123], v[108:109], v[60:61]
    v_pk_fma_f32 v[62:63], v[122:123], v[110:111], v[62:63]
    v_pk_mul_f32 v[56:57], v[56:57], v[132:133]
    v_pk_mul_f32 v[58:59], v[58:59], v[132:133]
    v_pk_mul_f32 v[60:61], v[60:61], v[134:135]
    v_pk_mul_f32 v[62:63], v[62:63], v[134:135]
    s_barrier
    ds_write_b128 v150, v[60:63]
    s_waitcnt lgkmcnt(0)
    s_barrier
    ds_read_b128 v[60:63], v151
    s_cmp_lt_u32 s66, 15
    s_cselect_b32 s70, 0, s73
    s_cmp_eq_u32 s70, 0
    s_cbranch_scc0 k3k3_skip6
    v_pk_fma_f32 v[8:9], v[120:121], v[84:85], v[8:9]
    v_pk_fma_f32 v[10:11], v[120:121], v[86:87], v[10:11]
    v_pk_fma_f32 v[12:13], v[122:123], v[84:85], v[12:13]
    v_pk_fma_f32 v[14:15], v[122:123], v[86:87], v[14:15]
    v_pk_fma_f32 v[16:17], v[120:121], v[88:89], v[16:17]
    v_pk_fma_f32 v[18:19], v[120:121], v[90:91], v[18:19]
    v_pk_fma_f32 v[20:21], v[122:123], v[88:89], v[20:21]
    v_pk_fma_f32 v[22:23], v[122:123], v[90:91], v[22:23]
    v_pk_fma_f32 v[24:25], v[120:121], v[92:93], v[24:25]
    v_pk_fma_f32 v[26:27], v[120:121], v[94:95], v[26:27]
    v_pk_fma_f32 v[28:29], v[122:123], v[92:93], v[28:29]
    v_pk_fma_f32 v[30:31], v[122:123], v[94:95], v[30:31]
    v_pk_fma_f32 v[32:33], v[120:121], v[96:97], v[32:33]
    v_pk_fma_f32 v[34:35], v[120:121], v[98:99], v[34:35]
    v_pk_fma_f32 v[36:37], v[122:123], v[96:97], v[36:37]
    v_pk_fma_f32 v[38:39], v[122:123], v[98:99], v[38:39]
    v_pk_fma_f32 v[40:41], v[120:121], v[100:101], v[40:41]
    v_pk_fma_f32 v[42:43], v[120:121], v[102:103], v[42:43]
    v_pk_fma_f32 v[44:45], v[122:123], v[100:101], v[44:45]
    v_pk_fma_f32 v[46:47], v[122:123], v[102:103], v[46:47]
    v_pk_fma_f32 v[48:49], v[120:121], v[104:105], v[48:49]
    v_pk_fma_f32 v[50:51], v[120:121], v[106:107], v[50:51]
    v_pk_fma_f32 v[52:53], v[122:123], v[104:105], v[52:53]
    v_pk_fma_f32 v[54:55], v[122:123], v[106:107], v[54:55]
    v_pk_mul_f32 v[8:9], v[8:9], v[128:129]
    v_pk_mul_f32 v[10:11], v[10:11], v[128:129]
    v_pk_mul_f32 v[12:13], v[12:13], v[130:131]
    v_pk_mul_f32 v[14:15], v[14:15], v[130:131]
    v_pk_mul_f32 v[16:17], v[16:17], v[124:125]
    v_pk_mul_f32 v[18:19], v[18:19], v[124:125]
    v_pk_mul_f32 v[20:21], v[20:21], v[126:127]
    v_pk_mul_f32 v[22:23], v[22:23], v[126:127]
    v_pk_mul_f32 v[24:25], v[24:25], v[128:129]
    v_pk_mul_f32 v[26:27], v[26:27], v[128:129]
    v_pk_mul_f32 v[28:29], v[28:29], v[130:131]
    v_pk_mul_f32 v[30:31], v[30:31], v[130:131]
    v_pk_mul_f32 v[32:33], v[32:33], v[124:125]
    v_pk_mul_f32 v[34:35], v[34:35], v[124:125]
    v_pk_mul_f32 v[36:37], v[36:37], v[126:127]
    v_pk_mul_f32 v[38:39], v[38:39], v[126:127]
    v_pk_mul_f32 v[40:41], v[40:41], v[128:129]
    v_pk_mul_f32 v[42:43], v[42:43], v[128:129]
    v_pk_mul_f32 v[44:45], v[44:45], v[130:131]
    v_pk_mul_f32 v[46:47], v[46:47], v[130:131]
    v_pk_mul_f32 v[48:49], v[48:49], v[124:125]
    v_pk_mul_f32 v[50:51], v[50:51], v[124:125]
    v_pk_mul_f32 v[52:53], v[52:53], v[126:127]
    v_pk_mul_f32 v[54:55], v[54:55], v[126:127]
    v_exp_f32 v8, v8
    v_exp_f32 v9, v9
    v_exp_f32 v10, v10
    v_exp_f32 v11, v11
    v_exp_f32 v12, v12
    v_exp_f32 v13, v13
    v_exp_f32 v14, v14
    v_exp_f32 v15, v15
    v_exp_f32 v24, v24
    v_exp_f32 v25, v25
    v_exp_f32 v26, v26
    v_exp_f32 v27, v27
    v_exp_f32 v28, v28
    v_exp_f32 v29, v29
    v_exp_f32 v30, v30
    v_exp_f32 v31, v31
    v_exp_f32 v40, v40
    v_exp_f32 v41, v41
    v_exp_f32 v42, v42
    v_exp_f32 v43, v43
    v_exp_f32 v44, v44
    v_exp_f32 v45, v45
    v_exp_f32 v46, v46
    v_exp_f32 v47, v47
    v_pk_add_f32 v[8:9], v[8:9], 1.0 op_sel_hi:[1,0]
    v_pk_add_f32 v[10:11], v[10:11], 1.0 op_sel_hi:[1,0]
    v_pk_add_f32 v[12:13], v[12:13], 1.0 op_sel_hi:[1,0]
    v_pk_add_f32 v[14:15], v[14:15], 1.0 op_sel_hi:[1,0]
    v_pk_add_f32 v[24:25], v[24:25], 1.0 op_sel_hi:[1,0]
    v_pk_add_f32 v[26:27], v[26:27], 1.0 op_sel_hi:[1,0]
    v_pk_add_f32 v[28:29], v[28:29], 1.0 op_sel_hi:[1,0]
    v_pk_add_f32 v[30:31], v[30:31], 1.0 op_sel_hi:[1,0]
    v_pk_add_f32 v[40:41], v[40:41], 1.0 op_sel_hi:[1,0]
    v_pk_add_f32 v[42:43], v[42:43], 1.0 op_sel_hi:[1,0]
    v_pk_add_f32 v[44:45], v[44:45], 1.0 op_sel_hi:[1,0]
    v_pk_add_f32 v[46:47], v[46:47], 1.0 op_sel_hi:[1,0]
    v_rcp_f32 v8, v8
    v_rcp_f32 v9, v9
    v_rcp_f32 v10, v10
    v_rcp_f32 v11, v11
    v_rcp_f32 v12, v12
    v_rcp_f32 v13, v13
    v_rcp_f32 v14, v14
    v_rcp_f32 v15, v15
    v_rcp_f32 v24, v24
    v_rcp_f32 v25, v25
    v_rcp_f32 v26, v26
    v_rcp_f32 v27, v27
    v_rcp_f32 v28, v28
    v_rcp_f32 v29, v29
    v_rcp_f32 v30, v30
    v_rcp_f32 v31, v31
    v_rcp_f32 v40, v40
    v_rcp_f32 v41, v41
    v_rcp_f32 v42, v42
    v_rcp_f32 v43, v43
    v_rcp_f32 v44, v44
    v_rcp_f32 v45, v45
    v_rcp_f32 v46, v46
    v_rcp_f32 v47, v47
    v_pk_mul_f32 v[16:17], v[16:17], v[8:9]
    v_pk_mul_f32 v[18:19], v[18:19], v[10:11]
    v_pk_mul_f32 v[20:21], v[20:21], v[12:13]
    v_pk_mul_f32 v[22:23], v[22:23], v[14:15]
    v_pk_mul_f32 v[32:33], v[32:33], v[24:25]
    v_pk_mul_f32 v[34:35], v[34:35], v[26:27]
    v_pk_mul_f32 v[36:37], v[36:37], v[28:29]
    v_pk_mul_f32 v[38:39], v[38:39], v[30:31]
    v_pk_mul_f32 v[48:49], v[48:49], v[40:41]
    v_pk_mul_f32 v[50:51], v[50:51], v[42:43]
    v_pk_mul_f32 v[52:53], v[52:53], v[44:45]
    v_pk_mul_f32 v[54:55], v[54:55], v[46:47]
    v_cvt_pk_bf16_f32 v8, v16, v17
    v_cvt_pk_bf16_f32 v9, v18, v19
    v_cvt_pk_bf16_f32 v12, v20, v21
    v_cvt_pk_bf16_f32 v13, v22, v23
    v_cvt_pk_bf16_f32 v24, v32, v33
    v_cvt_pk_bf16_f32 v25, v34, v35
    v_cvt_pk_bf16_f32 v28, v36, v37
    v_cvt_pk_bf16_f32 v29, v38, v39
    v_cvt_pk_bf16_f32 v40, v48, v49
    v_cvt_pk_bf16_f32 v41, v50, v51
    v_cvt_pk_bf16_f32 v44, v52, v53
    v_cvt_pk_bf16_f32 v45, v54, v55
    buffer_store_dwordx2 v[8:9], v148, s[56:59], s9 offen offset:0
    buffer_store_dwordx2 v[12:13], v149, s[56:59], s9 offen offset:0
    buffer_store_dwordx2 v[24:25], v148, s[56:59], s9 offen offset:32
    buffer_store_dwordx2 v[28:29], v149, s[56:59], s9 offen offset:32
    buffer_store_dwordx2 v[40:41], v148, s[56:59], s9 offen offset:64
    buffer_store_dwordx2 v[44:45], v149, s[56:59], s9 offen offset:64
    s_cmp_lt_u32 s66, 15
    s_cbranch_scc0 k3k3_skip6
    s_waitcnt lgkmcnt(0)
    v_cndmask_b32 v140, v56, v60, s[78:79]
    v_cndmask_b32 v144, v60, v56, s[78:79]
    v_cndmask_b32 v141, v57, v61, s[78:79]
    v_cndmask_b32 v145, v61, v57, s[78:79]
    v_cndmask_b32 v142, v58, v62, s[78:79]
    v_cndmask_b32 v146, v62, v58, s[78:79]
    v_cndmask_b32 v143, v59, v63, s[78:79]
    v_cndmask_b32 v147, v63, v59, s[78:79]
    v_exp_f32 v140, v140
    v_exp_f32 v141, v141
    v_exp_f32 v142, v142
    v_exp_f32 v143, v143
    v_pk_add_f32 v[140:141], v[140:141], 1.0 op_sel_hi:[1,0]
    v_pk_add_f32 v[142:143], v[142:143], 1.0 op_sel_hi:[1,0]
    v_rcp_f32 v140, v140
    v_rcp_f32 v141, v141
    v_rcp_f32 v142, v142
    v_rcp_f32 v143, v143
    v_pk_mul_f32 v[144:145], v[144:145], v[140:141]
    v_pk_mul_f32 v[146:147], v[146:147], v[142:143]
    v_cvt_pk_bf16_f32 v56, v144, v145
    v_cvt_pk_bf16_f32 v57, v146, v147
    buffer_store_dwordx2 v[56:57], v148, s[56:59], s10 offen
k3k3_skip6:
k3k3_end1:
    s_endpgm
.section .rodata,"a"
.p2align 6
.amdhsa_kernel k3_kernel
  .amdhsa_next_free_vgpr 224
  .amdhsa_next_free_sgpr 102
  .amdhsa_accum_offset 152
  .amdhsa_group_segment_fixed_size 0
  .amdhsa_kernarg_size 96
  .amdhsa_user_sgpr_count 2
  .amdhsa_user_sgpr_kernarg_segment_ptr 1
  .amdhsa_system_sgpr_workgroup_id_x 1
.end_amdhsa_kernel
.text
.globl k4_kernel
.p2align 8
.type k4_kernel,@function
k4_kernel:
    s_cmp_ge_u32 s2, 256
    s_cbranch_scc1 k4k4_end1
    s_load_dwordx16 s[16:31], s[0:1], 0
    s_load_dwordx8 s[32:39], s[0:1], 64
    v_readfirstlane_b32 s64, v0
    v_and_b32 v1, 63, v0
    s_lshr_b32 s64, s64, 6
    v_and_b32 v2, 15, v1
    v_lshrrev_b32 v3, 4, v1
    v_lshrrev_b32 v4, 3, v1
    v_and_b32 v6, 7, v1
    v_xor_b32 v5, v6, v4
    v_lshlrev_b32 v5, 4, v5
    s_bfe_u32 s65, s2, 0x20001
    s_lshl_b32 s65, s65, 3
    s_bfe_u32 s72, s2, 0x30003
    s_add_u32 s65, s65, s72
    s_and_b32 s66, s2, 1
    s_lshl_b32 s66, s66, 2
    s_lshr_b32 s72, s2, 6
    s_add_u32 s66, s66, s72
    s_mul_i32 s69, s64, 36864
    s_mul_i32 s70, s66, 80
    v_add_u32 v6, s70, v4
    v_mul_u32_u24 v6, 3456, v6
    v_add_u32 v162, v6, v5
    v_add_u32 v163, 0x6c00, v162
    v_add_u32 v164, 0xd800, v162
    v_add_u32 v165, 0x14400, v162
    v_add_u32 v166, 0x1b000, v162
    v_add_u32 v167, 0x21c00, v162
    v_add_u32 v168, 0x28800, v162
    v_add_u32 v169, 0x2f400, v162
    v_add_u32 v170, 0x36000, v162
    v_add_u32 v171, 0x3cc00, v162
    s_lshl_b32 s71, s65, 6
    v_add_u32 v6, s71, v4
    v_mul_u32_u24 v6, 3456, v6
    v_add_u32 v7, v6, v5
    s_add_u32 s70, s64, 0
    s_and_b32 s70, s70, 3
    s_mul_i32 s70, s70, 55296
    v_add_u32 v172, s70, v7
    v_add_u32 v173, 0x6c00, v172
    s_add_u32 s70, s64, 1
    s_and_b32 s70, s70, 3
    s_mul_i32 s70, s70, 55296
    v_add_u32 v174, s70, v7
    v_add_u32 v175, 0x6c00, v174
    s_add_u32 s70, s64, 2
    s_and_b32 s70, s70, 3
    s_mul_i32 s70, s70, 55296
    v_add_u32 v176, s70, v7
    v_add_u32 v177, 0x6c00, v176
    s_add_u32 s70, s64, 3
    s_and_b32 s70, s70, 3
    s_mul_i32 s70, s70, 55296
    v_add_u32 v178, s70, v7
    v_add_u32 v179, 0x6c00, v178
    s_mul_i32 s67, s64, 896
    s_cmp_eq_u32 s64, 3
    s_cselect_b32 s68, 6, 7
    s_waitcnt lgkmcnt(0)
    s_add_u32 s40, s38, 0x1438000
    s_addc_u32 s41, s39, 0
    s_and_b32 s41, s41, 0xffff
    s_mov_b32 s42, 0x21c000
    s_mov_b32 s43, 0x00020000
    s_add_u32 s44, s38, 0x2000000
    s_addc_u32 s45, s39, 0
    s_and_b32 s45, s45, 0xffff
    s_mov_b32 s46, 0x6c0000
    s_mov_b32 s47, 0x00020000
    s_mov_b32 s73, s69
k4k4_pro3:
    s_add_u32 m0, s73, 0x0
    s_nop 0
    buffer_load_dwordx4 v162, s[40:43], s67 offen lds
    s_add_u32 m0, s73, 0x400
    s_nop 0
    buffer_load_dwordx4 v163, s[40:43], s67 offen lds
    s_add_u32 m0, s73, 0x800
    s_nop 0
    buffer_load_dwordx4 v164, s[40:43], s67 offen lds
    s_add_u32 m0, s73, 0xc00
    s_nop 0
    buffer_load_dwordx4 v165, s[40:43], s67 offen lds
    s_add_u32 m0, s73, 0x1000
    s_nop 0
    buffer_load_dwordx4 v166, s[40:43], s67 offen lds
    s_add_u32 m0, s73, 0x1400
    s_nop 0
    buffer_load_dwordx4 v167, s[40:43], s67 offen lds
    s_add_u32 m0, s73, 0x1800
    s_nop 0
    buffer_load_dwordx4 v168, s[40:43], s67 offen lds
    s_add_u32 m0, s73, 0x1c00
    s_nop 0
    buffer_load_dwordx4 v169, s[40:43], s67 offen lds
    s_add_u32 m0, s73, 0x2000
    s_nop 0
    buffer_load_dwordx4 v170, s[40:43], s67 offen lds
    s_add_u32 m0, s73, 0x2400
    s_nop 0
    buffer_load_dwordx4 v171, s[40:43], s67 offen lds
    s_add_u32 m0, s73, 0x2800
    s_nop 0
    buffer_load_dwordx4 v172, s[44:47], s67 offen lds
    s_add_u32 m0, s73, 0x2c00
    s_nop 0
    buffer_load_dwordx4 v173, s[44:47], s67 offen lds
    s_add_u32 m0, s73, 0x3000
    s_nop 0
    buffer_load_dwordx4 v174, s[44:47], s67 offen lds
    s_add_u32 m0, s73, 0x3400
    s_nop 0
    buffer_load_dwordx4 v175, s[44:47], s67 offen lds
    s_add_u32 m0, s73, 0x3800
    s_nop 0
    buffer_load_dwordx4 v176, s[44:47], s67 offen lds
    s_add_u32 m0, s73, 0x3c00
    s_nop 0
    buffer_load_dwordx4 v177, s[44:47], s67 offen lds
    s_add_u32 m0, s73, 0x4000
    s_nop 0
    buffer_load_dwordx4 v178, s[44:47], s67 offen lds
    s_add_u32 m0, s73, 0x4400
    s_nop 0
    buffer_load_dwordx4 v179, s[44:47], s67 offen lds
    s_add_u32 s67, s67, 128
    s_add_u32 s73, s73, 18432
    s_sub_u32 s70, s73, s69
    s_cmp_lt_u32 s70, 36864
    s_cbranch_scc1 k4k4_pro3
    s_add_u32 s48, s38, 0x800000
    s_addc_u32 s49, s39, 0
    s_and_b32 s49, s49, 0xffff
    s_mov_b32 s50, 0x280000
    s_mov_b32 s51, 0x00020000
    s_mov_b32 s52, s34
    s_mov_b32 s53, s35
    s_and_b32 s53, s53, 0xffff
    s_mov_b32 s54, 0x280000
    s_mov_b32 s55, 0x00020000
    s_lshl_b32 s70, s65, 6
    s_lshl_b32 s71, s64, 4
    s_add_u32 s70, s70, s71
    v_add_u32 v6, s70, v2
    v_mul_u32_u24 v190, 1280, v6
    v_lshl_add_u32 v190, v3, 3, v190
    s_mul_i32 s71, s66, 160
    v_add_u32 v190, s71, v190
    buffer_load_dwordx2 v[180:181], v190, s[48:51], 0 offen offset:0
    buffer_load_dwordx2 v[182:183], v190, s[48:51], 0 offen offset:32
    buffer_load_dwordx2 v[184:185], v190, s[48:51], 0 offen offset:64
    buffer_load_dwordx2 v[186:187], v190, s[48:51], 0 offen offset:96
    buffer_load_dwordx2 v[188:189], v190, s[48:51], 0 offen offset:128
    v_and_b32 v6, 7, v2
    v_add_u32 v7, 0, v3
    v_xor_b32 v6, v6, v7
    v_lshlrev_b32 v6, 4, v6
    v_lshl_add_u32 v6, v2, 7, v6
    v_add_u32 v160, s69, v6
    v_and_b32 v6, 7, v2
    v_add_u32 v7, 4, v3
    v_xor_b32 v6, v6, v7
    v_lshlrev_b32 v6, 4, v6
    v_lshl_add_u32 v6, v2, 7, v6
    v_add_u32 v161, s69, v6
    v_lshlrev_b32 v6, 4, v1
    v_add_u32 v193, s69, v6
    s_sub_u32 s70, s64, 1
    s_and_b32 s70, s70, 3
    s_mul_i32 s70, s70, 36864
    v_add_u32 v194, s70, v6
    s_sub_u32 s70, s64, 2
    s_and_b32 s70, s70, 3
    s_mul_i32 s70, s70, 36864
    v_add_u32 v195, s70, v6
    s_sub_u32 s70, s64, 3
    s_and_b32 s70, s70, 3
    s_mul_i32 s70, s70, 36864
    v_add_u32 v196, s70, v6
    v_mov_b32 v8, 0
    v_mov_b32 v9, 0
    v_mov_b32 v10, 0
    v_mov_b32 v11, 0
    v_mov_b32 v12, 0
    v_mov_b32 v13, 0
    v_mov_b32 v14, 0
    v_mov_b32 v15, 0
    v_mov_b32 v16, 0
    v_mov_b32 v17, 0
    v_mov_b32 v18, 0
    v_mov_b32 v19, 0
    v_mov_b32 v20, 0
    v_mov_b32 v21, 0
    v_mov_b32 v22, 0
    v_mov_b32 v23, 0
    v_mov_b32 v24, 0
    v_mov_b32 v25, 0
    v_mov_b32 v26, 0
    v_mov_b32 v27, 0
    v_mov_b32 v28, 0
    v_mov_b32 v29, 0
    v_mov_b32 v30, 0
    v_mov_b32 v31, 0
    v_mov_b32 v32, 0
    v_mov_b32 v33, 0
    v_mov_b32 v34, 0
    v_mov_b32 v35, 0
    v_mov_b32 v36, 0
    v_mov_b32 v37, 0
    v_mov_b32 v38, 0
    v_mov_b32 v39, 0
    v_mov_b32 v40, 0
    v_mov_b32 v41, 0
    v_mov_b32 v42, 0
    v_mov_b32 v43, 0
    v_mov_b32 v44, 0
    v_mov_b32 v45, 0
    v_mov_b32 v46, 0
    v_mov_b32 v47, 0
    v_mov_b32 v48, 0
    v_mov_b32 v49, 0
    v_mov_b32 v50, 0
    v_mov_b32 v51, 0
    v_mov_b32 v52, 0
    v_mov_b32 v53, 0
    v_mov_b32 v54, 0
    v_mov_b32 v55, 0
    v_mov_b32 v56, 0
    v_mov_b32 v57, 0
    v_mov_b32 v58, 0
    v_mov_b32 v59, 0
    v_mov_b32 v60, 0
    v_mov_b32 v61, 0
    v_mov_b32 v62, 0
    v_mov_b32 v63, 0
    v_mov_b32 v64, 0
    v_mov_b32 v65, 0
    v_mov_b32 v66, 0
    v_mov_b32 v67, 0
    v_mov_b32 v68, 0
    v_mov_b32 v69, 0
    v_mov_b32 v70, 0
    v_mov_b32 v71, 0
    v_mov_b32 v72, 0
    v_mov_b32 v73, 0
    v_mov_b32 v74, 0
    v_mov_b32 v75, 0
    v_mov_b32 v76, 0
    v_mov_b32 v77, 0
    v_mov_b32 v78, 0
    v_mov_b32 v79, 0
    v_mov_b32 v80, 0
    v_mov_b32 v81, 0
    v_mov_b32 v82, 0
    v_mov_b32 v83, 0
    v_mov_b32 v84, 0
    v_mov_b32 v85, 0
    v_mov_b32 v86, 0
    v_mov_b32 v87, 0
k4k4_loop6:
    s_cmp_ge_u32 s68, 2
    s_cbranch_scc1 k4k4_wa8
    s_waitcnt vmcnt(0)
k4k4_wa8:
    s_waitcnt vmcnt(18)
    ds_read_b128 v[128:131], v160 offset:10240
    ds_read_b128 v[88:91], v160 offset:0
    ds_read_b128 v[132:135], v160 offset:12288
    ds_read_b128 v[92:95], v160 offset:2048
    ds_read_b128 v[136:139], v160 offset:14336
    ds_read_b128 v[96:99], v160 offset:4096
    ds_read_b128 v[140:143], v160 offset:16384
    ds_read_b128 v[100:103], v160 offset:6144
    ds_read_b128 v[104:107], v160 offset:8192
    s_waitcnt lgkmcnt(0)
    v_mfma_f32_16x16x32_bf16 v[8:11], v[88:91], v[128:131], v[8:11]
    ds_read_b128 v[144:147], v161 offset:10240
    v_mfma_f32_16x16x32_bf16 v[12:15], v[88:91], v[132:135], v[12:15]
    ds_read_b128 v[108:111], v161 offset:0
    v_mfma_f32_16x16x32_bf16 v[16:19], v[88:91], v[136:139], v[16:19]
    ds_read_b128 v[148:151], v161 offset:12288
    v_mfma_f32_16x16x32_bf16 v[20:23], v[88:91], v[140:143], v[20:23]
    ds_read_b128 v[112:115], v161 offset:2048
    v_mfma_f32_16x16x32_bf16 v[24:27], v[92:95], v[128:131], v[24:27]
    ds_read_b128 v[152:155], v161 offset:14336
    v_mfma_f32_16x16x32_bf16 v[28:31], v[92:95], v[132:135], v[28:31]
    ds_read_b128 v[116:119], v161 offset:4096
    v_mfma_f32_16x16x32_bf16 v[32:35], v[92:95], v[136:139], v[32:35]
    ds_read_b128 v[156:159], v161 offset:16384
    v_mfma_f32_16x16x32_bf16 v[36:39], v[92:95], v[140:143], v[36:39]
    ds_read_b128 v[120:123], v161 offset:6144
    v_mfma_f32_16x16x32_bf16 v[40:43], v[96:99], v[128:131], v[40:43]
    ds_read_b128 v[124:127], v161 offset:8192
    v_mfma_f32_16x16x32_bf16 v[44:47], v[96:99], v[132:135], v[44:47]
    v_mfma_f32_16x16x32_bf16 v[48:51], v[96:99], v[136:139], v[48:51]
    v_mfma_f32_16x16x32_bf16 v[52:55], v[96:99], v[140:143], v[52:55]
    v_mfma_f32_16x16x32_bf16 v[56:59], v[100:103], v[128:131], v[56:59]
    v_mfma_f32_16x16x32_bf16 v[60:63], v[100:103], v[132:135], v[60:63]
    v_mfma_f32_16x16x32_bf16 v[64:67], v[100:103], v[136:139], v[64:67]
    v_mfma_f32_16x16x32_bf16 v[68:71], v[100:103], v[140:143], v[68:71]
    v_mfma_f32_16x16x32_bf16 v[72:75], v[104:107], v[128:131], v[72:75]
    v_mfma_f32_16x16x32_bf16 v[76:79], v[104:107], v[132:135], v[76:79]
    v_mfma_f32_16x16x32_bf16 v[80:83], v[104:107], v[136:139], v[80:83]
    v_mfma_f32_16x16x32_bf16 v[84:87], v[104:107], v[140:143], v[84:87]
    s_waitcnt lgkmcnt(0)
    s_cmp_ge_u32 s68, 3
    s_cbranch_scc0 k4k4_nodma9
    s_add_u32 m0, s69, 0x0
    v_mfma_f32_16x16x32_bf16 v[8:11], v[108:111], v[144:147], v[8:11]
    buffer_load_dwordx4 v162, s[40:43], s67 offen lds
    s_add_u32 m0, s69, 0x400
    v_mfma_f32_16x16x32_bf16 v[12:15], v[108:111], v[148:151], v[12:15]
    buffer_load_dwordx4 v163, s[40:43], s67 offen lds
    s_add_u32 m0, s69, 0x800
    v_mfma_f32_16x16x32_bf16 v[16:19], v[108:111], v[152:155], v[16:19]
    buffer_load_dwordx4 v164, s[40:43], s67 offen lds
    s_add_u32 m0, s69, 0xc00
    v_mfma_f32_16x16x32_bf16 v[20:23], v[108:111], v[156:159], v[20:23]
    buffer_load_dwordx4 v165, s[40:43], s67 offen lds
    s_add_u32 m0, s69, 0x1000
    v_mfma_f32_16x16x32_bf16 v[24:27], v[112:115], v[144:147], v[24:27]
    buffer_load_dwordx4 v166, s[40:43], s67 offen lds
    s_add_u32 m0, s69, 0x1400
    v_mfma_f32_16x16x32_bf16 v[28:31], v[112:115], v[148:151], v[28:31]
    buffer_load_dwordx4 v167, s[40:43], s67 offen lds
    s_add_u32 m0, s69, 0x1800
    v_mfma_f32_16x16x32_bf16 v[32:35], v[112:115], v[152:155], v[32:35]
    buffer_load_dwordx4 v168, s[40:43], s67 offen lds
    s_add_u32 m0, s69, 0x1c00
    v_mfma_f32_16x16x32_bf16 v[36:39], v[112:115], v[156:159], v[36:39]
    buffer_load_dwordx4 v169, s[40:43], s67 offen lds
    s_add_u32 m0, s69, 0x2000
    v_mfma_f32_16x16x32_bf16 v[40:43], v[116:119], v[144:147], v[40:43]
    buffer_load_dwordx4 v170, s[40:43], s67 offen lds
    s_add_u32 m0, s69, 0x2400
    v_mfma_f32_16x16x32_bf16 v[44:47], v[116:119], v[148:151], v[44:47]
    buffer_load_dwordx4 v171, s[40:43], s67 offen lds
    s_add_u32 m0, s69, 0x2800
    v_mfma_f32_16x16x32_bf16 v[48:51], v[116:119], v[152:155], v[48:51]
    buffer_load_dwordx4 v172, s[44:47], s67 offen lds
    s_add_u32 m0, s69, 0x2c00
    v_mfma_f32_16x16x32_bf16 v[52:55], v[116:119], v[156:159], v[52:55]
    buffer_load_dwordx4 v173, s[44:47], s67 offen lds
    s_add_u32 m0, s69, 0x3000
    v_mfma_f32_16x16x32_bf16 v[56:59], v[120:123], v[144:147], v[56:59]
    buffer_load_dwordx4 v174, s[44:47], s67 offen lds
    s_add_u32 m0, s69, 0x3400
    v_mfma_f32_16x16x32_bf16 v[60:63], v[120:123], v[148:151], v[60:63]
    buffer_load_dwordx4 v175, s[44:47], s67 offen lds
    s_add_u32 m0, s69, 0x3800
    v_mfma_f32_16x16x32_bf16 v[64:67], v[120:123], v[152:155], v[64:67]
    buffer_load_dwordx4 v176, s[44:47], s67 offen lds
    s_add_u32 m0, s69, 0x3c00
    v_mfma_f32_16x16x32_bf16 v[68:71], v[120:123], v[156:159], v[68:71]
    buffer_load_dwordx4 v177, s[44:47], s67 offen lds
    s_add_u32 m0, s69, 0x4000
    v_mfma_f32_16x16x32_bf16 v[72:75], v[124:127], v[144:147], v[72:75]
    buffer_load_dwordx4 v178, s[44:47], s67 offen lds
    s_add_u32 m0, s69, 0x4400
    v_mfma_f32_16x16x32_bf16 v[76:79], v[124:127], v[148:151], v[76:79]
    buffer_load_dwordx4 v179, s[44:47], s67 offen lds
    s_add_u32 s67, s67, 128
    v_mfma_f32_16x16x32_bf16 v[80:83], v[124:127], v[152:155], v[80:83]
    v_mfma_f32_16x16x32_bf16 v[84:87], v[124:127], v[156:159], v[84:87]
    s_branch k4k4_join10
k4k4_nodma9:
    v_mfma_f32_16x16x32_bf16 v[8:11], v[108:111], v[144:147], v[8:11]
    v_mfma_f32_16x16x32_bf16 v[12:15], v[108:111], v[148:151], v[12:15]
    v_mfma_f32_16x16x32_bf16 v[16:19], v[108:111], v[152:155], v[16:19]
    v_mfma_f32_16x16x32_bf16 v[20:23], v[108:111], v[156:159], v[20:23]
    v_mfma_f32_16x16x32_bf16 v[24:27], v[112:115], v[144:147], v[24:27]
    v_mfma_f32_16x16x32_bf16 v[28:31], v[112:115], v[148:151], v[28:31]
    v_mfma_f32_16x16x32_bf16 v[32:35], v[112:115], v[152:155], v[32:35]
    v_mfma_f32_16x16x32_bf16 v[36:39], v[112:115], v[156:159], v[36:39]
    v_mfma_f32_16x16x32_bf16 v[40:43], v[116:119], v[144:147], v[40:43]
    v_mfma_f32_16x16x32_bf16 v[44:47], v[116:119], v[148:151], v[44:47]
    v_mfma_f32_16x16x32_bf16 v[48:51], v[116:119], v[152:155], v[48:51]
    v_mfma_f32_16x16x32_bf16 v[52:55], v[116:119], v[156:159], v[52:55]
    v_mfma_f32_16x16x32_bf16 v[56:59], v[120:123], v[144:147], v[56:59]
    v_mfma_f32_16x16x32_bf16 v[60:63], v[120:123], v[148:151], v[60:63]
    v_mfma_f32_16x16x32_bf16 v[64:67], v[120:123], v[152:155], v[64:67]
    v_mfma_f32_16x16x32_bf16 v[68:71], v[120:123], v[156:159], v[68:71]
    v_mfma_f32_16x16x32_bf16 v[72:75], v[124:127], v[144:147], v[72:75]
    v_mfma_f32_16x16x32_bf16 v[76:79], v[124:127], v[148:151], v[76:79]
    v_mfma_f32_16x16x32_bf16 v[80:83], v[124:127], v[152:155], v[80:83]
    v_mfma_f32_16x16x32_bf16 v[84:87], v[124:127], v[156:159], v[84:87]
k4k4_join10:
    s_sub_u32 s68, s68, 1
    s_cmp_eq_u32 s68, 0
    s_cbranch_scc1 k4k4_done7
    s_cmp_ge_u32 s68, 2
    s_cbranch_scc1 k4k4_wa11
    s_waitcnt vmcnt(0)
k4k4_wa11:
    s_waitcnt vmcnt(18)
    ds_read_b128 v[128:131], v160 offset:28672
    ds_read_b128 v[88:91], v160 offset:18432
    ds_read_b128 v[132:135], v160 offset:30720
    ds_read_b128 v[92:95], v160 offset:20480
    ds_read_b128 v[136:139], v160 offset:32768
    ds_read_b128 v[96:99], v160 offset:22528
    ds_read_b128 v[140:143], v160 offset:34816
    ds_read_b128 v[100:103], v160 offset:24576
    ds_read_b128 v[104:107], v160 offset:26624
    s_waitcnt lgkmcnt(0)
    v_mfma_f32_16x16x32_bf16 v[8:11], v[88:91], v[128:131], v[8:11]
    ds_read_b128 v[144:147], v161 offset:28672
    v_mfma_f32_16x16x32_bf16 v[12:15], v[88:91], v[132:135], v[12:15]
    ds_read_b128 v[108:111], v161 offset:18432
    v_mfma_f32_16x16x32_bf16 v[16:19], v[88:91], v[136:139], v[16:19]
    ds_read_b128 v[148:151], v161 offset:30720
    v_mfma_f32_16x16x32_bf16 v[20:23], v[88:91], v[140:143], v[20:23]
    ds_read_b128 v[112:115], v161 offset:20480
    v_mfma_f32_16x16x32_bf16 v[24:27], v[92:95], v[128:131], v[24:27]
    ds_read_b128 v[152:155], v161 offset:32768
    v_mfma_f32_16x16x32_bf16 v[28:31], v[92:95], v[132:135], v[28:31]
    ds_read_b128 v[116:119], v161 offset:22528
    v_mfma_f32_16x16x32_bf16 v[32:35], v[92:95], v[136:139], v[32:35]
    ds_read_b128 v[156:159], v161 offset:34816
    v_mfma_f32_16x16x32_bf16 v[36:39], v[92:95], v[140:143], v[36:39]
    ds_read_b128 v[120:123], v161 offset:24576
    v_mfma_f32_16x16x32_bf16 v[40:43], v[96:99], v[128:131], v[40:43]
    ds_read_b128 v[124:127], v161 offset:26624
    v_mfma_f32_16x16x32_bf16 v[44:47], v[96:99], v[132:135], v[44:47]
    v_mfma_f32_16x16x32_bf16 v[48:51], v[96:99], v[136:139], v[48:51]
    v_mfma_f32_16x16x32_bf16 v[52:55], v[96:99], v[140:143], v[52:55]
    v_mfma_f32_16x16x32_bf16 v[56:59], v[100:103], v[128:131], v[56:59]
    v_mfma_f32_16x16x32_bf16 v[60:63], v[100:103], v[132:135], v[60:63]
    v_mfma_f32_16x16x32_bf16 v[64:67], v[100:103], v[136:139], v[64:67]
    v_mfma_f32_16x16x32_bf16 v[68:71], v[100:103], v[140:143], v[68:71]
    v_mfma_f32_16x16x32_bf16 v[72:75], v[104:107], v[128:131], v[72:75]
    v_mfma_f32_16x16x32_bf16 v[76:79], v[104:107], v[132:135], v[76:79]
    v_mfma_f32_16x16x32_bf16 v[80:83], v[104:107], v[136:139], v[80:83]
    v_mfma_f32_16x16x32_bf16 v[84:87], v[104:107], v[140:143], v[84:87]
    s_waitcnt lgkmcnt(0)
    s_cmp_ge_u32 s68, 3
    s_cbranch_scc0 k4k4_nodma12
    s_add_u32 m0, s69, 0x4800
    v_mfma_f32_16x16x32_bf16 v[8:11], v[108:111], v[144:147], v[8:11]
    buffer_load_dwordx4 v162, s[40:43], s67 offen lds
    s_add_u32 m0, s69, 0x4c00
    v_mfma_f32_16x16x32_bf16 v[12:15], v[108:111], v[148:151], v[12:15]
    buffer_load_dwordx4 v163, s[40:43], s67 offen lds
    s_add_u32 m0, s69, 0x5000
    v_mfma_f32_16x16x32_bf16 v[16:19], v[108:111], v[152:155], v[16:19]
    buffer_load_dwordx4 v164, s[40:43], s67 offen lds
    s_add_u32 m0, s69, 0x5400
    v_mfma_f32_16x16x32_bf16 v[20:23], v[108:111], v[156:159], v[20:23]
    buffer_load_dwordx4 v165, s[40:43], s67 offen lds
    s_add_u32 m0, s69, 0x5800
    v_mfma_f32_16x16x32_bf16 v[24:27], v[112:115], v[144:147], v[24:27]
    buffer_load_dwordx4 v166, s[40:43], s67 offen lds
    s_add_u32 m0, s69, 0x5c00
    v_mfma_f32_16x16x32_bf16 v[28:31], v[112:115], v[148:151], v[28:31]
    buffer_load_dwordx4 v167, s[40:43], s67 offen lds
    s_add_u32 m0, s69, 0x6000
    v_mfma_f32_16x16x32_bf16 v[32:35], v[112:115], v[152:155], v[32:35]
    buffer_load_dwordx4 v168, s[40:43], s67 offen lds
    s_add_u32 m0, s69, 0x6400
    v_mfma_f32_16x16x32_bf16 v[36:39], v[112:115], v[156:159], v[36:39]
    buffer_load_dwordx4 v169, s[40:43], s67 offen lds
    s_add_u32 m0, s69, 0x6800
    v_mfma_f32_16x16x32_bf16 v[40:43], v[116:119], v[144:147], v[40:43]
    buffer_load_dwordx4 v170, s[40:43], s67 offen lds
    s_add_u32 m0, s69, 0x6c00
    v_mfma_f32_16x16x32_bf16 v[44:47], v[116:119], v[148:151], v[44:47]
    buffer_load_dwordx4 v171, s[40:43], s67 offen lds
    s_add_u32 m0, s69, 0x7000
    v_mfma_f32_16x16x32_bf16 v[48:51], v[116:119], v[152:155], v[48:51]
    buffer_load_dwordx4 v172, s[44:47], s67 offen lds
    s_add_u32 m0, s69, 0x7400
    v_mfma_f32_16x16x32_bf16 v[52:55], v[116:119], v[156:159], v[52:55]
    buffer_load_dwordx4 v173, s[44:47], s67 offen lds
    s_add_u32 m0, s69, 0x7800
    v_mfma_f32_16x16x32_bf16 v[56:59], v[120:123], v[144:147], v[56:59]
    buffer_load_dwordx4 v174, s[44:47], s67 offen lds
    s_add_u32 m0, s69, 0x7c00
    v_mfma_f32_16x16x32_bf16 v[60:63], v[120:123], v[148:151], v[60:63]
    buffer_load_dwordx4 v175, s[44:47], s67 offen lds
    s_add_u32 m0, s69, 0x8000
    v_mfma_f32_16x16x32_bf16 v[64:67], v[120:123], v[152:155], v[64:67]
    buffer_load_dwordx4 v176, s[44:47], s67 offen lds
    s_add_u32 m0, s69, 0x8400
    v_mfma_f32_16x16x32_bf16 v[68:71], v[120:123], v[156:159], v[68:71]
    buffer_load_dwordx4 v177, s[44:47], s67 offen lds
    s_add_u32 m0, s69, 0x8800
    v_mfma_f32_16x16x32_bf16 v[72:75], v[124:127], v[144:147], v[72:75]
    buffer_load_dwordx4 v178, s[44:47], s67 offen lds
    s_add_u32 m0, s69, 0x8c00
    v_mfma_f32_16x16x32_bf16 v[76:79], v[124:127], v[148:151], v[76:79]
    buffer_load_dwordx4 v179, s[44:47], s67 offen lds
    s_add_u32 s67, s67, 128
    v_mfma_f32_16x16x32_bf16 v[80:83], v[124:127], v[152:155], v[80:83]
    v_mfma_f32_16x16x32_bf16 v[84:87], v[124:127], v[156:159], v[84:87]
    s_branch k4k4_join13
k4k4_nodma12:
    v_mfma_f32_16x16x32_bf16 v[8:11], v[108:111], v[144:147], v[8:11]
    v_mfma_f32_16x16x32_bf16 v[12:15], v[108:111], v[148:151], v[12:15]
    v_mfma_f32_16x16x32_bf16 v[16:19], v[108:111], v[152:155], v[16:19]
    v_mfma_f32_16x16x32_bf16 v[20:23], v[108:111], v[156:159], v[20:23]
    v_mfma_f32_16x16x32_bf16 v[24:27], v[112:115], v[144:147], v[24:27]
    v_mfma_f32_16x16x32_bf16 v[28:31], v[112:115], v[148:151], v[28:31]
    v_mfma_f32_16x16x32_bf16 v[32:35], v[112:115], v[152:155], v[32:35]
    v_mfma_f32_16x16x32_bf16 v[36:39], v[112:115], v[156:159], v[36:39]
    v_mfma_f32_16x16x32_bf16 v[40:43], v[116:119], v[144:147], v[40:43]
    v_mfma_f32_16x16x32_bf16 v[44:47], v[116:119], v[148:151], v[44:47]
    v_mfma_f32_16x16x32_bf16 v[48:51], v[116:119], v[152:155], v[48:51]
    v_mfma_f32_16x16x32_bf16 v[52:55], v[116:119], v[156:159], v[52:55]
    v_mfma_f32_16x16x32_bf16 v[56:59], v[120:123], v[144:147], v[56:59]
    v_mfma_f32_16x16x32_bf16 v[60:63], v[120:123], v[148:151], v[60:63]
    v_mfma_f32_16x16x32_bf16 v[64:67], v[120:123], v[152:155], v[64:67]
    v_mfma_f32_16x16x32_bf16 v[68:71], v[120:123], v[156:159], v[68:71]
    v_mfma_f32_16x16x32_bf16 v[72:75], v[124:127], v[144:147], v[72:75]
    v_mfma_f32_16x16x32_bf16 v[76:79], v[124:127], v[148:151], v[76:79]
    v_mfma_f32_16x16x32_bf16 v[80:83], v[124:127], v[152:155], v[80:83]
    v_mfma_f32_16x16x32_bf16 v[84:87], v[124:127], v[156:159], v[84:87]
k4k4_join13:
    s_sub_u32 s68, s68, 1
    s_cmp_eq_u32 s68, 0
    s_cbranch_scc0 k4k4_loop6
k4k4_done7:
    s_nop 7
    s_nop 7
k4k4_epi4:
    ds_write_b128 v193, v[12:15] offset:5120
    ds_write_b128 v193, v[28:31] offset:6144
    ds_write_b128 v193, v[44:47] offset:7168
    ds_write_b128 v193, v[60:63] offset:8192
    ds_write_b128 v193, v[76:79] offset:9216
    ds_write_b128 v193, v[16:19] offset:10240
    ds_write_b128 v193, v[32:35] offset:11264
    ds_write_b128 v193, v[48:51] offset:12288
    ds_write_b128 v193, v[64:67] offset:13312
    ds_write_b128 v193, v[80:83] offset:14336
    ds_write_b128 v193, v[20:23] offset:15360
    ds_write_b128 v193, v[36:39] offset:16384
    ds_write_b128 v193, v[52:55] offset:17408
    ds_write_b128 v193, v[68:71] offset:18432
    ds_write_b128 v193, v[84:87] offset:19456
    s_waitcnt lgkmcnt(0)
    s_barrier
    ds_read_b128 v[88:91], v194 offset:5120
    ds_read_b128 v[92:95], v194 offset:6144
    ds_read_b128 v[96:99], v194 offset:7168
    ds_read_b128 v[100:103], v194 offset:8192
    ds_read_b128 v[104:107], v194 offset:9216
    ds_read_b128 v[108:111], v195 offset:10240
    ds_read_b128 v[112:115], v195 offset:11264
    ds_read_b128 v[116:119], v195 offset:12288
    ds_read_b128 v[120:123], v195 offset:13312
    ds_read_b128 v[124:127], v195 offset:14336
    ds_read_b128 v[128:131], v196 offset:15360
    ds_read_b128 v[132:135], v196 offset:16384
    ds_read_b128 v[136:139], v196 offset:17408
    ds_read_b128 v[140:143], v196 offset:18432
    ds_read_b128 v[144:147], v196 offset:19456
    s_waitcnt lgkmcnt(14)
    v_pk_add_f32 v[8:9], v[8:9], v[88:89]
    v_pk_add_f32 v[10:11], v[10:11], v[90:91]
    s_waitcnt lgkmcnt(13)
    v_pk_add_f32 v[24:25], v[24:25], v[92:93]
    v_pk_add_f32 v[26:27], v[26:27], v[94:95]
    s_waitcnt lgkmcnt(12)
    v_pk_add_f32 v[40:41], v[40:41], v[96:97]
    v_pk_add_f32 v[42:43], v[42:43], v[98:99]
    s_waitcnt lgkmcnt(11)
    v_pk_add_f32 v[56:57], v[56:57], v[100:101]
    v_pk_add_f32 v[58:59], v[58:59], v[102:103]
    s_waitcnt lgkmcnt(10)
    v_pk_add_f32 v[72:73], v[72:73], v[104:105]
    v_pk_add_f32 v[74:75], v[74:75], v[106:107]
    s_waitcnt lgkmcnt(9)
    v_pk_add_f32 v[8:9], v[8:9], v[108:109]
    v_pk_add_f32 v[10:11], v[10:11], v[110:111]
    s_waitcnt lgkmcnt(8)
    v_pk_add_f32 v[24:25], v[24:25], v[112:113]
    v_pk_add_f32 v[26:27], v[26:27], v[114:115]
    s_waitcnt lgkmcnt(7)
    v_pk_add_f32 v[40:41], v[40:41], v[116:117]
    v_pk_add_f32 v[42:43], v[42:43], v[118:119]
    s_waitcnt lgkmcnt(6)
    v_pk_add_f32 v[56:57], v[56:57], v[120:121]
    v_pk_add_f32 v[58:59], v[58:59], v[122:123]
    s_waitcnt lgkmcnt(5)
    v_pk_add_f32 v[72:73], v[72:73], v[124:125]
    v_pk_add_f32 v[74:75], v[74:75], v[126:127]
    s_waitcnt lgkmcnt(4)
    v_pk_add_f32 v[8:9], v[8:9], v[128:129]
    v_pk_add_f32 v[10:11], v[10:11], v[130:131]
    s_waitcnt lgkmcnt(3)
    v_pk_add_f32 v[24:25], v[24:25], v[132:133]
    v_pk_add_f32 v[26:27], v[26:27], v[134:135]
    s_waitcnt lgkmcnt(2)
    v_pk_add_f32 v[40:41], v[40:41], v[136:137]
    v_pk_add_f32 v[42:43], v[42:43], v[138:139]
    s_waitcnt lgkmcnt(1)
    v_pk_add_f32 v[56:57], v[56:57], v[140:141]
    v_pk_add_f32 v[58:59], v[58:59], v[142:143]
    s_waitcnt lgkmcnt(0)
    v_pk_add_f32 v[72:73], v[72:73], v[144:145]
    v_pk_add_f32 v[74:75], v[74:75], v[146:147]
    s_mov_b32 s70, 0xffff0000
    v_lshlrev_b32 v12, 16, v180
    v_and_b32 v13, s70, v180
    v_pk_add_f32 v[8:9], v[8:9], v[12:13]
    v_cvt_pk_bf16_f32 v88, v8, v9
    v_lshlrev_b32 v12, 16, v181
    v_and_b32 v13, s70, v181
    v_pk_add_f32 v[10:11], v[10:11], v[12:13]
    v_cvt_pk_bf16_f32 v89, v10, v11
    buffer_store_dwordx2 v[88:89], v190, s[52:55], 0 offen offset:0
    v_lshlrev_b32 v12, 16, v182
    v_and_b32 v13, s70, v182
    v_pk_add_f32 v[24:25], v[24:25], v[12:13]
    v_cvt_pk_bf16_f32 v90, v24, v25
    v_lshlrev_b32 v12, 16, v183
    v_and_b32 v13, s70, v183
    v_pk_add_f32 v[26:27], v[26:27], v[12:13]
    v_cvt_pk_bf16_f32 v91, v26, v27
    buffer_store_dwordx2 v[90:91], v190, s[52:55], 0 offen offset:32
    v_lshlrev_b32 v12, 16, v184
    v_and_b32 v13, s70, v184
    v_pk_add_f32 v[40:41], v[40:41], v[12:13]
    v_cvt_pk_bf16_f32 v92, v40, v41
    v_lshlrev_b32 v12, 16, v185
    v_and_b32 v13, s70, v185
    v_pk_add_f32 v[42:43], v[42:43], v[12:13]
    v_cvt_pk_bf16_f32 v93, v42, v43
    buffer_store_dwordx2 v[92:93], v190, s[52:55], 0 offen offset:64
    v_lshlrev_b32 v12, 16, v186
    v_and_b32 v13, s70, v186
    v_pk_add_f32 v[56:57], v[56:57], v[12:13]
    v_cvt_pk_bf16_f32 v94, v56, v57
    v_lshlrev_b32 v12, 16, v187
    v_and_b32 v13, s70, v187
    v_pk_add_f32 v[58:59], v[58:59], v[12:13]
    v_cvt_pk_bf16_f32 v95, v58, v59
    buffer_store_dwordx2 v[94:95], v190, s[52:55], 0 offen offset:96
    v_lshlrev_b32 v12, 16, v188
    v_and_b32 v13, s70, v188
    v_pk_add_f32 v[72:73], v[72:73], v[12:13]
    v_cvt_pk_bf16_f32 v96, v72, v73
    v_lshlrev_b32 v12, 16, v189
    v_and_b32 v13, s70, v189
    v_pk_add_f32 v[74:75], v[74:75], v[12:13]
    v_cvt_pk_bf16_f32 v97, v74, v75
    buffer_store_dwordx2 v[96:97], v190, s[52:55], 0 offen offset:128
k4k4_end1:
    s_endpgm
.section .rodata,"a"
.p2align 6
.amdhsa_kernel k4_kernel
  .amdhsa_next_free_vgpr 197
  .amdhsa_next_free_sgpr 102
  .amdhsa_accum_offset 200
  .amdhsa_group_segment_fixed_size 0
  .amdhsa_kernarg_size 96
  .amdhsa_user_sgpr_count 2
  .amdhsa_user_sgpr_kernarg_segment_ptr 1
  .amdhsa_system_sgpr_workgroup_id_x 1
.end_amdhsa_kernel
.text
.p2align 8
fnet_tbl:
.long 0x3f803f80, 0x3f803f80, 0x3f803f80, 0x3f803f80, 0x3f7b3f80, 0x3f553f6d, 0xbf7bbf80, 0xbf55bf6d
.long 0x3f6d3f80, 0x3ec43f35, 0x3f6d3f80, 0x3ec43f35, 0x3f553f80, 0xbe483ec4, 0xbf55bf80, 0x3e48bec4
.long 0x3f353f80, 0xbf35248d, 0x3f353f80, 0xbf35248d, 0x3f0e3f80, 0xbf7bbec4, 0xbf0ebf80, 0x3f7b3ec4
.long 0x3ec43f80, 0xbf6dbf35, 0x3ec43f80, 0xbf6dbf35, 0x3e483f80, 0xbf0ebf6d, 0xbe48bf80, 0x3f0e3f6d
.long 0x248d3f80, 0xa554bf80, 0x248d3f80, 0xa554bf80, 0xbe483f80, 0x3f0ebf6d, 0x3e48bf80, 0xbf0e3f6d
.long 0xbec43f80, 0x3f6dbf35, 0xbec43f80, 0x3f6dbf35, 0xbf0e3f80, 0x3f7bbec4, 0x3f0ebf80, 0xbf7b3ec4
.long 0xbf353f80, 0x3f35a554, 0xbf353f80, 0x3f35a554, 0xbf553f80, 0x3e483ec4, 0x3f55bf80, 0xbe48bec4
.long 0xbf6d3f80, 0xbec43f35, 0xbf6d3f80, 0xbec43f35, 0xbf7b3f80, 0xbf553f6d, 0x3f7bbf80, 0x3f55bf6d
.long 0x3f803f80, 0x3f803f80, 0x3f803f80, 0x3f803f80, 0x3f0e3f35, 0x3e483ec4, 0xbf0ebf35, 0xbe48bec4
.long 0xbec4248d, 0xbf6dbf35, 0xbec4248d, 0xbf6dbf35, 0xbf7bbf35, 0xbf0ebf6d, 0x3f7b3f35, 0x3f0e3f6d
.long 0xbf35bf80, 0x3f35a554, 0xbf35bf80, 0x3f35a554, 0x3e48bf35, 0x3f553f6d, 0xbe483f35, 0xbf55bf6d
.long 0x3f6da554, 0xbec43f35, 0x3f6da554, 0xbec43f35, 0x3f553f35, 0xbf7bbec4, 0xbf55bf35, 0x3f7b3ec4
.long 0x248d3f80, 0xa554bf80, 0x248d3f80, 0xa554bf80, 0xbf553f35, 0x3f7bbec4, 0x3f55bf35, 0xbf7b3ec4
.long 0xbf6d248d, 0x3ec43f35, 0xbf6d248d, 0x3ec43f35, 0xbe48bf35, 0xbf553f6d, 0x3e483f35, 0x3f55bf6d
.long 0x3f35bf80, 0xbf35248d, 0x3f35bf80, 0xbf35248d, 0x3f7bbf35, 0x3f0ebf6d, 0xbf7b3f35, 0xbf0e3f6d
.long 0x3ec4a554, 0x3f6dbf35, 0x3ec4a554, 0x3f6dbf35, 0xbf0e3f35, 0xbe483ec4, 0x3f0ebf35, 0x3e48bec4
.long 0x3f803f80, 0x3f803f80, 0x3f803f80, 0x3f803f80, 0xbe48248d, 0xbf0ebec4, 0x3e48a554, 0x3f0e3ec4
.long 0xbf6dbf80, 0xbec4bf35, 0xbf6dbf80, 0xbec4bf35, 0x3f0ea554, 0x3f7b3f6d, 0xbf0e248d, 0xbf7bbf6d
.long 0x3f353f80, 0xbf35248d, 0x3f353f80, 0xbf35248d, 0xbf55248d, 0xbe48bf6d, 0x3f55a554, 0x3e483f6d
.long 0xbec4bf80, 0x3f6d3f35, 0xbec4bf80, 0x3f6d3f35, 0x3f7ba554, 0xbf553ec4, 0xbf7b248d, 0x3f55bec4
.long 0x248d3f80, 0xa554bf80, 0x248d3f80, 0xa554bf80, 0xbf7b248d, 0x3f553ec4, 0x3f7ba554, 0xbf55bec4
.long 0x3ec4bf80, 0xbf6d3f35, 0x3ec4bf80, 0xbf6d3f35, 0x3f55a554, 0x3e48bf6d, 0xbf55248d, 0xbe483f6d
.long 0xbf353f80, 0x3f35a554, 0xbf353f80, 0x3f35a554, 0xbf0e248d, 0xbf7b3f6d, 0x3f0ea554, 0x3f7bbf6d
.long 0x3f6dbf80, 0x3ec4bf35, 0x3f6dbf80, 0x3ec4bf35, 0x3e48a554, 0x3f0ebec4, 0xbe48248d, 0xbf0e3ec4
.long 0x3f803f80, 0x3f803f80, 0x3f803f80, 0x3f803f80, 0xbf55bf35, 0xbf7bbf6d, 0x3f553f35, 0x3f7b3f6d
.long 0x3ec4a554, 0x3f6d3f35, 0x3ec4a554, 0x3f6d3f35, 0x3e483f35, 0xbf55bec4, 0xbe48bf35, 0x3f553ec4
.long 0xbf35bf80, 0x3f35a554, 0xbf35bf80, 0x3f35a554, 0x3f7b3f35, 0xbf0e3ec4, 0xbf7bbf35, 0x3f0ebec4
.long 0xbf6d248d, 0x3ec4bf35, 0xbf6d248d, 0x3ec4bf35, 0x3f0ebf35, 0xbe483f6d, 0xbf0e3f35, 0x3e48bf6d
.long 0x248d3f80, 0xa554bf80, 0x248d3f80, 0xa554bf80, 0xbf0ebf35, 0x3e483f6d, 0x3f0e3f35, 0xbe48bf6d
.long 0x3f6da554, 0xbec4bf35, 0x3f6da554, 0xbec4bf35, 0xbf7b3f35, 0x3f0e3ec4, 0x3f7bbf35, 0xbf0ebec4
.long 0x3f35bf80, 0xbf35248d, 0x3f35bf80, 0xbf35248d, 0xbe483f35, 0x3f55bec4, 0x3e48bf35, 0xbf553ec4
.long 0xbec4248d, 0xbf6d3f35, 0xbec4248d, 0xbf6d3f35, 0x3f55bf35, 0x3f7bbf6d, 0xbf553f35, 0xbf7b3f6d
.long 0xbf803f80, 0xbf803f80, 0xbf803f80, 0xbf803f80, 0xbf7b3f80, 0xbf553f6d, 0x3f7bbf80, 0x3f55bf6d
.long 0xbf6d3f80, 0xbec43f35, 0xbf6d3f80, 0xbec43f35, 0xbf553f80, 0x3e483ec4, 0x3f55bf80, 0xbe48bec4
.long 0xbf353f80, 0x3f35248d, 0xbf353f80, 0x3f35248d, 0xbf0e3f80, 0x3f7bbec4, 0x3f0ebf80, 0xbf7b3ec4
.long 0xbec43f80, 0x3f6dbf35, 0xbec43f80, 0x3f6dbf35, 0xbe483f80, 0x3f0ebf6d, 0x3e48bf80, 0xbf0e3f6d
.long 0xa5543f80, 0x248dbf80, 0xa5543f80, 0x248dbf80, 0x3e483f80, 0xbf0ebf6d, 0xbe48bf80, 0x3f0e3f6d
.long 0x3ec43f80, 0xbf6dbf35, 0x3ec43f80, 0xbf6dbf35, 0x3f0e3f80, 0xbf7bbec4, 0xbf0ebf80, 0x3f7b3ec4
.long 0x3f353f80, 0xbf35a554, 0x3f353f80, 0xbf35a554, 0x3f553f80, 0xbe483ec4, 0xbf55bf80, 0x3e48bec4
.long 0x3f6d3f80, 0x3ec43f35, 0x3f6d3f80, 0x3ec43f35, 0x3f7b3f80, 0x3f553f6d, 0xbf7bbf80, 0xbf55bf6d
.long 0xbf803f80, 0xbf803f80, 0xbf803f80, 0xbf803f80, 0xbf0e3f35, 0xbe483ec4, 0x3f0ebf35, 0x3e48bec4
.long 0x3ec4248d, 0x3f6dbf35, 0x3ec4248d, 0x3f6dbf35, 0x3f7bbf35, 0x3f0ebf6d, 0xbf7b3f35, 0xbf0e3f6d
.long 0x3f35bf80, 0xbf35a554, 0x3f35bf80, 0xbf35a554, 0xbe48bf35, 0xbf553f6d, 0x3e483f35, 0x3f55bf6d
.long 0xbf6da554, 0x3ec43f35, 0xbf6da554, 0x3ec43f35, 0xbf553f35, 0x3f7bbec4, 0x3f55bf35, 0xbf7b3ec4
.long 0xa5543f80, 0x248dbf80, 0xa5543f80, 0x248dbf80, 0x3f553f35, 0xbf7bbec4, 0xbf55bf35, 0x3f7b3ec4
.long 0x3f6d248d, 0xbec43f35, 0x3f6d248d, 0xbec43f35, 0x3e48bf35, 0x3f553f6d, 0xbe483f35, 0xbf55bf6d
.long 0xbf35bf80, 0x3f35248d, 0xbf35bf80, 0x3f35248d, 0xbf7bbf35, 0xbf0ebf6d, 0x3f7b3f35, 0x3f0e3f6d
.long 0xbec4a554, 0xbf6dbf35, 0xbec4a554, 0xbf6dbf35, 0x3f0e3f35, 0x3e483ec4, 0xbf0ebf35, 0xbe48bec4
.long 0xbf803f80, 0xbf803f80, 0xbf803f80, 0xbf803f80, 0x3e48248d, 0x3f0ebec4, 0xbe48a554, 0xbf0e3ec4
.long 0x3f6dbf80, 0x3ec4bf35, 0x3f6dbf80, 0x3ec4bf35, 0xbf0ea554, 0xbf7b3f6d, 0x3f0e248d, 0x3f7bbf6d
.long 0xbf353f80, 0x3f35248d, 0xbf353f80, 0x3f35248d, 0x3f55248d, 0x3e48bf6d, 0xbf55a554, 0xbe483f6d
.long 0x3ec4bf80, 0xbf6d3f35, 0x3ec4bf80, 0xbf6d3f35, 0xbf7ba554, 0x3f553ec4, 0x3f7b248d, 0xbf55bec4
.long 0xa5543f80, 0x248dbf80, 0xa5543f80, 0x248dbf80, 0x3f7b248d, 0xbf553ec4, 0xbf7ba554, 0x3f55bec4
.long 0xbec4bf80, 0x3f6d3f35, 0xbec4bf80, 0x3f6d3f35, 0xbf55a554, 0xbe48bf6d, 0x3f55248d, 0x3e483f6d
.long 0x3f353f80, 0xbf35a554, 0x3f353f80, 0xbf35a554, 0x3f0e248d, 0x3f7b3f6d, 0xbf0ea554, 0xbf7bbf6d
.long 0xbf6dbf80, 0xbec4bf35, 0xbf6dbf80, 0xbec4bf35, 0xbe48a554, 0xbf0ebec4, 0x3e48248d, 0x3f0e3ec4
.long 0xbf803f80, 0xbf803f80, 0xbf803f80, 0xbf803f80, 0x3f55bf35, 0x3f7bbf6d, 0xbf553f35, 0xbf7b3f6d
.long 0xbec4a554, 0xbf6d3f35, 0xbec4a554, 0xbf6d3f35, 0xbe483f35, 0x3f55bec4, 0x3e48bf35, 0xbf553ec4
.long 0x3f35bf80, 0xbf35a554, 0x3f35bf80, 0xbf35a554, 0xbf7b3f35, 0x3f0e3ec4, 0x3f7bbf35, 0xbf0ebec4
.long 0x3f6d248d, 0xbec4bf35, 0x3f6d248d, 0xbec4bf35, 0xbf0ebf35, 0x3e483f6d, 0x3f0e3f35, 0xbe48bf6d
.long 0xa5543f80, 0x248dbf80, 0xa5543f80, 0x248dbf80, 0x3f0ebf35, 0xbe483f6d, 0xbf0e3f35, 0x3e48bf6d
.long 0xbf6da554, 0x3ec4bf35, 0xbf6da554, 0x3ec4bf35, 0x3f7b3f35, 0xbf0e3ec4, 0xbf7bbf35, 0x3f0ebec4
.long 0xbf35bf80, 0x3f35248d, 0xbf35bf80, 0x3f35248d, 0x3e483f35, 0xbf55bec4, 0xbe48bf35, 0x3f553ec4
.long 0x3ec4248d, 0x3f6d3f35, 0x3ec4248d, 0x3f6d3f35, 0xbf55bf35, 0xbf7bbf6d, 0x3f553f35, 0x3f7b3f6d
.long 0x00000000, 0x00000000, 0x00000000, 0x00000000, 0x3e480000, 0x3f0e3ec4, 0xbe48250d, 0xbf0ebec4
.long 0x3ec40000, 0x3f6d3f35, 0x3ec40000, 0x3f6d3f35, 0x3f0e0000, 0x3f7b3f6d, 0xbf0e250d, 0xbf7bbf6d
.long 0x3f350000, 0x3f353f80, 0x3f350000, 0x3f353f80, 0x3f550000, 0x3e483f6d, 0xbf55250d, 0xbe48bf6d
.long 0x3f6d0000, 0xbec43f35, 0x3f6d0000, 0xbec43f35, 0x3f7b0000, 0xbf553ec4, 0xbf7b250d, 0x3f55bec4
.long 0x3f800000, 0xbf80250d, 0x3f800000, 0xbf80250d, 0x3f7b0000, 0xbf55bec4, 0xbf7b250d, 0x3f553ec4
.long 0x3f6d0000, 0xbec4bf35, 0x3f6d0000, 0xbec4bf35, 0x3f550000, 0x3e48bf6d, 0xbf55250d, 0xbe483f6d
.long 0x3f350000, 0x3f35bf80, 0x3f350000, 0x3f35bf80, 0x3f0e0000, 0x3f7bbf6d, 0xbf0e250d, 0xbf7b3f6d
.long 0x3ec40000, 0x3f6dbf35, 0x3ec40000, 0x3f6dbf35, 0x3e480000, 0x3f0ebec4, 0xbe48250d, 0xbf0e3ec4
.long 0x00000000, 0x00000000, 0x00000000, 0x00000000, 0x3f553f35, 0x3f7b3f6d, 0xbf55bf35, 0xbf7bbf6d
.long 0x3f6d3f80, 0x3ec43f35, 0x3f6d3f80, 0x3ec43f35, 0x3e483f35, 0xbf55bec4, 0xbe48bf35, 0x3f553ec4
.long 0xbf35250d, 0xbf35bf80, 0xbf35250d, 0xbf35bf80, 0xbf7bbf35, 0x3f0ebec4, 0x3f7b3f35, 0xbf0e3ec4
.long 0xbec4bf80, 0x3f6d3f35, 0xbec4bf80, 0x3f6d3f35, 0x3f0ebf35, 0xbe483f6d, 0xbf0e3f35, 0x3e48bf6d
.long 0x3f800000, 0xbf80250d, 0x3f800000, 0xbf80250d, 0x3f0e3f35, 0xbe48bf6d, 0xbf0ebf35, 0x3e483f6d
.long 0xbec43f80, 0x3f6dbf35, 0xbec43f80, 0x3f6dbf35, 0xbf7b3f35, 0x3f0e3ec4, 0x3f7bbf35, 0xbf0ebec4
.long 0xbf35250d, 0xbf353f80, 0xbf35250d, 0xbf353f80, 0x3e48bf35, 0xbf553ec4, 0xbe483f35, 0x3f55bec4
.long 0x3f6dbf80, 0x3ec4bf35, 0x3f6dbf80, 0x3ec4bf35, 0x3f55bf35, 0x3f7bbf6d, 0xbf553f35, 0xbf7b3f6d
.long 0x00000000, 0x00000000, 0x00000000, 0x00000000, 0x3f7b3f80, 0x3f553f6d, 0xbf7bbf80, 0xbf55bf6d
.long 0xbec4250d, 0xbf6dbf35, 0xbec4250d, 0xbf6dbf35, 0xbf55bf80, 0x3e48bec4, 0x3f553f80, 0xbe483ec4
.long 0x3f350000, 0x3f353f80, 0x3f350000, 0x3f353f80, 0x3f0e3f80, 0xbf7bbec4, 0xbf0ebf80, 0x3f7b3ec4
.long 0xbf6d250d, 0x3ec4bf35, 0xbf6d250d, 0x3ec4bf35, 0xbe48bf80, 0x3f0e3f6d, 0x3e483f80, 0xbf0ebf6d
.long 0x3f800000, 0xbf80250d, 0x3f800000, 0xbf80250d, 0xbe483f80, 0x3f0ebf6d, 0x3e48bf80, 0xbf0e3f6d
.long 0xbf6d250d, 0x3ec43f35, 0xbf6d250d, 0x3ec43f35, 0x3f0ebf80, 0xbf7b3ec4, 0xbf0e3f80, 0x3f7bbec4
.long 0x3f350000, 0x3f35bf80, 0x3f350000, 0x3f35bf80, 0xbf553f80, 0x3e483ec4, 0x3f55bf80, 0xbe48bec4
.long 0xbec4250d, 0xbf6d3f35, 0xbec4250d, 0xbf6d3f35, 0x3f7bbf80, 0x3f55bf6d, 0xbf7b3f80, 0xbf553f6d
.long 0x00000000, 0x00000000, 0x00000000, 0x00000000, 0x3f0e3f35, 0x3e483ec4, 0xbf0ebf35, 0xbe48bec4
.long 0xbf6dbf80, 0xbec4bf35, 0xbf6dbf80, 0xbec4bf35, 0x3f7b3f35, 0x3f0e3f6d, 0xbf7bbf35, 0xbf0ebf6d
.long 0xbf35250d, 0xbf35bf80, 0xbf35250d, 0xbf35bf80, 0x3e48bf35, 0x3f553f6d, 0xbe483f35, 0xbf55bf6d
.long 0x3ec43f80, 0xbf6dbf35, 0x3ec43f80, 0xbf6dbf35, 0xbf55bf35, 0x3f7b3ec4, 0x3f553f35, 0xbf7bbec4
.long 0x3f800000, 0xbf80250d, 0x3f800000, 0xbf80250d, 0xbf553f35, 0x3f7bbec4, 0x3f55bf35, 0xbf7b3ec4
.long 0x3ec4bf80, 0xbf6d3f35, 0x3ec4bf80, 0xbf6d3f35, 0x3e483f35, 0x3f55bf6d, 0xbe48bf35, 0xbf553f6d
.long 0xbf35250d, 0xbf353f80, 0xbf35250d, 0xbf353f80, 0x3f7bbf35, 0x3f0ebf6d, 0xbf7b3f35, 0xbf0e3f6d
.long 0xbf6d3f80, 0xbec43f35, 0xbf6d3f80, 0xbec43f35, 0x3f0ebf35, 0x3e48bec4, 0xbf0e3f35, 0xbe483ec4
.long 0x250d0000, 0x250d0000, 0x250d0000, 0x250d0000, 0xbe480000, 0xbf0e3ec4, 0x3e48250d, 0x3f0ebec4
.long 0xbec40000, 0xbf6d3f35, 0xbec40000, 0xbf6d3f35, 0xbf0e0000, 0xbf7b3f6d, 0x3f0e250d, 0x3f7bbf6d
.long 0xbf350000, 0xbf353f80, 0xbf350000, 0xbf353f80, 0xbf550000, 0xbe483f6d, 0x3f55250d, 0x3e48bf6d
.long 0xbf6d0000, 0x3ec43f35, 0xbf6d0000, 0x3ec43f35, 0xbf7b0000, 0x3f553ec4, 0x3f7b250d, 0xbf55bec4
.long 0xbf800000, 0x3f80250d, 0xbf800000, 0x3f80250d, 0xbf7b0000, 0x3f55bec4, 0x3f7b250d, 0xbf553ec4
.long 0xbf6d0000, 0x3ec4bf35, 0xbf6d0000, 0x3ec4bf35, 0xbf550000, 0xbe48bf6d, 0x3f55250d, 0x3e483f6d
.long 0xbf350000, 0xbf35bf80, 0xbf350000, 0xbf35bf80, 0xbf0e0000, 0xbf7bbf6d, 0x3f0e250d, 0x3f7b3f6d
.long 0xbec40000, 0xbf6dbf35, 0xbec40000, 0xbf6dbf35, 0xbe480000, 0xbf0ebec4, 0x3e48250d, 0x3f0e3ec4
.long 0x250d0000, 0x250d0000, 0x250d0000, 0x250d0000, 0xbf553f35, 0xbf7b3f6d, 0x3f55bf35, 0x3f7bbf6d
.long 0xbf6d3f80, 0xbec43f35, 0xbf6d3f80, 0xbec43f35, 0xbe483f35, 0x3f55bec4, 0x3e48bf35, 0xbf553ec4
.long 0x3f35250d, 0x3f35bf80, 0x3f35250d, 0x3f35bf80, 0x3f7bbf35, 0xbf0ebec4, 0xbf7b3f35, 0x3f0e3ec4
.long 0x3ec4bf80, 0xbf6d3f35, 0x3ec4bf80, 0xbf6d3f35, 0xbf0ebf35, 0x3e483f6d, 0x3f0e3f35, 0xbe48bf6d
.long 0xbf800000, 0x3f80250d, 0xbf800000, 0x3f80250d, 0xbf0e3f35, 0x3e48bf6d, 0x3f0ebf35, 0xbe483f6d
.long 0x3ec43f80, 0xbf6dbf35, 0x3ec43f80, 0xbf6dbf35, 0x3f7b3f35, 0xbf0e3ec4, 0xbf7bbf35, 0x3f0ebec4
.long 0x3f35250d, 0x3f353f80, 0x3f35250d, 0x3f353f80, 0xbe48bf35, 0x3f553ec4, 0x3e483f35, 0xbf55bec4
.long 0xbf6dbf80, 0xbec4bf35, 0xbf6dbf80, 0xbec4bf35, 0xbf55bf35, 0xbf7bbf6d, 0x3f553f35, 0x3f7b3f6d
.long 0x250d0000, 0x250d0000, 0x250d0000, 0x250d0000, 0xbf7b3f80, 0xbf553f6d, 0x3f7bbf80, 0x3f55bf6d
.long 0x3ec4250d, 0x3f6dbf35, 0x3ec4250d, 0x3f6dbf35, 0x3f55bf80, 0xbe48bec4, 0xbf553f80, 0x3e483ec4
.long 0xbf350000, 0xbf353f80, 0xbf350000, 0xbf353f80, 0xbf0e3f80, 0x3f7bbec4, 0x3f0ebf80, 0xbf7b3ec4
.long 0x3f6d250d, 0xbec4bf35, 0x3f6d250d, 0xbec4bf35, 0x3e48bf80, 0xbf0e3f6d, 0xbe483f80, 0x3f0ebf6d
.long 0xbf800000, 0x3f80250d, 0xbf800000, 0x3f80250d, 0x3e483f80, 0xbf0ebf6d, 0xbe48bf80, 0x3f0e3f6d
.long 0x3f6d250d, 0xbec43f35, 0x3f6d250d, 0xbec43f35, 0xbf0ebf80, 0x3f7b3ec4, 0x3f0e3f80, 0xbf7bbec4
.long 0xbf350000, 0xbf35bf80, 0xbf350000, 0xbf35bf80, 0x3f553f80, 0xbe483ec4, 0xbf55bf80, 0x3e48bec4
.long 0x3ec4250d, 0x3f6d3f35, 0x3ec4250d, 0x3f6d3f35, 0xbf7bbf80, 0xbf55bf6d, 0x3f7b3f80, 0x3f553f6d
.long 0x250d0000, 0x250d0000, 0x250d0000, 0x250d0000, 0xbf0e3f35, 0xbe483ec4, 0x3f0ebf35, 0x3e48bec4
.long 0x3f6dbf80, 0x3ec4bf35, 0x3f6dbf80, 0x3ec4bf35, 0xbf7b3f35, 0xbf0e3f6d, 0x3f7bbf35, 0x3f0ebf6d
.long 0x3f35250d, 0x3f35bf80, 0x3f35250d, 0x3f35bf80, 0xbe48bf35, 0xbf553f6d, 0x3e483f35, 0x3f55bf6d
.long 0xbec43f80, 0x3f6dbf35, 0xbec43f80, 0x3f6dbf35, 0x3f55bf35, 0xbf7b3ec4, 0xbf553f35, 0x3f7bbec4
.long 0xbf800000, 0x3f80250d, 0xbf800000, 0x3f80250d, 0x3f553f35, 0xbf7bbec4, 0xbf55bf35, 0x3f7b3ec4
.long 0xbec4bf80, 0x3f6d3f35, 0xbec4bf80, 0x3f6d3f35, 0xbe483f35, 0xbf55bf6d, 0x3e48bf35, 0x3f553f6d
.long 0x3f35250d, 0x3f353f80, 0x3f35250d, 0x3f353f80, 0xbf7bbf35, 0xbf0ebf6d, 0x3f7b3f35, 0x3f0e3f6d
.long 0x3f6d3f80, 0x3ec43f35, 0x3f6d3f80, 0x3ec43f35, 0xbf0ebf35, 0xbe48bec4, 0x3f0e3f35, 0x3e483ec4
.long 0x80008000, 0x80008000, 0x80008000, 0x80008000, 0xbe488000, 0xbf0ebec4, 0x3e48a50d, 0x3f0e3ec4
.long 0xbec48000, 0xbf6dbf35, 0xbec48000, 0xbf6dbf35, 0xbf0e8000, 0xbf7bbf6d, 0x3f0ea50d, 0x3f7b3f6d
.long 0xbf358000, 0xbf35bf80, 0xbf358000, 0xbf35bf80, 0xbf558000, 0xbe48bf6d, 0x3f55a50d, 0x3e483f6d
.long 0xbf6d8000, 0x3ec4bf35, 0xbf6d8000, 0x3ec4bf35, 0xbf7b8000, 0x3f55bec4, 0x3f7ba50d, 0xbf553ec4
.long 0xbf808000, 0x3f80a50d, 0xbf808000, 0x3f80a50d, 0xbf7b8000, 0x3f553ec4, 0x3f7ba50d, 0xbf55bec4
.long 0xbf6d8000, 0x3ec43f35, 0xbf6d8000, 0x3ec43f35, 0xbf558000, 0xbe483f6d, 0x3f55a50d, 0x3e48bf6d
.long 0xbf358000, 0xbf353f80, 0xbf358000, 0xbf353f80, 0xbf0e8000, 0xbf7b3f6d, 0x3f0ea50d, 0x3f7bbf6d
.long 0xbec48000, 0xbf6d3f35, 0xbec48000, 0xbf6d3f35, 0xbe488000, 0xbf0e3ec4, 0x3e48a50d, 0x3f0ebec4
.long 0x80008000, 0x80008000, 0x80008000, 0x80008000, 0xbf55bf35, 0xbf7bbf6d, 0x3f553f35, 0x3f7b3f6d
.long 0xbf6dbf80, 0xbec4bf35, 0xbf6dbf80, 0xbec4bf35, 0xbe48bf35, 0x3f553ec4, 0x3e483f35, 0xbf55bec4
.long 0x3f35a50d, 0x3f353f80, 0x3f35a50d, 0x3f353f80, 0x3f7b3f35, 0xbf0e3ec4, 0xbf7bbf35, 0x3f0ebec4
.long 0x3ec43f80, 0xbf6dbf35, 0x3ec43f80, 0xbf6dbf35, 0xbf0e3f35, 0x3e48bf6d, 0x3f0ebf35, 0xbe483f6d
.long 0xbf808000, 0x3f80a50d, 0xbf808000, 0x3f80a50d, 0xbf0ebf35, 0x3e483f6d, 0x3f0e3f35, 0xbe48bf6d
.long 0x3ec4bf80, 0xbf6d3f35, 0x3ec4bf80, 0xbf6d3f35, 0x3f7bbf35, 0xbf0ebec4, 0xbf7b3f35, 0x3f0e3ec4
.long 0x3f35a50d, 0x3f35bf80, 0x3f35a50d, 0x3f35bf80, 0xbe483f35, 0x3f55bec4, 0x3e48bf35, 0xbf553ec4
.long 0xbf6d3f80, 0xbec43f35, 0xbf6d3f80, 0xbec43f35, 0xbf553f35, 0xbf7b3f6d, 0x3f55bf35, 0x3f7bbf6d
.long 0x80008000, 0x80008000, 0x80008000, 0x80008000, 0xbf7bbf80, 0xbf55bf6d, 0x3f7b3f80, 0x3f553f6d
.long 0x3ec4a50d, 0x3f6d3f35, 0x3ec4a50d, 0x3f6d3f35, 0x3f553f80, 0xbe483ec4, 0xbf55bf80, 0x3e48bec4
.long 0xbf358000, 0xbf35bf80, 0xbf358000, 0xbf35bf80, 0xbf0ebf80, 0x3f7b3ec4, 0x3f0e3f80, 0xbf7bbec4
.long 0x3f6da50d, 0xbec43f35, 0x3f6da50d, 0xbec43f35, 0x3e483f80, 0xbf0ebf6d, 0xbe48bf80, 0x3f0e3f6d
.long 0xbf808000, 0x3f80a50d, 0xbf808000, 0x3f80a50d, 0x3e48bf80, 0xbf0e3f6d, 0xbe483f80, 0x3f0ebf6d
.long 0x3f6da50d, 0xbec4bf35, 0x3f6da50d, 0xbec4bf35, 0xbf0e3f80, 0x3f7bbec4, 0x3f0ebf80, 0xbf7b3ec4
.long 0xbf358000, 0xbf353f80, 0xbf358000, 0xbf353f80, 0x3f55bf80, 0xbe48bec4, 0xbf553f80, 0x3e483ec4
.long 0x3ec4a50d, 0x3f6dbf35, 0x3ec4a50d, 0x3f6dbf35, 0xbf7b3f80, 0xbf553f6d, 0x3f7bbf80, 0x3f55bf6d
.long 0x80008000, 0x80008000, 0x80008000, 0x80008000, 0xbf0ebf35, 0xbe48bec4, 0x3f0e3f35, 0x3e483ec4
.long 0x3f6d3f80, 0x3ec43f35, 0x3f6d3f80, 0x3ec43f35, 0xbf7bbf35, 0xbf0ebf6d, 0x3f7b3f35, 0x3f0e3f6d
.long 0x3f35a50d, 0x3f353f80, 0x3f35a50d, 0x3f353f80, 0xbe483f35, 0xbf55bf6d, 0x3e48bf35, 0x3f553f6d
.long 0xbec4bf80, 0x3f6d3f35, 0xbec4bf80, 0x3f6d3f35, 0x3f553f35, 0xbf7bbec4, 0xbf55bf35, 0x3f7b3ec4
.long 0xbf808000, 0x3f80a50d, 0xbf808000, 0x3f80a50d, 0x3f55bf35, 0xbf7b3ec4, 0xbf553f35, 0x3f7bbec4
.long 0xbec43f80, 0x3f6dbf35, 0xbec43f80, 0x3f6dbf35, 0xbe48bf35, 0xbf553f6d, 0x3e483f35, 0x3f55bf6d
.long 0x3f35a50d, 0x3f35bf80, 0x3f35a50d, 0x3f35bf80, 0xbf7b3f35, 0xbf0e3f6d, 0x3f7bbf35, 0x3f0ebf6d
.long 0x3f6dbf80, 0x3ec4bf35, 0x3f6dbf80, 0x3ec4bf35, 0xbf0e3f35, 0xbe483ec4, 0x3f0ebf35, 0x3e48bec4
.long 0xa50d8000, 0xa50d8000, 0xa50d8000, 0xa50d8000, 0x3e488000, 0x3f0ebec4, 0xbe48a50d, 0xbf0e3ec4
.long 0x3ec48000, 0x3f6dbf35, 0x3ec48000, 0x3f6dbf35, 0x3f0e8000, 0x3f7bbf6d, 0xbf0ea50d, 0xbf7b3f6d
.long 0x3f358000, 0x3f35bf80, 0x3f358000, 0x3f35bf80, 0x3f558000, 0x3e48bf6d, 0xbf55a50d, 0xbe483f6d
.long 0x3f6d8000, 0xbec4bf35, 0x3f6d8000, 0xbec4bf35, 0x3f7b8000, 0xbf55bec4, 0xbf7ba50d, 0x3f553ec4
.long 0x3f808000, 0xbf80a50d, 0x3f808000, 0xbf80a50d, 0x3f7b8000, 0xbf553ec4, 0xbf7ba50d, 0x3f55bec4
.long 0x3f6d8000, 0xbec43f35, 0x3f6d8000, 0xbec43f35, 0x3f558000, 0x3e483f6d, 0xbf55a50d, 0xbe48bf6d
.long 0x3f358000, 0x3f353f80, 0x3f358000, 0x3f353f80, 0x3f0e8000, 0x3f7b3f6d, 0xbf0ea50d, 0xbf7bbf6d
.long 0x3ec48000, 0x3f6d3f35, 0x3ec48000, 0x3f6d3f35, 0x3e488000, 0x3f0e3ec4, 0xbe48a50d, 0xbf0ebec4
.long 0xa50d8000, 0xa50d8000, 0xa50d8000, 0xa50d8000, 0x3f55bf35, 0x3f7bbf6d, 0xbf553f35, 0xbf7b3f6d
.long 0x3f6dbf80, 0x3ec4bf35, 0x3f6dbf80, 0x3ec4bf35, 0x3e48bf35, 0xbf553ec4, 0xbe483f35, 0x3f55bec4
.long 0xbf35a50d, 0xbf353f80, 0xbf35a50d, 0xbf353f80, 0xbf7b3f35, 0x3f0e3ec4, 0x3f7bbf35, 0xbf0ebec4
.long 0xbec43f80, 0x3f6dbf35, 0xbec43f80, 0x3f6dbf35, 0x3f0e3f35, 0xbe48bf6d, 0xbf0ebf35, 0x3e483f6d
.long 0x3f808000, 0xbf80a50d, 0x3f808000, 0xbf80a50d, 0x3f0ebf35, 0xbe483f6d, 0xbf0e3f35, 0x3e48bf6d
.long 0xbec4bf80, 0x3f6d3f35, 0xbec4bf80, 0x3f6d3f35, 0xbf7bbf35, 0x3f0ebec4, 0x3f7b3f35, 0xbf0e3ec4
.long 0xbf35a50d, 0xbf35bf80, 0xbf35a50d, 0xbf35bf80, 0x3e483f35, 0xbf55bec4, 0xbe48bf35, 0x3f553ec4
.long 0x3f6d3f80, 0x3ec43f35, 0x3f6d3f80, 0x3ec43f35, 0x3f553f35, 0x3f7b3f6d, 0xbf55bf35, 0xbf7bbf6d
.long 0xa50d8000, 0xa50d8000, 0xa50d8000, 0xa50d8000, 0x3f7bbf80, 0x3f55bf6d, 0xbf7b3f80, 0xbf553f6d
.long 0xbec4a50d, 0xbf6d3f35, 0xbec4a50d, 0xbf6d3f35, 0xbf553f80, 0x3e483ec4, 0x3f55bf80, 0xbe48bec4
.long 0x3f358000, 0x3f35bf80, 0x3f358000, 0x3f35bf80, 0x3f0ebf80, 0xbf7b3ec4, 0xbf0e3f80, 0x3f7bbec4
.long 0xbf6da50d, 0x3ec43f35, 0xbf6da50d, 0x3ec43f35, 0xbe483f80, 0x3f0ebf6d, 0x3e48bf80, 0xbf0e3f6d
.long 0x3f808000, 0xbf80a50d, 0x3f808000, 0xbf80a50d, 0xbe48bf80, 0x3f0e3f6d, 0x3e483f80, 0xbf0ebf6d
.long 0xbf6da50d, 0x3ec4bf35, 0xbf6da50d, 0x3ec4bf35, 0x3f0e3f80, 0xbf7bbec4, 0xbf0ebf80, 0x3f7b3ec4
.long 0x3f358000, 0x3f353f80, 0x3f358000, 0x3f353f80, 0xbf55bf80, 0x3e48bec4, 0x3f553f80, 0xbe483ec4
.long 0xbec4a50d, 0xbf6dbf35, 0xbec4a50d, 0xbf6dbf35, 0x3f7b3f80, 0x3f553f6d, 0xbf7bbf80, 0xbf55bf6d
.long 0xa50d8000, 0xa50d8000, 0xa50d8000, 0xa50d8000, 0x3f0ebf35, 0x3e48bec4, 0xbf0e3f35, 0xbe483ec4
.long 0xbf6d3f80, 0xbec43f35, 0xbf6d3f80, 0xbec43f35, 0x3f7bbf35, 0x3f0ebf6d, 0xbf7b3f35, 0xbf0e3f6d
.long 0xbf35a50d, 0xbf353f80, 0xbf35a50d, 0xbf353f80, 0x3e483f35, 0x3f55bf6d, 0xbe48bf35, 0xbf553f6d
.long 0x3ec4bf80, 0xbf6d3f35, 0x3ec4bf80, 0xbf6d3f35, 0xbf553f35, 0x3f7bbec4, 0x3f55bf35, 0xbf7b3ec4
.long 0x3f808000, 0xbf80a50d, 0x3f808000, 0xbf80a50d, 0xbf55bf35, 0x3f7b3ec4, 0x3f553f35, 0xbf7bbec4
.long 0x3ec43f80, 0xbf6dbf35, 0x3ec43f80, 0xbf6dbf35, 0x3e48bf35, 0x3f553f6d, 0xbe483f35, 0xbf55bf6d
.long 0xbf35a50d, 0xbf35bf80, 0xbf35a50d, 0xbf35bf80, 0x3f7b3f35, 0x3f0e3f6d, 0xbf7bbf35, 0xbf0ebf6d
.long 0xbf6dbf80, 0xbec4bf35, 0xbf6dbf80, 0xbec4bf35, 0x3f0e3f35, 0x3e483ec4, 0xbf0ebf35, 0xbe48bec4
.long 0x3f800000, 0x3f800000, 0x3f800000, 0x3f800000, 0x3f800000, 0x3f7ffcd7, 0x3f7ff35e, 0x3f7fe394
.long 0x3f800000, 0x3f7ff35e, 0x3f7fcd79, 0x3f7f8e56, 0x3f800000, 0x3f7fe394, 0x3f7f8e56, 0x3f7f0059
.long 0x3f800000, 0x3f7fcd79, 0x3f7f35f9, 0x3f7e39bc, 0x3f800000, 0x3f7fb10f, 0x3f7ec46d, 0x3f7d3aac
.long 0x3f800000, 0x3f7f8e56, 0x3f7e39bc, 0x3f7c0361, 0x3f800000, 0x3f7f654e, 0x3f7d95f4, 0x3f7a9421
.long 0x3f800000, 0x3f7f35f9, 0x3f7cd925, 0x3f78ed3c, 0x3f800000, 0x3f7f0059, 0x3f7c0361, 0x3f770f11
.long 0x3f800000, 0x3f7ec46d, 0x3f7b14be, 0x3f74fa0b, 0x3f800000, 0x3f7e8238, 0x3f7a0d54, 0x3f72ae9e
.long 0x3f800000, 0x3f7e39bc, 0x3f78ed3c, 0x3f702d4f, 0x3f800000, 0x3f7deafa, 0x3f77b493, 0x3f6d76aa
.long 0x3f800000, 0x3f7d95f4, 0x3f766377, 0x3f6a8b4b, 0x3f800000, 0x3f7d3aac, 0x3f74fa0b, 0x3f676bd8
.long 0x3f800000, 0x3f800000, 0x3f800000, 0x3f800000, 0x3f7fcd79, 0x3f7fb10f, 0x3f7f8e56, 0x3f7f654e
.long 0x3f7f35f9, 0x3f7ec46d, 0x3f7e39bc, 0x3f7d95f4, 0x3f7e39bc, 0x3f7d3aac, 0x3f7c0361, 0x3f7a9421
.long 0x3f7cd925, 0x3f7b14be, 0x3f78ed3c, 0x3f766377, 0x3f7b14be, 0x3f7853f8, 0x3f74fa0b, 0x3f710908
.long 0x3f78ed3c, 0x3f74fa0b, 0x3f702d4f, 0x3f6a8b4b, 0x3f766377, 0x3f710908, 0x3f6a8b4b, 0x3f62f219
.long 0x3f737871, 0x3f6c835e, 0x3f641901, 0x3f5a46a0, 0x3f702d4f, 0x3f676bd8, 0x3f5cdc29, 0x3f50935b
.long 0x3f6c835e, 0x3f61c598, 0x3f54db31, 0x3f45e403, 0x3f687c12, 0x3f5b941a, 0x3f4c1d35, 0x3f3a4582
.long 0x3f641901, 0x3f54db31, 0x3f42a9f7, 0x3f2dc5e3, 0x3f5f5be6, 0x3f4d9f02, 0x3f3889dc, 0x3f207440
.long 0x3f5a46a0, 0x3f45e403, 0x3f2dc5e3, 0x3f1260b2, 0x3f54db31, 0x3f3daef9, 0x3f226799, 0x3f039c3d
.long 0x3f800000, 0x3f800000, 0x3f800000, 0x3f800000, 0x3f7f35f9, 0x3f7f0059, 0x3f7ec46d, 0x3f7e8238
.long 0x3f7cd925, 0x3f7c0361, 0x3f7b14be, 0x3f7a0d54, 0x3f78ed3c, 0x3f770f11, 0x3f74fa0b, 0x3f72ae9e
.long 0x3f737871, 0x3f702d4f, 0x3f6c835e, 0x3f687c12, 0x3f6c835e, 0x3f676bd8, 0x3f61c598, 0x3f5b941a
.long 0x3f641901, 0x3f5cdc29, 0x3f54db31, 0x3f4c1d35, 0x3f5a46a0, 0x3f50935b, 0x3f45e403, 0x3f3a4582
.long 0x3f4f1bbd, 0x3f42a9f7, 0x3f3504f3, 0x3f26423a, 0x3f42a9f7, 0x3f333bc6, 0x3f226799, 0x3f104f0e
.long 0x3f3504f3, 0x3f226799, 0x3f0e39da, 0x3ef15aea, 0x3f26423a, 0x3f104f0e, 0x3ef15aea, 0x3ebf47d7
.long 0x3f167918, 0x3efa2c90, 0x3ec3ef15, 0x3e8afa3e, 0x3f05c277, 0x3ed1c759, 0x3e94a031, 0x3e2a1c3f
.long 0x3ee87171, 0x3ea7bf25, 0x3e47c5c2, 0x3d712283, 0x3ec3ef15, 0x3e78cfcc, 0x3dc8bd36, 0xbd48fb30
.long 0x3f800000, 0x3f800000, 0x3f800000, 0x3f800000, 0x3f7e39bc, 0x3f7deafa, 0x3f7d95f4, 0x3f7d3aac
.long 0x3f78ed3c, 0x3f77b493, 0x3f766377, 0x3f74fa0b, 0x3f702d4f, 0x3f6d76aa, 0x3f6a8b4b, 0x3f676bd8
.long 0x3f641901, 0x3f5f5be6, 0x3f5a46a0, 0x3f54db31, 0x3f54db31, 0x3f4d9f02, 0x3f45e403, 0x3f3daef9
.long 0x3f42a9f7, 0x3f3889dc, 0x3f2dc5e3, 0x3f226799, 0x3f2dc5e3, 0x3f207440, 0x3f1260b2, 0x3f039c3d
.long 0x3f167918, 0x3f05c277, 0x3ee87171, 0x3ec3ef15, 0x3efa2c90, 0x3ed1c759, 0x3ea7bf25, 0x3e78cfcc
.long 0x3ec3ef15, 0x3e94a031, 0x3e47c5c2, 0x3dc8bd36, 0x3e8afa3e, 0x3e2a1c3f, 0x3d712283, 0xbd48fb30
.long 0x3e20305b, 0x3d20cee7, 0xbda0af2a, 0xbe47c5c2, 0x3d20cee7, 0xbdb4b86a, 0xbe5b73dc, 0xbeac7cd4
.long 0xbda0af2a, 0xbe5b73dc, 0xbeb13641, 0xbef15aea, 0xbe47c5c2, 0xbeac7cd4, 0xbef15aea, 0xbf187fc0
.long 0x3f800000, 0x3f7cd925, 0x3f737871, 0x3f641901, 0x3f800000, 0x3f7c7160, 0x3f71decf, 0x3f609384
.long 0x3f800000, 0x3f7c0361, 0x3f702d4f, 0x3f5cdc29, 0x3f800000, 0x3f7b8f2a, 0x3f6e641a, 0x3f58f3c4
.long 0x3f800000, 0x3f7b14be, 0x3f6c835e, 0x3f54db31, 0x3f800000, 0x3f7a9421, 0x3f6a8b4b, 0x3f50935b
.long 0x3f800000, 0x3f7a0d54, 0x3f687c12, 0x3f4c1d35, 0x3f800000, 0x3f79805c, 0x3f6655e7, 0x3f4779bc
.long 0x3f800000, 0x3f78ed3c, 0x3f641901, 0x3f42a9f7, 0x3f800000, 0x3f7853f8, 0x3f61c598, 0x3f3daef9
.long 0x3f800000, 0x3f77b493, 0x3f5f5be6, 0x3f3889dc, 0x3f800000, 0x3f770f11, 0x3f5cdc29, 0x3f333bc6
.long 0x3f800000, 0x3f766377, 0x3f5a46a0, 0x3f2dc5e3, 0x3f800000, 0x3f75b1c9, 0x3f579b8c, 0x3f28296a
.long 0x3f800000, 0x3f74fa0b, 0x3f54db31, 0x3f226799, 0x3f800000, 0x3f743c41, 0x3f5205d4, 0x3f1c81b9
.long 0x3f4f1bbd, 0x3f3504f3, 0x3f167918, 0x3ee87171, 0x3f490a88, 0x3f2beb4a, 0x3f0a04f8, 0x3ec8917e
.long 0x3f42a9f7, 0x3f226799, 0x3efa2c90, 0x3ea7bf25, 0x3f3bfc8f, 0x3f187fc0, 0x3edf7108, 0x3e862210
.long 0x3f3504f3, 0x3f0e39da, 0x3ec3ef15, 0x3e47c5c2, 0x3f2dc5e3, 0x3f039c3d, 0x3ea7bf25, 0x3e0255f4
.long 0x3f26423a, 0x3ef15aea, 0x3e8afa3e, 0x3d712283, 0x3f1e7cf1, 0x3edae880, 0x3e5b73dc, 0xbc20d8d2
.long 0x3f167918, 0x3ec3ef15, 0x3e20305b, 0xbda0af2a, 0x3f0e39da, 0x3eac7cd4, 0x3dc8bd36, 0xbe164083
.long 0x3f05c277, 0x3e94a031, 0x3d20cee7, 0xbe5b73dc, 0x3efa2c90, 0x3e78cfcc, 0xbca0d6d6, 0xbe8fcefe
.long 0x3ee87171, 0x3e47c5c2, 0xbda0af2a, 0xbeb13641, 0x3ed65a92, 0x3e164083, 0xbe0c4cf7, 0xbed1c759
.long 0x3ec3ef15, 0x3dc8bd36, 0xbe47c5c2, 0xbef15aea, 0x3eb13641, 0x3d48fb30, 0xbe814693, 0xbf07e565
.long 0x3e9e377a, 0x3e20305b, 0x248d3132, 0xbe20305b, 0x3e6f0c4d, 0x3d8ca1f2, 0xbdc8bd36, 0xbe862210
.long 0x3e20305b, 0xbca0d6d6, 0xbe47c5c2, 0xbeba9be1, 0x3da0af2a, 0xbddcbd0d, 0xbe94a031, 0xbeece91a
.long 0x248d3132, 0xbe47c5c2, 0xbec3ef15, 0xbf0e39da, 0xbda0af2a, 0xbe8fcefe, 0xbef15aea, 0xbf2456f1
.long 0xbe20305b, 0xbeba9be1, 0xbf0e39da, 0xbf3889dc, 0xbe6f0c4d, 0xbee3f40d, 0xbf226799, 0xbf4a965e
.long 0xbe9e377a, 0xbf05c277, 0xbf3504f3, 0xbf5a46a0, 0xbec3ef15, 0xbf187fc0, 0xbf45e403, 0xbf676bd8
.long 0xbee87171, 0xbf2a0c73, 0xbf54db31, 0xbf71decf, 0xbf05c277, 0xbf3a4582, 0xbf61c598, 0xbf79805c
.long 0xbf167918, 0xbf490a88, 0xbf6c835e, 0xbf7e39bc, 0xbf26423a, 0xbf563e03, 0xbf74fa0b, 0xbf7ffcd7
.long 0xbf3504f3, 0xbf61c598, 0xbf7b14be, 0xbf7ec46d, 0xbf42a9f7, 0xbf6b8a3d, 0xbf7ec46d, 0xbf7a9421
.long 0xbe9e377a, 0xbee87171, 0xbf167918, 0xbf3504f3, 0xbed65a92, 0xbf104f0e, 0xbf316e2c, 0xbf4d9f02
.long 0xbf05c277, 0xbf2a0c73, 0xbf490a88, 0xbf61c598, 0xbf1e7cf1, 0xbf4105b8, 0xbf5cdc29, 0xbf710908
.long 0xbf3504f3, 0xbf54db31, 0xbf6c835e, 0xbf7b14be, 0xbf490a88, 0xbf653a48, 0xbf77b493, 0xbf7fb10f
.long 0xbf5a46a0, 0xbf71decf, 0xbf7e39bc, 0xbf7ec46d, 0xbf687c12, 0xbf7a9421, 0xbf7ff35e, 0xbf7853f8
.long 0xbf737871, 0xbf7f35f9, 0xbf7cd925, 0xbf6c835e, 0xbf7b14be, 0xbf7fb10f, 0xbf74fa0b, 0xbf5b941a
.long 0xbf7f35f9, 0xbf7c0361, 0xbf687c12, 0xbf45e403, 0xbf7fcd79, 0xbf743c41, 0xbf579b8c, 0xbf2beb4a
.long 0xbf7cd925, 0xbf687c12, 0xbf42a9f7, 0xbf0e39da, 0xbf766377, 0xbf58f3c4, 0xbf2a0c73, 0xbedae880
.long 0xbf6c835e, 0xbf45e403, 0xbf0e39da, 0xbe94a031, 0xbf5f5be6, 0xbf2f9c32, 0xbedf7108, 0xbe164083
.long 0x3f800000, 0x3f800000, 0x3f800000, 0x3f800000, 0x3f7cd925, 0x3f7c7160, 0x3f7c0361, 0x3f7b8f2a
.long 0x3f737871, 0x3f71decf, 0x3f702d4f, 0x3f6e641a, 0x3f641901, 0x3f609384, 0x3f5cdc29, 0x3f58f3c4
.long 0x3f4f1bbd, 0x3f490a88, 0x3f42a9f7, 0x3f3bfc8f, 0x3f3504f3, 0x3f2beb4a, 0x3f226799, 0x3f187fc0
.long 0x3f167918, 0x3f0a04f8, 0x3efa2c90, 0x3edf7108, 0x3ee87171, 0x3ec8917e, 0x3ea7bf25, 0x3e862210
.long 0x3e9e377a, 0x3e6f0c4d, 0x3e20305b, 0x3da0af2a, 0x3e20305b, 0x3d8ca1f2, 0xbca0d6d6, 0xbddcbd0d
.long 0x248d3132, 0xbdc8bd36, 0xbe47c5c2, 0xbe94a031, 0xbe20305b, 0xbe862210, 0xbeba9be1, 0xbeece91a
.long 0xbe9e377a, 0xbed65a92, 0xbf05c277, 0xbf1e7cf1, 0xbee87171, 0xbf104f0e, 0xbf2a0c73, 0xbf4105b8
.long 0xbf167918, 0xbf316e2c, 0xbf490a88, 0xbf5cdc29, 0xbf3504f3, 0xbf4d9f02, 0xbf61c598, 0xbf710908
.long 0x3f800000, 0x3f800000, 0x3f800000, 0x3f800000, 0x3f7b14be, 0x3f7a9421, 0x3f7a0d54, 0x3f79805c
.long 0x3f6c835e, 0x3f6a8b4b, 0x3f687c12, 0x3f6655e7, 0x3f54db31, 0x3f50935b, 0x3f4c1d35, 0x3f4779bc
.long 0x3f3504f3, 0x3f2dc5e3, 0x3f26423a, 0x3f1e7cf1, 0x3f0e39da, 0x3f039c3d, 0x3ef15aea, 0x3edae880
.long 0x3ec3ef15, 0x3ea7bf25, 0x3e8afa3e, 0x3e5b73dc, 0x3e47c5c2, 0x3e0255f4, 0x3d712283, 0xbc20d8d2
.long 0x248d3132, 0xbda0af2a, 0xbe20305b, 0xbe6f0c4d, 0xbe47c5c2, 0xbe8fcefe, 0xbeba9be1, 0xbee3f40d
.long 0xbec3ef15, 0xbef15aea, 0xbf0e39da, 0xbf226799, 0xbf0e39da, 0xbf2456f1, 0xbf3889dc, 0xbf4a965e
.long 0xbf3504f3, 0xbf490a88, 0xbf5a46a0, 0xbf687c12, 0xbf54db31, 0xbf653a48, 0xbf71decf, 0xbf7a9421
.long 0xbf6c835e, 0xbf77b493, 0xbf7e39bc, 0xbf7ff35e, 0xbf7b14be, 0xbf7fb10f, 0xbf7ec46d, 0xbf7853f8
.long 0x3f800000, 0x3f800000, 0x3f800000, 0x3f800000, 0x3f78ed3c, 0x3f7853f8, 0x3f77b493, 0x3f770f11
.long 0x3f641901, 0x3f61c598, 0x3f5f5be6, 0x3f5cdc29, 0x3f42a9f7, 0x3f3daef9, 0x3f3889dc, 0x3f333bc6
.long 0x3f167918, 0x3f0e39da, 0x3f05c277, 0x3efa2c90, 0x3ec3ef15, 0x3eac7cd4, 0x3e94a031, 0x3e78cfcc
.long 0x3e20305b, 0x3dc8bd36, 0x3d20cee7, 0xbca0d6d6, 0xbda0af2a, 0xbe164083, 0xbe5b73dc, 0xbe8fcefe
.long 0xbe9e377a, 0xbec3ef15, 0xbee87171, 0xbf05c277, 0xbf05c277, 0xbf187fc0, 0xbf2a0c73, 0xbf3a4582
.long 0xbf3504f3, 0xbf45e403, 0xbf54db31, 0xbf61c598, 0xbf5a46a0, 0xbf676bd8, 0xbf71decf, 0xbf79805c
.long 0xbf737871, 0xbf7b14be, 0xbf7f35f9, 0xbf7fcd79, 0xbf7f35f9, 0xbf7fb10f, 0xbf7c0361, 0xbf743c41
.long 0xbf7cd925, 0xbf74fa0b, 0xbf687c12, 0xbf579b8c, 0xbf6c835e, 0xbf5b941a, 0xbf45e403, 0xbf2beb4a
.long 0x3f800000, 0x3f800000, 0x3f800000, 0x3f800000, 0x3f766377, 0x3f75b1c9, 0x3f74fa0b, 0x3f743c41
.long 0x3f5a46a0, 0x3f579b8c, 0x3f54db31, 0x3f5205d4, 0x3f2dc5e3, 0x3f28296a, 0x3f226799, 0x3f1c81b9
.long 0x3ee87171, 0x3ed65a92, 0x3ec3ef15, 0x3eb13641, 0x3e47c5c2, 0x3e164083, 0x3dc8bd36, 0x3d48fb30
.long 0xbda0af2a, 0xbe0c4cf7, 0xbe47c5c2, 0xbe814693, 0xbeb13641, 0xbed1c759, 0xbef15aea, 0xbf07e565
.long 0xbf167918, 0xbf26423a, 0xbf3504f3, 0xbf42a9f7, 0xbf490a88, 0xbf563e03, 0xbf61c598, 0xbf6b8a3d
.long 0xbf6c835e, 0xbf74fa0b, 0xbf7b14be, 0xbf7ec46d, 0xbf7e39bc, 0xbf7ffcd7, 0xbf7ec46d, 0xbf7a9421
.long 0xbf7cd925, 0xbf766377, 0xbf6c835e, 0xbf5f5be6, 0xbf687c12, 0xbf58f3c4, 0xbf45e403, 0xbf2f9c32
.long 0xbf42a9f7, 0xbf2a0c73, 0xbf0e39da, 0xbedf7108, 0xbf0e39da, 0xbedae880, 0xbe94a031, 0xbe164083
.long 0xbf4f1bbd, 0xbf641901, 0xbf737871, 0xbf7cd925, 0xbf641901, 0xbf743c41, 0xbf7d95f4, 0xbf7fe394
.long 0xbf737871, 0xbf7d95f4, 0xbf7fcd79, 0xbf7a0d54, 0xbf7cd925, 0xbf7fe394, 0xbf7a0d54, 0xbf6b8a3d
.long 0xbf800000, 0xbf7b14be, 0xbf6c835e, 0xbf54db31, 0xbf7cd925, 0xbf6f4ba8, 0xbf579b8c, 0xbf36c9a9
.long 0xbf737871, 0xbf5cdc29, 0xbf3bfc8f, 0xbf1260b2, 0xbf641901, 0xbf444969, 0xbf1a82a4, 0xbed1c759
.long 0xbf4f1bbd, 0xbf26423a, 0xbee87171, 0xbe6f0c4d, 0xbf3504f3, 0xbf039c3d, 0xbe94a031, 0xbd48fb30
.long 0xbf167918, 0xbeba9be1, 0xbdf0b772, 0x3e0c4cf7, 0xbee87171, 0xbe519f65, 0x3d712283, 0x3ea2fd52
.long 0xbe9e377a, 0xbd20cee7, 0x3e6f0c4d, 0x3efa2c90, 0xbe20305b, 0x3e0255f4, 0x3ecd2ef3, 0x3f2456f1
.long 0xa553c9ca, 0x3e94a031, 0x3f0e39da, 0x3f45e403, 0x3e20305b, 0x3ee3f40d, 0x3f316e2c, 0x3f609384
.long 0xbf800000, 0xbf7cd925, 0xbf737871, 0xbf641901, 0xbf7b14be, 0xbf6f4ba8, 0xbf5cdc29, 0xbf444969
.long 0xbf6c835e, 0xbf579b8c, 0xbf3bfc8f, 0xbf1a82a4, 0xbf54db31, 0xbf36c9a9, 0xbf1260b2, 0xbed1c759
.long 0xbf3504f3, 0xbf0e39da, 0xbec3ef15, 0xbe47c5c2, 0xbf0e39da, 0xbebf47d7, 0xbe3403f1, 0x3cf13d4c
.long 0xbec3ef15, 0xbe3403f1, 0x3d20cee7, 0x3e814693, 0xbe47c5c2, 0x3cf13d4c, 0x3e814693, 0x3eece91a
.long 0xa553c9ca, 0x3e6f0c4d, 0x3ee87171, 0x3f26423a, 0x3e47c5c2, 0x3edae880, 0x3f226799, 0x3f4d9f02
.long 0x3ec3ef15, 0x3f1a82a4, 0x3f490a88, 0x3f6a8b4b, 0x3f0e39da, 0x3f4105b8, 0x3f6655e7, 0x3f7b8f2a
.long 0x3f3504f3, 0x3f5f5be6, 0x3f78ed3c, 0x3f7fcd79, 0x3f54db31, 0x3f743c41, 0x3f7ff35e, 0x3f770f11
.long 0x3f6c835e, 0x3f7ec46d, 0x3f7b14be, 0x3f61c598, 0x3f7b14be, 0x3f7e8238, 0x3f6a8b4b, 0x3f4105b8
.long 0xbf4f1bbd, 0xbf3504f3, 0xbf167918, 0xbee87171, 0xbf26423a, 0xbf039c3d, 0xbeba9be1, 0xbe519f65
.long 0xbee87171, 0xbe94a031, 0xbdf0b772, 0x3d712283, 0xbe6f0c4d, 0xbd48fb30, 0x3e0c4cf7, 0x3ea2fd52
.long 0xa553c9ca, 0x3e47c5c2, 0x3ec3ef15, 0x3f0e39da, 0x3e6f0c4d, 0x3edae880, 0x3f1a82a4, 0x3f4105b8
.long 0x3ee87171, 0x3f226799, 0x3f490a88, 0x3f6655e7, 0x3f26423a, 0x3f4d9f02, 0x3f6a8b4b, 0x3f7b8f2a
.long 0x3f4f1bbd, 0x3f6c835e, 0x3f7cd925, 0x3f7f35f9, 0x3f6c835e, 0x3f7d3aac, 0x3f7ec46d, 0x3f710908
.long 0x3f7cd925, 0x3f7ec46d, 0x3f702d4f, 0x3f5205d4, 0x3f7f35f9, 0x3f710908, 0x3f5205d4, 0x3f2456f1
.long 0x3f737871, 0x3f54db31, 0x3f26423a, 0x3ed65a92, 0x3f5a46a0, 0x3f2beb4a, 0x3edf7108, 0x3e2a1c3f
.long 0x3f3504f3, 0x3ef15aea, 0x3e47c5c2, 0xbdc8bd36, 0x3f05c277, 0x3e78cfcc, 0xbd712283, 0xbeb5eb4f
.long 0xbe9e377a, 0xbe20305b, 0xa553c9ca, 0x3e20305b, 0xbd20cee7, 0x3e0255f4, 0x3e94a031, 0x3ee3f40d
.long 0x3e6f0c4d, 0x3ecd2ef3, 0x3f0e39da, 0x3f316e2c, 0x3efa2c90, 0x3f2456f1, 0x3f45e403, 0x3f609384
.long 0x3f3504f3, 0x3f54db31, 0x3f6c835e, 0x3f7b14be, 0x3f5f5be6, 0x3f743c41, 0x3f7ec46d, 0x3f7e8238
.long 0x3f78ed3c, 0x3f7ff35e, 0x3f7b14be, 0x3f6a8b4b, 0x3f7fcd79, 0x3f770f11, 0x3f61c598, 0x3f4105b8
.long 0x3f737871, 0x3f5a46a0, 0x3f3504f3, 0x3f05c277, 0x3f54db31, 0x3f2beb4a, 0x3ef15aea, 0x3e78cfcc
.long 0x3f26423a, 0x3edf7108, 0x3e47c5c2, 0xbd712283, 0x3ed65a92, 0x3e2a1c3f, 0xbdc8bd36, 0xbeb5eb4f
.long 0x3e20305b, 0xbdf0b772, 0xbec3ef15, 0xbf1e7cf1, 0xbdf0b772, 0xbec8917e, 0xbf226799, 0xbf53731f
.long 0xbec3ef15, 0xbf226799, 0xbf54db31, 0xbf74fa0b, 0xbf1e7cf1, 0xbf53731f, 0xbf74fa0b, 0xbf7ffcd7
.long 0x00000000, 0x00000000, 0x00000000, 0x00000000, 0x00000000, 0x3c20d8d2, 0x3ca0d6d6, 0x3cf13d4c
.long 0x00000000, 0x3ca0d6d6, 0x3d20cee7, 0x3d712283, 0x00000000, 0x3cf13d4c, 0x3d712283, 0x3db4b86a
.long 0x00000000, 0x3d20cee7, 0x3da0af2a, 0x3df0b772, 0x00000000, 0x3d48fb30, 0x3dc8bd36, 0x3e164083
.long 0x00000000, 0x3d712283, 0x3df0b772, 0x3e3403f1, 0x00000000, 0x3d8ca1f2, 0x3e0c4cf7, 0x3e519f65
.long 0x00000000, 0x3da0af2a, 0x3e20305b, 0x3e6f0c4d, 0x00000000, 0x3db4b86a, 0x3e3403f1, 0x3e862210
.long 0x00000000, 0x3dc8bd36, 0x3e47c5c2, 0x3e94a031, 0x00000000, 0x3ddcbd0d, 0x3e5b73dc, 0x3ea2fd52
.long 0x00000000, 0x3df0b772, 0x3e6f0c4d, 0x3eb13641, 0x00000000, 0x3e0255f4, 0x3e814693, 0x3ebf47d7
.long 0x00000000, 0x3e0c4cf7, 0x3e8afa3e, 0x3ecd2ef3, 0x00000000, 0x3e164083, 0x3e94a031, 0x3edae880
.long 0x00000000, 0x00000000, 0x00000000, 0x00000000, 0x3d20cee7, 0x3d48fb30, 0x3d712283, 0x3d8ca1f2
.long 0x3da0af2a, 0x3dc8bd36, 0x3df0b772, 0x3e0c4cf7, 0x3df0b772, 0x3e164083, 0x3e3403f1, 0x3e519f65
.long 0x3e20305b, 0x3e47c5c2, 0x3e6f0c4d, 0x3e8afa3e, 0x3e47c5c2, 0x3e78cfcc, 0x3e94a031, 0x3eac7cd4
.long 0x3e6f0c4d, 0x3e94a031, 0x3eb13641, 0x3ecd2ef3, 0x3e8afa3e, 0x3eac7cd4, 0x3ecd2ef3, 0x3eece91a
.long 0x3e9e377a, 0x3ec3ef15, 0x3ee87171, 0x3f05c277, 0x3eb13641, 0x3edae880, 0x3f0172c3, 0x3f146eba
.long 0x3ec3ef15, 0x3ef15aea, 0x3f0e39da, 0x3f226799, 0x3ed65a92, 0x3f039c3d, 0x3f1a82a4, 0x3f2f9c32
.long 0x3ee87171, 0x3f0e39da, 0x3f26423a, 0x3f3bfc8f, 0x3efa2c90, 0x3f187fc0, 0x3f316e2c, 0x3f4779bc
.long 0x3f05c277, 0x3f226799, 0x3f3bfc8f, 0x3f5205d4, 0x3f0e39da, 0x3f2beb4a, 0x3f45e403, 0x3f5b941a
.long 0x00000000, 0x00000000, 0x00000000, 0x00000000, 0x3da0af2a, 0x3db4b86a, 0x3dc8bd36, 0x3ddcbd0d
.long 0x3e20305b, 0x3e3403f1, 0x3e47c5c2, 0x3e5b73dc, 0x3e6f0c4d, 0x3e862210, 0x3e94a031, 0x3ea2fd52
.long 0x3e9e377a, 0x3eb13641, 0x3ec3ef15, 0x3ed65a92, 0x3ec3ef15, 0x3edae880, 0x3ef15aea, 0x3f039c3d
.long 0x3ee87171, 0x3f0172c3, 0x3f0e39da, 0x3f1a82a4, 0x3f05c277, 0x3f146eba, 0x3f226799, 0x3f2f9c32
.long 0x3f167918, 0x3f26423a, 0x3f3504f3, 0x3f42a9f7, 0x3f26423a, 0x3f36c9a9, 0x3f45e403, 0x3f53731f
.long 0x3f3504f3, 0x3f45e403, 0x3f54db31, 0x3f61c598, 0x3f42a9f7, 0x3f53731f, 0x3f61c598, 0x3f6d76aa
.long 0x3f4f1bbd, 0x3f5f5be6, 0x3f6c835e, 0x3f766377, 0x3f5a46a0, 0x3f698690, 0x3f74fa0b, 0x3f7c7160
.long 0x3f641901, 0x3f71decf, 0x3f7b14be, 0x3f7f8e56, 0x3f6c835e, 0x3f7853f8, 0x3f7ec46d, 0x3f7fb10f
.long 0x00000000, 0x00000000, 0x00000000, 0x00000000, 0x3df0b772, 0x3e0255f4, 0x3e0c4cf7, 0x3e164083
.long 0x3e6f0c4d, 0x3e814693, 0x3e8afa3e, 0x3e94a031, 0x3eb13641, 0x3ebf47d7, 0x3ecd2ef3, 0x3edae880
.long 0x3ee87171, 0x3efa2c90, 0x3f05c277, 0x3f0e39da, 0x3f0e39da, 0x3f187fc0, 0x3f226799, 0x3f2beb4a
.long 0x3f26423a, 0x3f316e2c, 0x3f3bfc8f, 0x3f45e403, 0x3f3bfc8f, 0x3f4779bc, 0x3f5205d4, 0x3f5b941a
.long 0x3f4f1bbd, 0x3f5a46a0, 0x3f641901, 0x3f6c835e, 0x3f5f5be6, 0x3f698690, 0x3f71decf, 0x3f7853f8
.long 0x3f6c835e, 0x3f74fa0b, 0x3f7b14be, 0x3f7ec46d, 0x3f766377, 0x3f7c7160, 0x3f7f8e56, 0x3f7fb10f
.long 0x3f7cd925, 0x3f7fcd79, 0x3f7f35f9, 0x3f7b14be, 0x3f7fcd79, 0x3f7f0059, 0x3f7a0d54, 0x3f710908
.long 0x3f7f35f9, 0x3f7a0d54, 0x3f702d4f, 0x3f61c598, 0x3f7b14be, 0x3f710908, 0x3f61c598, 0x3f4d9f02
.long 0x00000000, 0x3e20305b, 0x3e9e377a, 0x3ee87171, 0x00000000, 0x3e2a1c3f, 0x3ea7bf25, 0x3ef5c6c5
.long 0x00000000, 0x3e3403f1, 0x3eb13641, 0x3f0172c3, 0x00000000, 0x3e3de731, 0x3eba9be1, 0x3f07e565
.long 0x00000000, 0x3e47c5c2, 0x3ec3ef15, 0x3f0e39da, 0x00000000, 0x3e519f65, 0x3ecd2ef3, 0x3f146eba
.long 0x00000000, 0x3e5b73dc, 0x3ed65a92, 0x3f1a82a4, 0x00000000, 0x3e6542e9, 0x3edf7108, 0x3f207440
.long 0x00000000, 0x3e6f0c4d, 0x3ee87171, 0x3f26423a, 0x00000000, 0x3e78cfcc, 0x3ef15aea, 0x3f2beb4a
.long 0x00000000, 0x3e814693, 0x3efa2c90, 0x3f316e2c, 0x00000000, 0x3e862210, 0x3f0172c3, 0x3f36c9a9
.long 0x00000000, 0x3e8afa3e, 0x3f05c277, 0x3f3bfc8f, 0x00000000, 0x3e8fcefe, 0x3f0a04f8, 0x3f4105b8
.long 0x00000000, 0x3e94a031, 0x3f0e39da, 0x3f45e403, 0x00000000, 0x3e996dba, 0x3f1260b2, 0x3f4a965e
.long 0x3f167918, 0x3f3504f3, 0x3f4f1bbd, 0x3f641901, 0x3f1e7cf1, 0x3f3daef9, 0x3f579b8c, 0x3f6b8a3d
.long 0x3f26423a, 0x3f45e403, 0x3f5f5be6, 0x3f71decf, 0x3f2dc5e3, 0x3f4d9f02, 0x3f6655e7, 0x3f770f11
.long 0x3f3504f3, 0x3f54db31, 0x3f6c835e, 0x3f7b14be, 0x3f3bfc8f, 0x3f5b941a, 0x3f71decf, 0x3f7deafa
.long 0x3f42a9f7, 0x3f61c598, 0x3f766377, 0x3f7f8e56, 0x3f490a88, 0x3f676bd8, 0x3f7a0d54, 0x3f7ffcd7
.long 0x3f4f1bbd, 0x3f6c835e, 0x3f7cd925, 0x3f7f35f9, 0x3f54db31, 0x3f710908, 0x3f7ec46d, 0x3f7d3aac
.long 0x3f5a46a0, 0x3f74fa0b, 0x3f7fcd79, 0x3f7a0d54, 0x3f5f5be6, 0x3f7853f8, 0x3f7ff35e, 0x3f75b1c9
.long 0x3f641901, 0x3f7b14be, 0x3f7f35f9, 0x3f702d4f, 0x3f687c12, 0x3f7d3aac, 0x3f7d95f4, 0x3f698690
.long 0x3f6c835e, 0x3f7ec46d, 0x3f7b14be, 0x3f61c598, 0x3f702d4f, 0x3f7fb10f, 0x3f77b493, 0x3f58f3c4
.long 0x3f737871, 0x3f7cd925, 0x3f800000, 0x3f7cd925, 0x3f78ed3c, 0x3f7f654e, 0x3f7ec46d, 0x3f770f11
.long 0x3f7cd925, 0x3f7ff35e, 0x3f7b14be, 0x3f6e641a, 0x3f7f35f9, 0x3f7e8238, 0x3f74fa0b, 0x3f62f219
.long 0x3f800000, 0x3f7b14be, 0x3f6c835e, 0x3f54db31, 0x3f7f35f9, 0x3f75b1c9, 0x3f61c598, 0x3f444969
.long 0x3f7cd925, 0x3f6e641a, 0x3f54db31, 0x3f316e2c, 0x3f78ed3c, 0x3f653a48, 0x3f45e403, 0x3f1c81b9
.long 0x3f737871, 0x3f5a46a0, 0x3f3504f3, 0x3f05c277, 0x3f6c835e, 0x3f4d9f02, 0x3f226799, 0x3edae880
.long 0x3f641901, 0x3f3f5cb5, 0x3f0e39da, 0x3ea7bf25, 0x3f5a46a0, 0x3f2f9c32, 0x3ef15aea, 0x3e6542e9
.long 0x3f4f1bbd, 0x3f1e7cf1, 0x3ec3ef15, 0x3df0b772, 0x3f42a9f7, 0x3f0c2124, 0x3e94a031, 0x3c20d8d2
.long 0x3f3504f3, 0x3ef15aea, 0x3e47c5c2, 0xbdc8bd36, 0x3f26423a, 0x3ec8917e, 0x3dc8bd36, 0xbe519f65
.long 0x3f737871, 0x3f641901, 0x3f4f1bbd, 0x3f3504f3, 0x3f687c12, 0x3f53731f, 0x3f3889dc, 0x3f187fc0
.long 0x3f5a46a0, 0x3f3f5cb5, 0x3f1e7cf1, 0x3ef15aea, 0x3f490a88, 0x3f28296a, 0x3f0172c3, 0x3eac7cd4
.long 0x3f3504f3, 0x3f0e39da, 0x3ec3ef15, 0x3e47c5c2, 0x3f1e7cf1, 0x3ee3f40d, 0x3e814693, 0x3d48fb30
.long 0x3f05c277, 0x3ea7bf25, 0x3df0b772, 0xbdc8bd36, 0x3ed65a92, 0x3e519f65, 0xbca0d6d6, 0xbe78cfcc
.long 0x3e9e377a, 0x3da0af2a, 0xbe20305b, 0xbec3ef15, 0x3e47c5c2, 0xbd48fb30, 0xbe94a031, 0xbf039c3d
.long 0x3da0af2a, 0xbe3403f1, 0xbed65a92, 0xbf226799, 0xbd20cee7, 0xbe996dba, 0xbf0a04f8, 0xbf3daef9
.long 0xbe20305b, 0xbed65a92, 0xbf26423a, 0xbf54db31, 0xbe8afa3e, 0xbf07e565, 0xbf3f5cb5, 0xbf676bd8
.long 0xbec3ef15, 0xbf226799, 0xbf54db31, 0xbf74fa0b, 0xbefa2c90, 0xbf3a4582, 0xbf6655e7, 0xbf7d3aac
.long 0x00000000, 0x00000000, 0x00000000, 0x00000000, 0x3e20305b, 0x3e2a1c3f, 0x3e3403f1, 0x3e3de731
.long 0x3e9e377a, 0x3ea7bf25, 0x3eb13641, 0x3eba9be1, 0x3ee87171, 0x3ef5c6c5, 0x3f0172c3, 0x3f07e565
.long 0x3f167918, 0x3f1e7cf1, 0x3f26423a, 0x3f2dc5e3, 0x3f3504f3, 0x3f3daef9, 0x3f45e403, 0x3f4d9f02
.long 0x3f4f1bbd, 0x3f579b8c, 0x3f5f5be6, 0x3f6655e7, 0x3f641901, 0x3f6b8a3d, 0x3f71decf, 0x3f770f11
.long 0x3f737871, 0x3f78ed3c, 0x3f7cd925, 0x3f7f35f9, 0x3f7cd925, 0x3f7f654e, 0x3f7ff35e, 0x3f7e8238
.long 0x3f800000, 0x3f7ec46d, 0x3f7b14be, 0x3f74fa0b, 0x3f7cd925, 0x3f770f11, 0x3f6e641a, 0x3f62f219
.long 0x3f737871, 0x3f687c12, 0x3f5a46a0, 0x3f490a88, 0x3f641901, 0x3f53731f, 0x3f3f5cb5, 0x3f28296a
.long 0x3f4f1bbd, 0x3f3889dc, 0x3f1e7cf1, 0x3f0172c3, 0x3f3504f3, 0x3f187fc0, 0x3ef15aea, 0x3eac7cd4
.long 0x00000000, 0x00000000, 0x00000000, 0x00000000, 0x3e47c5c2, 0x3e519f65, 0x3e5b73dc, 0x3e6542e9
.long 0x3ec3ef15, 0x3ecd2ef3, 0x3ed65a92, 0x3edf7108, 0x3f0e39da, 0x3f146eba, 0x3f1a82a4, 0x3f207440
.long 0x3f3504f3, 0x3f3bfc8f, 0x3f42a9f7, 0x3f490a88, 0x3f54db31, 0x3f5b941a, 0x3f61c598, 0x3f676bd8
.long 0x3f6c835e, 0x3f71decf, 0x3f766377, 0x3f7a0d54, 0x3f7b14be, 0x3f7deafa, 0x3f7f8e56, 0x3f7ffcd7
.long 0x3f800000, 0x3f7f35f9, 0x3f7cd925, 0x3f78ed3c, 0x3f7b14be, 0x3f75b1c9, 0x3f6e641a, 0x3f653a48
.long 0x3f6c835e, 0x3f61c598, 0x3f54db31, 0x3f45e403, 0x3f54db31, 0x3f444969, 0x3f316e2c, 0x3f1c81b9
.long 0x3f3504f3, 0x3f1e7cf1, 0x3f05c277, 0x3ed65a92, 0x3f0e39da, 0x3ee3f40d, 0x3ea7bf25, 0x3e519f65
.long 0x3ec3ef15, 0x3e814693, 0x3df0b772, 0xbca0d6d6, 0x3e47c5c2, 0x3d48fb30, 0xbdc8bd36, 0xbe78cfcc
.long 0x00000000, 0x00000000, 0x00000000, 0x00000000, 0x3e6f0c4d, 0x3e78cfcc, 0x3e814693, 0x3e862210
.long 0x3ee87171, 0x3ef15aea, 0x3efa2c90, 0x3f0172c3, 0x3f26423a, 0x3f2beb4a, 0x3f316e2c, 0x3f36c9a9
.long 0x3f4f1bbd, 0x3f54db31, 0x3f5a46a0, 0x3f5f5be6, 0x3f6c835e, 0x3f710908, 0x3f74fa0b, 0x3f7853f8
.long 0x3f7cd925, 0x3f7ec46d, 0x3f7fcd79, 0x3f7ff35e, 0x3f7f35f9, 0x3f7d3aac, 0x3f7a0d54, 0x3f75b1c9
.long 0x3f737871, 0x3f6c835e, 0x3f641901, 0x3f5a46a0, 0x3f5a46a0, 0x3f4d9f02, 0x3f3f5cb5, 0x3f2f9c32
.long 0x3f3504f3, 0x3f226799, 0x3f0e39da, 0x3ef15aea, 0x3f05c277, 0x3edae880, 0x3ea7bf25, 0x3e6542e9
.long 0x3e9e377a, 0x3e47c5c2, 0x3da0af2a, 0xbd20cee7, 0x3da0af2a, 0xbd48fb30, 0xbe3403f1, 0xbe996dba
.long 0xbe20305b, 0xbe94a031, 0xbed65a92, 0xbf0a04f8, 0xbec3ef15, 0xbf039c3d, 0xbf226799, 0xbf3daef9
.long 0x00000000, 0x00000000, 0x00000000, 0x00000000, 0x3e8afa3e, 0x3e8fcefe, 0x3e94a031, 0x3e996dba
.long 0x3f05c277, 0x3f0a04f8, 0x3f0e39da, 0x3f1260b2, 0x3f3bfc8f, 0x3f4105b8, 0x3f45e403, 0x3f4a965e
.long 0x3f641901, 0x3f687c12, 0x3f6c835e, 0x3f702d4f, 0x3f7b14be, 0x3f7d3aac, 0x3f7ec46d, 0x3f7fb10f
.long 0x3f7f35f9, 0x3f7d95f4, 0x3f7b14be, 0x3f77b493, 0x3f702d4f, 0x3f698690, 0x3f61c598, 0x3f58f3c4
.long 0x3f4f1bbd, 0x3f42a9f7, 0x3f3504f3, 0x3f26423a, 0x3f1e7cf1, 0x3f0c2124, 0x3ef15aea, 0x3ec8917e
.long 0x3ec3ef15, 0x3e94a031, 0x3e47c5c2, 0x3dc8bd36, 0x3df0b772, 0x3c20d8d2, 0xbdc8bd36, 0xbe519f65
.long 0xbe20305b, 0xbe8afa3e, 0xbec3ef15, 0xbefa2c90, 0xbed65a92, 0xbf07e565, 0xbf226799, 0xbf3a4582
.long 0xbf26423a, 0xbf3f5cb5, 0xbf54db31, 0xbf6655e7, 0xbf54db31, 0xbf676bd8, 0xbf74fa0b, 0xbf7d3aac
.long 0x3f167918, 0x3ee87171, 0x3e9e377a, 0x3e20305b, 0x3ee87171, 0x3e996dba, 0x3e0c4cf7, 0xbcf13d4c
.long 0x3e9e377a, 0x3e0c4cf7, 0xbd20cee7, 0xbe5b73dc, 0x3e20305b, 0xbcf13d4c, 0xbe5b73dc, 0xbec8917e
.long 0x250d3132, 0xbe47c5c2, 0xbec3ef15, 0xbf0e39da, 0xbe20305b, 0xbeb5eb4f, 0xbf0a04f8, 0xbf333bc6
.long 0xbe9e377a, 0xbf0172c3, 0xbf2dc5e3, 0xbf5205d4, 0xbee87171, 0xbf2456f1, 0xbf4c1d35, 0xbf698690
.long 0xbf167918, 0xbf42a9f7, 0xbf641901, 0xbf78ed3c, 0xbf3504f3, 0xbf5b941a, 0xbf74fa0b, 0xbf7fb10f
.long 0xbf4f1bbd, 0xbf6e641a, 0xbf7e39bc, 0xbf7d95f4, 0xbf641901, 0xbf7a9421, 0xbf7f8e56, 0xbf72ae9e
.long 0xbf737871, 0xbf7fcd79, 0xbf78ed3c, 0xbf5f5be6, 0xbf7cd925, 0xbf7deafa, 0xbf6a8b4b, 0xbf444969
.long 0xbf800000, 0xbf74fa0b, 0xbf54db31, 0xbf226799, 0xbf7cd925, 0xbf653a48, 0xbf3889dc, 0xbef5c6c5
.long 0x250d3132, 0xbe20305b, 0xbe9e377a, 0xbee87171, 0xbe47c5c2, 0xbeb5eb4f, 0xbf0172c3, 0xbf2456f1
.long 0xbec3ef15, 0xbf0a04f8, 0xbf2dc5e3, 0xbf4c1d35, 0xbf0e39da, 0xbf333bc6, 0xbf5205d4, 0xbf698690
.long 0xbf3504f3, 0xbf54db31, 0xbf6c835e, 0xbf7b14be, 0xbf54db31, 0xbf6d76aa, 0xbf7c0361, 0xbf7fe394
.long 0xbf6c835e, 0xbf7c0361, 0xbf7fcd79, 0xbf77b493, 0xbf7b14be, 0xbf7fe394, 0xbf77b493, 0xbf62f219
.long 0xbf800000, 0xbf78ed3c, 0xbf641901, 0xbf42a9f7, 0xbf7b14be, 0xbf676bd8, 0xbf45e403, 0xbf187fc0
.long 0xbf6c835e, 0xbf4c1d35, 0xbf1e7cf1, 0xbecd2ef3, 0xbf54db31, 0xbf28296a, 0xbedf7108, 0xbe3de731
.long 0xbf3504f3, 0xbefa2c90, 0xbe6f0c4d, 0x3d20cee7, 0xbf0e39da, 0xbe996dba, 0xbca0d6d6, 0x3e862210
.long 0xbec3ef15, 0xbdc8bd36, 0x3e47c5c2, 0x3ef15aea, 0xbe47c5c2, 0x3ddcbd0d, 0x3ecd2ef3, 0x3f28296a
.long 0xbf167918, 0xbf3504f3, 0xbf4f1bbd, 0xbf641901, 0xbf42a9f7, 0xbf5b941a, 0xbf6e641a, 0xbf7a9421
.long 0xbf641901, 0xbf74fa0b, 0xbf7e39bc, 0xbf7f8e56, 0xbf78ed3c, 0xbf7fb10f, 0xbf7d95f4, 0xbf72ae9e
.long 0xbf800000, 0xbf7b14be, 0xbf6c835e, 0xbf54db31, 0xbf78ed3c, 0xbf676bd8, 0xbf4c1d35, 0xbf28296a
.long 0xbf641901, 0xbf45e403, 0xbf1e7cf1, 0xbedf7108, 0xbf42a9f7, 0xbf187fc0, 0xbecd2ef3, 0xbe3de731
.long 0xbf167918, 0xbec3ef15, 0xbe20305b, 0x3da0af2a, 0xbec3ef15, 0xbe164083, 0x3dc8bd36, 0x3eac7cd4
.long 0xbe20305b, 0x3dc8bd36, 0x3eb13641, 0x3f1260b2, 0x3da0af2a, 0x3eac7cd4, 0x3f1260b2, 0x3f444969
.long 0x3e9e377a, 0x3f0e39da, 0x3f42a9f7, 0x3f687c12, 0x3f05c277, 0x3f3daef9, 0x3f6655e7, 0x3f7c7160
.long 0x3f3504f3, 0x3f61c598, 0x3f7b14be, 0x3f7ec46d, 0x3f5a46a0, 0x3f7853f8, 0x3f7f8e56, 0x3f6f4ba8
.long 0xbf737871, 0xbf7cd925, 0xbf800000, 0xbf7cd925, 0xbf7fcd79, 0xbf7deafa, 0xbf74fa0b, 0xbf653a48
.long 0xbf78ed3c, 0xbf6a8b4b, 0xbf54db31, 0xbf3889dc, 0xbf5f5be6, 0xbf444969, 0xbf226799, 0xbef5c6c5
.long 0xbf3504f3, 0xbf0e39da, 0xbec3ef15, 0xbe47c5c2, 0xbefa2c90, 0xbe996dba, 0xbdc8bd36, 0x3ddcbd0d
.long 0xbe6f0c4d, 0xbca0d6d6, 0x3e47c5c2, 0x3ecd2ef3, 0x3d20cee7, 0x3e862210, 0x3ef15aea, 0x3f28296a
.long 0x3e9e377a, 0x3f05c277, 0x3f3504f3, 0x3f5a46a0, 0x3f0e39da, 0x3f3daef9, 0x3f61c598, 0x3f7853f8
.long 0x3f42a9f7, 0x3f6655e7, 0x3f7b14be, 0x3f7f8e56, 0x3f687c12, 0x3f7c7160, 0x3f7ec46d, 0x3f6f4ba8
.long 0x3f7cd925, 0x3f7e39bc, 0x3f6c835e, 0x3f490a88, 0x3f7e39bc, 0x3f6b8a3d, 0x3f45e403, 0x3f104f0e
.long 0x3f6c835e, 0x3f45e403, 0x3f0e39da, 0x3e94a031, 0x3f490a88, 0x3f104f0e, 0x3e94a031, 0xbc20d8d2
.long 0x3f803f80, 0x3f803f80, 0x3f803f80, 0x3f803f80, 0x3f733f80, 0x3f163f4f, 0x3f163e9e, 0x3f733f4f
.long 0x3f4f3f80, 0xbe9e3e9e, 0xbe9ebf4f, 0x3f4f3e9e, 0x3f163f80, 0xbf73be9e, 0xbf73bf4f, 0x3f16be9e
.long 0x3e9e3f80, 0xbf4fbf4f, 0xbf4f3e9e, 0x3e9ebf4f, 0x00000000, 0x00000000, 0x00000000, 0x00000000
.long 0x00000000, 0x00000000, 0x00000000, 0x00000000, 0x00000000, 0x00000000, 0x00000000, 0x00000000
.long 0x00000000, 0x00000000, 0x00000000, 0x00000000, 0x00000000, 0x00000000, 0x00000000, 0x00000000
.long 0x00000000, 0x00000000, 0x00000000, 0x00000000, 0x00000000, 0x00000000, 0x00000000, 0x00000000
.long 0x00000000, 0x00000000, 0x00000000, 0x00000000, 0x00000000, 0x00000000, 0x00000000, 0x00000000
.long 0x00000000, 0x00000000, 0x00000000, 0x00000000, 0x00000000, 0x00000000, 0x00000000, 0x00000000
.long 0x3f803f80, 0x3f803f80, 0x00000000, 0x00000000, 0x248d3e9e, 0xbf16be9e, 0x00000000, 0x00000000
.long 0xbf80bf4f, 0xbe9ebf4f, 0x00000000, 0x00000000, 0xa554bf4f, 0x3f733f4f, 0x00000000, 0x00000000
.long 0x3f803e9e, 0xbf4f3e9e, 0x00000000, 0x00000000, 0x00000000, 0x00000000, 0x00000000, 0x00000000
.long 0x00000000, 0x00000000, 0x00000000, 0x00000000, 0x00000000, 0x00000000, 0x00000000, 0x00000000
.long 0x00000000, 0x00000000, 0x00000000, 0x00000000, 0x00000000, 0x00000000, 0x00000000, 0x00000000
.long 0x00000000, 0x00000000, 0x00000000, 0x00000000, 0x00000000, 0x00000000, 0x00000000, 0x00000000
.long 0x00000000, 0x00000000, 0x00000000, 0x00000000, 0x00000000, 0x00000000, 0x00000000, 0x00000000
.long 0x00000000, 0x00000000, 0x00000000, 0x00000000, 0x00000000, 0x00000000, 0x00000000, 0x00000000
.long 0x3f803f80, 0x3f803f80, 0x00000000, 0x00000000, 0xbf73bf4f, 0xbf73bf80, 0x00000000, 0x00000000
.long 0x3f4f3e9e, 0x3f4f3f80, 0x00000000, 0x00000000, 0xbf163e9e, 0xbf16bf80, 0x00000000, 0x00000000
.long 0x3e9ebf4f, 0x3e9e3f80, 0x00000000, 0x00000000, 0x00000000, 0x00000000, 0x00000000, 0x00000000
.long 0x00000000, 0x00000000, 0x00000000, 0x00000000, 0x00000000, 0x00000000, 0x00000000, 0x00000000
.long 0x00000000, 0x00000000, 0x00000000, 0x00000000, 0x00000000, 0x00000000, 0x00000000, 0x00000000
.long 0x00000000, 0x00000000, 0x00000000, 0x00000000, 0x00000000, 0x00000000, 0x00000000, 0x00000000
.long 0x00000000, 0x00000000, 0x00000000, 0x00000000, 0x00000000, 0x00000000, 0x00000000, 0x00000000
.long 0x00000000, 0x00000000, 0x00000000, 0x00000000, 0x00000000, 0x00000000, 0x00000000, 0x00000000
.long 0x3f803f80, 0x3f803f80, 0x00000000, 0x00000000, 0xbf16bf4f, 0xa554be9e, 0x00000000, 0x00000000
.long 0xbe9e3e9e, 0xbf80bf4f, 0x00000000, 0x00000000, 0x3f733e9e, 0x248d3f4f, 0x00000000, 0x00000000
.long 0xbf4fbf4f, 0x3f803e9e, 0x00000000, 0x00000000, 0x00000000, 0x00000000, 0x00000000, 0x00000000
.long 0x00000000, 0x00000000, 0x00000000, 0x00000000, 0x00000000, 0x00000000, 0x00000000, 0x00000000
.long 0x00000000, 0x00000000, 0x00000000, 0x00000000, 0x00000000, 0x00000000, 0x00000000, 0x00000000
.long 0x00000000, 0x00000000, 0x00000000, 0x00000000, 0x00000000, 0x00000000, 0x00000000, 0x00000000
.long 0x00000000, 0x00000000, 0x00000000, 0x00000000, 0x00000000, 0x00000000, 0x00000000, 0x00000000
.long 0x00000000, 0x00000000, 0x00000000, 0x00000000, 0x00000000, 0x00000000, 0x00000000, 0x00000000
.long 0x00000000, 0x00000000, 0x00000000, 0x00000000, 0x3e9e0000, 0x3f4f3f16, 0xbf4fbf73, 0xbe9ebf16
.long 0x3f160000, 0x3f733f73, 0xbf73bf16, 0xbf16bf73, 0x3f4f0000, 0x3e9e3f73, 0xbe9e3f16, 0xbf4fbf73
.long 0x3f730000, 0xbf163f16, 0x3f163f73, 0xbf73bf16, 0x00000000, 0x00000000, 0x00000000, 0x00000000
.long 0x00000000, 0x00000000, 0x00000000, 0x00000000, 0x00000000, 0x00000000, 0x00000000, 0x00000000
.long 0x00000000, 0x00000000, 0x00000000, 0x00000000, 0x00000000, 0x00000000, 0x00000000, 0x00000000
.long 0x00000000, 0x00000000, 0x00000000, 0x00000000, 0x00000000, 0x00000000, 0x00000000, 0x00000000
.long 0x00000000, 0x00000000, 0x00000000, 0x00000000, 0x00000000, 0x00000000, 0x00000000, 0x00000000
.long 0x00000000, 0x00000000, 0x00000000, 0x00000000, 0x00000000, 0x00000000, 0x00000000, 0x00000000
.long 0x00000000, 0x00000000, 0x00000000, 0x00000000, 0x3f803f73, 0x3f4f3f73, 0x00000000, 0x00000000
.long 0x250d3f16, 0xbf73bf16, 0x00000000, 0x00000000, 0xbf80bf16, 0x3e9ebf16, 0x00000000, 0x00000000
.long 0x0000bf73, 0x3f163f73, 0x00000000, 0x00000000, 0x00000000, 0x00000000, 0x00000000, 0x00000000
.long 0x00000000, 0x00000000, 0x00000000, 0x00000000, 0x00000000, 0x00000000, 0x00000000, 0x00000000
.long 0x00000000, 0x00000000, 0x00000000, 0x00000000, 0x00000000, 0x00000000, 0x00000000, 0x00000000
.long 0x00000000, 0x00000000, 0x00000000, 0x00000000, 0x00000000, 0x00000000, 0x00000000, 0x00000000
.long 0x00000000, 0x00000000, 0x00000000, 0x00000000, 0x00000000, 0x00000000, 0x00000000, 0x00000000
.long 0x00000000, 0x00000000, 0x00000000, 0x00000000, 0x00000000, 0x00000000, 0x00000000, 0x00000000
.long 0x00000000, 0x00000000, 0x00000000, 0x00000000, 0x3e9e3f16, 0xbe9e250d, 0x00000000, 0x00000000
.long 0xbf16bf73, 0x3f160000, 0x00000000, 0x00000000, 0x3f4f3f73, 0xbf4f250d, 0x00000000, 0x00000000
.long 0xbf73bf16, 0x3f730000, 0x00000000, 0x00000000, 0x00000000, 0x00000000, 0x00000000, 0x00000000
.long 0x00000000, 0x00000000, 0x00000000, 0x00000000, 0x00000000, 0x00000000, 0x00000000, 0x00000000
.long 0x00000000, 0x00000000, 0x00000000, 0x00000000, 0x00000000, 0x00000000, 0x00000000, 0x00000000
.long 0x00000000, 0x00000000, 0x00000000, 0x00000000, 0x00000000, 0x00000000, 0x00000000, 0x00000000
.long 0x00000000, 0x00000000, 0x00000000, 0x00000000, 0x00000000, 0x00000000, 0x00000000, 0x00000000
.long 0x00000000, 0x00000000, 0x00000000, 0x00000000, 0x00000000, 0x00000000, 0x00000000, 0x00000000
.long 0x00000000, 0x00000000, 0x00000000, 0x00000000, 0xbf4fbf16, 0xbf80bf73, 0x00000000, 0x00000000
.long 0x3f733f73, 0x250d3f16, 0x00000000, 0x00000000, 0xbe9ebf73, 0x3f803f16, 0x00000000, 0x00000000
.long 0xbf163f16, 0x0000bf73, 0x00000000, 0x00000000, 0x00000000, 0x00000000, 0x00000000, 0x00000000
.long 0x00000000, 0x00000000, 0x00000000, 0x00000000, 0x00000000, 0x00000000, 0x00000000, 0x00000000
.long 0x00000000, 0x00000000, 0x00000000, 0x00000000, 0x00000000, 0x00000000, 0x00000000, 0x00000000
.long 0x00000000, 0x00000000, 0x00000000, 0x00000000, 0x00000000, 0x00000000, 0x00000000, 0x00000000
.long 0x00000000, 0x00000000, 0x00000000, 0x00000000, 0x00000000, 0x00000000, 0x00000000, 0x00000000
.long 0x00000000, 0x00000000, 0x00000000, 0x00000000, 0x00000000, 0x00000000, 0x00000000, 0x00000000
.long 0x80008000, 0x80008000, 0x80008000, 0x80008000, 0xbe9e8000, 0xbf4fbf16, 0x3f4f3f73, 0x3e9e3f16
.long 0xbf168000, 0xbf73bf73, 0x3f733f16, 0x3f163f73, 0xbf4f8000, 0xbe9ebf73, 0x3e9ebf16, 0x3f4f3f73
.long 0xbf738000, 0x3f16bf16, 0xbf16bf73, 0x3f733f16, 0x00000000, 0x00000000, 0x00000000, 0x00000000
.long 0x00000000, 0x00000000, 0x00000000, 0x00000000, 0x00000000, 0x00000000, 0x00000000, 0x00000000
.long 0x00000000, 0x00000000, 0x00000000, 0x00000000, 0x00000000, 0x00000000, 0x00000000, 0x00000000
.long 0x00000000, 0x00000000, 0x00000000, 0x00000000, 0x00000000, 0x00000000, 0x00000000, 0x00000000
.long 0x00000000, 0x00000000, 0x00000000, 0x00000000, 0x00000000, 0x00000000, 0x00000000, 0x00000000
.long 0x00000000, 0x00000000, 0x00000000, 0x00000000, 0x00000000, 0x00000000, 0x00000000, 0x00000000
.long 0x80008000, 0x80008000, 0x00000000, 0x00000000, 0xbf80bf73, 0xbf4fbf73, 0x00000000, 0x00000000
.long 0xa50dbf16, 0x3f733f16, 0x00000000, 0x00000000, 0x3f803f16, 0xbe9e3f16, 0x00000000, 0x00000000
.long 0x80003f73, 0xbf16bf73, 0x00000000, 0x00000000, 0x00000000, 0x00000000, 0x00000000, 0x00000000
.long 0x00000000, 0x00000000, 0x00000000, 0x00000000, 0x00000000, 0x00000000, 0x00000000, 0x00000000
.long 0x00000000, 0x00000000, 0x00000000, 0x00000000, 0x00000000, 0x00000000, 0x00000000, 0x00000000
.long 0x00000000, 0x00000000, 0x00000000, 0x00000000, 0x00000000, 0x00000000, 0x00000000, 0x00000000
.long 0x00000000, 0x00000000, 0x00000000, 0x00000000, 0x00000000, 0x00000000, 0x00000000, 0x00000000
.long 0x00000000, 0x00000000, 0x00000000, 0x00000000, 0x00000000, 0x00000000, 0x00000000, 0x00000000
.long 0x80008000, 0x80008000, 0x00000000, 0x00000000, 0xbe9ebf16, 0x3e9ea50d, 0x00000000, 0x00000000
.long 0x3f163f73, 0xbf168000, 0x00000000, 0x00000000, 0xbf4fbf73, 0x3f4fa50d, 0x00000000, 0x00000000
.long 0x3f733f16, 0xbf738000, 0x00000000, 0x00000000, 0x00000000, 0x00000000, 0x00000000, 0x00000000
.long 0x00000000, 0x00000000, 0x00000000, 0x00000000, 0x00000000, 0x00000000, 0x00000000, 0x00000000
.long 0x00000000, 0x00000000, 0x00000000, 0x00000000, 0x00000000, 0x00000000, 0x00000000, 0x00000000
.long 0x00000000, 0x00000000, 0x00000000, 0x00000000, 0x00000000, 0x00000000, 0x00000000, 0x00000000
.long 0x00000000, 0x00000000, 0x00000000, 0x00000000, 0x00000000, 0x00000000, 0x00000000, 0x00000000
.long 0x00000000, 0x00000000, 0x00000000, 0x00000000, 0x00000000, 0x00000000, 0x00000000, 0x00000000
.long 0x80008000, 0x80008000, 0x00000000, 0x00000000, 0x3f4f3f16, 0x3f803f73, 0x00000000, 0x00000000
.long 0xbf73bf73, 0xa50dbf16, 0x00000000, 0x00000000, 0x3e9e3f73, 0xbf80bf16, 0x00000000, 0x00000000
.long 0x3f16bf16, 0x80003f73, 0x00000000, 0x00000000, 0x00000000, 0x00000000, 0x00000000, 0x00000000
.long 0x00000000, 0x00000000, 0x00000000, 0x00000000, 0x00000000, 0x00000000, 0x00000000, 0x00000000
.long 0x00000000, 0x00000000, 0x00000000, 0x00000000, 0x00000000, 0x00000000, 0x00000000, 0x00000000
.long 0x00000000, 0x00000000, 0x00000000, 0x00000000, 0x00000000, 0x00000000, 0x00000000, 0x00000000
.long 0x00000000, 0x00000000, 0x00000000, 0x00000000, 0x00000000, 0x00000000, 0x00000000, 0x00000000
.long 0x00000000, 0x00000000, 0x00000000, 0x00000000, 0x00000000, 0x00000000, 0x00000000, 0x00000000
.long 0x248d3f80, 0xa554bf80, 0x248d3f80, 0xa554bf80, 0xbe9e3f80, 0x3f4fbf4f, 0x3f4f3e9e, 0xbe9ebf4f
.long 0xbf163f80, 0x3f73be9e, 0x3f73bf4f, 0xbf16be9e, 0xbf4f3f80, 0x3e9e3e9e, 0x3e9ebf4f, 0xbf4f3e9e
.long 0xbf733f80, 0xbf163f4f, 0xbf163e9e, 0xbf733f4f, 0x00000000, 0x00000000, 0x00000000, 0x00000000
.long 0x00000000, 0x00000000, 0x00000000, 0x00000000, 0x00000000, 0x00000000, 0x00000000, 0x00000000
.long 0x00000000, 0x00000000, 0x00000000, 0x00000000, 0x00000000, 0x00000000, 0x00000000, 0x00000000
.long 0x00000000, 0x00000000, 0x00000000, 0x00000000, 0x00000000, 0x00000000, 0x00000000, 0x00000000
.long 0x00000000, 0x00000000, 0x00000000, 0x00000000, 0x00000000, 0x00000000, 0x00000000, 0x00000000
.long 0x00000000, 0x00000000, 0x00000000, 0x00000000, 0x00000000, 0x00000000, 0x00000000, 0x00000000
.long 0x248d3f80, 0xa554bf80, 0x00000000, 0x00000000, 0xbf803e9e, 0x3f4f3e9e, 0x00000000, 0x00000000
.long 0xa554bf4f, 0xbf733f4f, 0x00000000, 0x00000000, 0x3f80bf4f, 0x3e9ebf4f, 0x00000000, 0x00000000
.long 0x248d3e9e, 0x3f16be9e, 0x00000000, 0x00000000, 0x00000000, 0x00000000, 0x00000000, 0x00000000
.long 0x00000000, 0x00000000, 0x00000000, 0x00000000, 0x00000000, 0x00000000, 0x00000000, 0x00000000
.long 0x00000000, 0x00000000, 0x00000000, 0x00000000, 0x00000000, 0x00000000, 0x00000000, 0x00000000
.long 0x00000000, 0x00000000, 0x00000000, 0x00000000, 0x00000000, 0x00000000, 0x00000000, 0x00000000
.long 0x00000000, 0x00000000, 0x00000000, 0x00000000, 0x00000000, 0x00000000, 0x00000000, 0x00000000
.long 0x00000000, 0x00000000, 0x00000000, 0x00000000, 0x00000000, 0x00000000, 0x00000000, 0x00000000
.long 0x248d3f80, 0xa554bf80, 0x00000000, 0x00000000, 0xbe9ebf4f, 0xbe9e3f80, 0x00000000, 0x00000000
.long 0x3f163e9e, 0x3f16bf80, 0x00000000, 0x00000000, 0xbf4f3e9e, 0xbf4f3f80, 0x00000000, 0x00000000
.long 0x3f73bf4f, 0x3f73bf80, 0x00000000, 0x00000000, 0x00000000, 0x00000000, 0x00000000, 0x00000000
.long 0x00000000, 0x00000000, 0x00000000, 0x00000000, 0x00000000, 0x00000000, 0x00000000, 0x00000000
.long 0x00000000, 0x00000000, 0x00000000, 0x00000000, 0x00000000, 0x00000000, 0x00000000, 0x00000000
.long 0x00000000, 0x00000000, 0x00000000, 0x00000000, 0x00000000, 0x00000000, 0x00000000, 0x00000000
.long 0x00000000, 0x00000000, 0x00000000, 0x00000000, 0x00000000, 0x00000000, 0x00000000, 0x00000000
.long 0x00000000, 0x00000000, 0x00000000, 0x00000000, 0x00000000, 0x00000000, 0x00000000, 0x00000000
.long 0x248d3f80, 0xa554bf80, 0x00000000, 0x00000000, 0x3f4fbf4f, 0xbf803e9e, 0x00000000, 0x00000000
.long 0xbf733e9e, 0x248d3f4f, 0x00000000, 0x00000000, 0x3e9e3e9e, 0x3f80bf4f, 0x00000000, 0x00000000
.long 0x3f16bf4f, 0xa554be9e, 0x00000000, 0x00000000, 0x00000000, 0x00000000, 0x00000000, 0x00000000
.long 0x00000000, 0x00000000, 0x00000000, 0x00000000, 0x00000000, 0x00000000, 0x00000000, 0x00000000
.long 0x00000000, 0x00000000, 0x00000000, 0x00000000, 0x00000000, 0x00000000, 0x00000000, 0x00000000
.long 0x00000000, 0x00000000, 0x00000000, 0x00000000, 0x00000000, 0x00000000, 0x00000000, 0x00000000
.long 0x00000000, 0x00000000, 0x00000000, 0x00000000, 0x00000000, 0x00000000, 0x00000000, 0x00000000
.long 0x00000000, 0x00000000, 0x00000000, 0x00000000, 0x00000000, 0x00000000, 0x00000000, 0x00000000
.long 0x3f800000, 0xbf80250d, 0x3f800000, 0xbf80250d, 0x3f730000, 0xbf16bf16, 0x3f16bf73, 0xbf733f16
.long 0x3f4f0000, 0x3e9ebf73, 0xbe9ebf16, 0xbf4f3f73, 0x3f160000, 0x3f73bf73, 0xbf733f16, 0xbf163f73
.long 0x3e9e0000, 0x3f4fbf16, 0xbf4f3f73, 0xbe9e3f16, 0x00000000, 0x00000000, 0x00000000, 0x00000000
.long 0x00000000, 0x00000000, 0x00000000, 0x00000000, 0x00000000, 0x00000000, 0x00000000, 0x00000000
.long 0x00000000, 0x00000000, 0x00000000, 0x00000000, 0x00000000, 0x00000000, 0x00000000, 0x00000000
.long 0x00000000, 0x00000000, 0x00000000, 0x00000000, 0x00000000, 0x00000000, 0x00000000, 0x00000000
.long 0x00000000, 0x00000000, 0x00000000, 0x00000000, 0x00000000, 0x00000000, 0x00000000, 0x00000000
.long 0x00000000, 0x00000000, 0x00000000, 0x00000000, 0x00000000, 0x00000000, 0x00000000, 0x00000000
.long 0x3f800000, 0xbf80250d, 0x00000000, 0x00000000, 0x250d3f73, 0x3f16bf73, 0x00000000, 0x00000000
.long 0xbf803f16, 0x3e9e3f16, 0x00000000, 0x00000000, 0x0000bf16, 0xbf733f16, 0x00000000, 0x00000000
.long 0x3f80bf73, 0x3f4fbf73, 0x00000000, 0x00000000, 0x00000000, 0x00000000, 0x00000000, 0x00000000
.long 0x00000000, 0x00000000, 0x00000000, 0x00000000, 0x00000000, 0x00000000, 0x00000000, 0x00000000
.long 0x00000000, 0x00000000, 0x00000000, 0x00000000, 0x00000000, 0x00000000, 0x00000000, 0x00000000
.long 0x00000000, 0x00000000, 0x00000000, 0x00000000, 0x00000000, 0x00000000, 0x00000000, 0x00000000
.long 0x00000000, 0x00000000, 0x00000000, 0x00000000, 0x00000000, 0x00000000, 0x00000000, 0x00000000
.long 0x00000000, 0x00000000, 0x00000000, 0x00000000, 0x00000000, 0x00000000, 0x00000000, 0x00000000
.long 0x3f800000, 0xbf80250d, 0x00000000, 0x00000000, 0xbf733f16, 0x3f730000, 0x00000000, 0x00000000
.long 0x3f4fbf73, 0xbf4f250d, 0x00000000, 0x00000000, 0xbf163f73, 0x3f160000, 0x00000000, 0x00000000
.long 0x3e9ebf16, 0xbe9e250d, 0x00000000, 0x00000000, 0x00000000, 0x00000000, 0x00000000, 0x00000000
.long 0x00000000, 0x00000000, 0x00000000, 0x00000000, 0x00000000, 0x00000000, 0x00000000, 0x00000000
.long 0x00000000, 0x00000000, 0x00000000, 0x00000000, 0x00000000, 0x00000000, 0x00000000, 0x00000000
.long 0x00000000, 0x00000000, 0x00000000, 0x00000000, 0x00000000, 0x00000000, 0x00000000, 0x00000000
.long 0x00000000, 0x00000000, 0x00000000, 0x00000000, 0x00000000, 0x00000000, 0x00000000, 0x00000000
.long 0x00000000, 0x00000000, 0x00000000, 0x00000000, 0x00000000, 0x00000000, 0x00000000, 0x00000000
.long 0x3f800000, 0xbf80250d, 0x00000000, 0x00000000, 0xbf16bf16, 0x250d3f73, 0x00000000, 0x00000000
.long 0xbe9e3f73, 0x3f80bf16, 0x00000000, 0x00000000, 0x3f73bf73, 0x0000bf16, 0x00000000, 0x00000000
.long 0xbf4f3f16, 0xbf803f73, 0x00000000, 0x00000000, 0x00000000, 0x00000000, 0x00000000, 0x00000000
.long 0x00000000, 0x00000000, 0x00000000, 0x00000000, 0x00000000, 0x00000000, 0x00000000, 0x00000000
.long 0x00000000, 0x00000000, 0x00000000, 0x00000000, 0x00000000, 0x00000000, 0x00000000, 0x00000000
.long 0x00000000, 0x00000000, 0x00000000, 0x00000000, 0x00000000, 0x00000000, 0x00000000, 0x00000000
.long 0x00000000, 0x00000000, 0x00000000, 0x00000000, 0x00000000, 0x00000000, 0x00000000, 0x00000000
.long 0x00000000, 0x00000000, 0x00000000, 0x00000000, 0x00000000, 0x00000000, 0x00000000, 0x00000000
.long 0xbf808000, 0x3f80a50d, 0xbf808000, 0x3f80a50d, 0xbf738000, 0x3f163f16, 0xbf163f73, 0x3f73bf16
.long 0xbf4f8000, 0xbe9e3f73, 0x3e9e3f16, 0x3f4fbf73, 0xbf168000, 0xbf733f73, 0x3f73bf16, 0x3f16bf73
.long 0xbe9e8000, 0xbf4f3f16, 0x3f4fbf73, 0x3e9ebf16, 0x00000000, 0x00000000, 0x00000000, 0x00000000
.long 0x00000000, 0x00000000, 0x00000000, 0x00000000, 0x00000000, 0x00000000, 0x00000000, 0x00000000
.long 0x00000000, 0x00000000, 0x00000000, 0x00000000, 0x00000000, 0x00000000, 0x00000000, 0x00000000
.long 0x00000000, 0x00000000, 0x00000000, 0x00000000, 0x00000000, 0x00000000, 0x00000000, 0x00000000
.long 0x00000000, 0x00000000, 0x00000000, 0x00000000, 0x00000000, 0x00000000, 0x00000000, 0x00000000
.long 0x00000000, 0x00000000, 0x00000000, 0x00000000, 0x00000000, 0x00000000, 0x00000000, 0x00000000
.long 0xbf808000, 0x3f80a50d, 0x00000000, 0x00000000, 0xa50dbf73, 0xbf163f73, 0x00000000, 0x00000000
.long 0x3f80bf16, 0xbe9ebf16, 0x00000000, 0x00000000, 0x80003f16, 0x3f73bf16, 0x00000000, 0x00000000
.long 0xbf803f73, 0xbf4f3f73, 0x00000000, 0x00000000, 0x00000000, 0x00000000, 0x00000000, 0x00000000
.long 0x00000000, 0x00000000, 0x00000000, 0x00000000, 0x00000000, 0x00000000, 0x00000000, 0x00000000
.long 0x00000000, 0x00000000, 0x00000000, 0x00000000, 0x00000000, 0x00000000, 0x00000000, 0x00000000
.long 0x00000000, 0x00000000, 0x00000000, 0x00000000, 0x00000000, 0x00000000, 0x00000000, 0x00000000
.long 0x00000000, 0x00000000, 0x00000000, 0x00000000, 0x00000000, 0x00000000, 0x00000000, 0x00000000
.long 0x00000000, 0x00000000, 0x00000000, 0x00000000, 0x00000000, 0x00000000, 0x00000000, 0x00000000
.long 0xbf808000, 0x3f80a50d, 0x00000000, 0x00000000, 0x3f73bf16, 0xbf738000, 0x00000000, 0x00000000
.long 0xbf4f3f73, 0x3f4fa50d, 0x00000000, 0x00000000, 0x3f16bf73, 0xbf168000, 0x00000000, 0x00000000
.long 0xbe9e3f16, 0x3e9ea50d, 0x00000000, 0x00000000, 0x00000000, 0x00000000, 0x00000000, 0x00000000
.long 0x00000000, 0x00000000, 0x00000000, 0x00000000, 0x00000000, 0x00000000, 0x00000000, 0x00000000
.long 0x00000000, 0x00000000, 0x00000000, 0x00000000, 0x00000000, 0x00000000, 0x00000000, 0x00000000
.long 0x00000000, 0x00000000, 0x00000000, 0x00000000, 0x00000000, 0x00000000, 0x00000000, 0x00000000
.long 0x00000000, 0x00000000, 0x00000000, 0x00000000, 0x00000000, 0x00000000, 0x00000000, 0x00000000
.long 0x00000000, 0x00000000, 0x00000000, 0x00000000, 0x00000000, 0x00000000, 0x00000000, 0x00000000
.long 0xbf808000, 0x3f80a50d, 0x00000000, 0x00000000, 0x3f163f16, 0xa50dbf73, 0x00000000, 0x00000000
.long 0x3e9ebf73, 0xbf803f16, 0x00000000, 0x00000000, 0xbf733f73, 0x80003f16, 0x00000000, 0x00000000
.long 0x3f4fbf16, 0x3f80bf73, 0x00000000, 0x00000000, 0x00000000, 0x00000000, 0x00000000, 0x00000000
.long 0x00000000, 0x00000000, 0x00000000, 0x00000000, 0x00000000, 0x00000000, 0x00000000, 0x00000000
.long 0x00000000, 0x00000000, 0x00000000, 0x00000000, 0x00000000, 0x00000000, 0x00000000, 0x00000000
.long 0x00000000, 0x00000000, 0x00000000, 0x00000000, 0x00000000, 0x00000000, 0x00000000, 0x00000000
.long 0x00000000, 0x00000000, 0x00000000, 0x00000000, 0x00000000, 0x00000000, 0x00000000, 0x00000000
.long 0x00000000, 0x00000000, 0x00000000, 0x00000000, 0x00000000, 0x00000000, 0x00000000, 0x00000000
.long 0xbf803f80, 0xbf803f80, 0xbf803f80, 0xbf803f80, 0xbf733f80, 0xbf163f4f, 0xbf163e9e, 0xbf733f4f
.long 0xbf4f3f80, 0x3e9e3e9e, 0x3e9ebf4f, 0xbf4f3e9e, 0xbf163f80, 0x3f73be9e, 0x3f73bf4f, 0xbf16be9e
.long 0xbe9e3f80, 0x3f4fbf4f, 0x3f4f3e9e, 0xbe9ebf4f, 0x00000000, 0x00000000, 0x00000000, 0x00000000
.long 0x00000000, 0x00000000, 0x00000000, 0x00000000, 0x00000000, 0x00000000, 0x00000000, 0x00000000
.long 0x00000000, 0x00000000, 0x00000000, 0x00000000, 0x00000000, 0x00000000, 0x00000000, 0x00000000
.long 0x00000000, 0x00000000, 0x00000000, 0x00000000, 0x00000000, 0x00000000, 0x00000000, 0x00000000
.long 0x00000000, 0x00000000, 0x00000000, 0x00000000, 0x00000000, 0x00000000, 0x00000000, 0x00000000
.long 0x00000000, 0x00000000, 0x00000000, 0x00000000, 0x00000000, 0x00000000, 0x00000000, 0x00000000
.long 0xbf803f80, 0xbf803f80, 0x00000000, 0x00000000, 0xa5543e9e, 0x3f16be9e, 0x00000000, 0x00000000
.long 0x3f80bf4f, 0x3e9ebf4f, 0x00000000, 0x00000000, 0x248dbf4f, 0xbf733f4f, 0x00000000, 0x00000000
.long 0xbf803e9e, 0x3f4f3e9e, 0x00000000, 0x00000000, 0x00000000, 0x00000000, 0x00000000, 0x00000000
.long 0x00000000, 0x00000000, 0x00000000, 0x00000000, 0x00000000, 0x00000000, 0x00000000, 0x00000000
.long 0x00000000, 0x00000000, 0x00000000, 0x00000000, 0x00000000, 0x00000000, 0x00000000, 0x00000000
.long 0x00000000, 0x00000000, 0x00000000, 0x00000000, 0x00000000, 0x00000000, 0x00000000, 0x00000000
.long 0x00000000, 0x00000000, 0x00000000, 0x00000000, 0x00000000, 0x00000000, 0x00000000, 0x00000000
.long 0x00000000, 0x00000000, 0x00000000, 0x00000000, 0x00000000, 0x00000000, 0x00000000, 0x00000000
.long 0xbf803f80, 0xbf803f80, 0x00000000, 0x00000000, 0x3f73bf4f, 0x3f73bf80, 0x00000000, 0x00000000
.long 0xbf4f3e9e, 0xbf4f3f80, 0x00000000, 0x00000000, 0x3f163e9e, 0x3f16bf80, 0x00000000, 0x00000000
.long 0xbe9ebf4f, 0xbe9e3f80, 0x00000000, 0x00000000, 0x00000000, 0x00000000, 0x00000000, 0x00000000
.long 0x00000000, 0x00000000, 0x00000000, 0x00000000, 0x00000000, 0x00000000, 0x00000000, 0x00000000
.long 0x00000000, 0x00000000, 0x00000000, 0x00000000, 0x00000000, 0x00000000, 0x00000000, 0x00000000
.long 0x00000000, 0x00000000, 0x00000000, 0x00000000, 0x00000000, 0x00000000, 0x00000000, 0x00000000
.long 0x00000000, 0x00000000, 0x00000000, 0x00000000, 0x00000000, 0x00000000, 0x00000000, 0x00000000
.long 0x00000000, 0x00000000, 0x00000000, 0x00000000, 0x00000000, 0x00000000, 0x00000000, 0x00000000
.long 0xbf803f80, 0xbf803f80, 0x00000000, 0x00000000, 0x3f16bf4f, 0x248dbe9e, 0x00000000, 0x00000000
.long 0x3e9e3e9e, 0x3f80bf4f, 0x00000000, 0x00000000, 0xbf733e9e, 0xa5543f4f, 0x00000000, 0x00000000
.long 0x3f4fbf4f, 0xbf803e9e, 0x00000000, 0x00000000, 0x00000000, 0x00000000, 0x00000000, 0x00000000
.long 0x00000000, 0x00000000, 0x00000000, 0x00000000, 0x00000000, 0x00000000, 0x00000000, 0x00000000
.long 0x00000000, 0x00000000, 0x00000000, 0x00000000, 0x00000000, 0x00000000, 0x00000000, 0x00000000
.long 0x00000000, 0x00000000, 0x00000000, 0x00000000, 0x00000000, 0x00000000, 0x00000000, 0x00000000
.long 0x00000000, 0x00000000, 0x00000000, 0x00000000, 0x00000000, 0x00000000, 0x00000000, 0x00000000
.long 0x00000000, 0x00000000, 0x00000000, 0x00000000, 0x00000000, 0x00000000, 0x00000000, 0x00000000
.long 0x250d0000, 0x250d0000, 0x250d0000, 0x250d0000, 0xbe9e0000, 0xbf4f3f16, 0x3f4fbf73, 0x3e9ebf16
.long 0xbf160000, 0xbf733f73, 0x3f73bf16, 0x3f16bf73, 0xbf4f0000, 0xbe9e3f73, 0x3e9e3f16, 0x3f4fbf73
.long 0xbf730000, 0x3f163f16, 0xbf163f73, 0x3f73bf16, 0x00000000, 0x00000000, 0x00000000, 0x00000000
.long 0x00000000, 0x00000000, 0x00000000, 0x00000000, 0x00000000, 0x00000000, 0x00000000, 0x00000000
.long 0x00000000, 0x00000000, 0x00000000, 0x00000000, 0x00000000, 0x00000000, 0x00000000, 0x00000000
.long 0x00000000, 0x00000000, 0x00000000, 0x00000000, 0x00000000, 0x00000000, 0x00000000, 0x00000000
.long 0x00000000, 0x00000000, 0x00000000, 0x00000000, 0x00000000, 0x00000000, 0x00000000, 0x00000000
.long 0x00000000, 0x00000000, 0x00000000, 0x00000000, 0x00000000, 0x00000000, 0x00000000, 0x00000000
.long 0x250d0000, 0x250d0000, 0x00000000, 0x00000000, 0xbf803f73, 0xbf4f3f73, 0x00000000, 0x00000000
.long 0x00003f16, 0x3f73bf16, 0x00000000, 0x00000000, 0x3f80bf16, 0xbe9ebf16, 0x00000000, 0x00000000
.long 0x250dbf73, 0xbf163f73, 0x00000000, 0x00000000, 0x00000000, 0x00000000, 0x00000000, 0x00000000
.long 0x00000000, 0x00000000, 0x00000000, 0x00000000, 0x00000000, 0x00000000, 0x00000000, 0x00000000
.long 0x00000000, 0x00000000, 0x00000000, 0x00000000, 0x00000000, 0x00000000, 0x00000000, 0x00000000
.long 0x00000000, 0x00000000, 0x00000000, 0x00000000, 0x00000000, 0x00000000, 0x00000000, 0x00000000
.long 0x00000000, 0x00000000, 0x00000000, 0x00000000, 0x00000000, 0x00000000, 0x00000000, 0x00000000
.long 0x00000000, 0x00000000, 0x00000000, 0x00000000, 0x00000000, 0x00000000, 0x00000000, 0x00000000
.long 0x250d0000, 0x250d0000, 0x00000000, 0x00000000, 0xbe9e3f16, 0x3e9e250d, 0x00000000, 0x00000000
.long 0x3f16bf73, 0xbf160000, 0x00000000, 0x00000000, 0xbf4f3f73, 0x3f4f250d, 0x00000000, 0x00000000
.long 0x3f73bf16, 0xbf730000, 0x00000000, 0x00000000, 0x00000000, 0x00000000, 0x00000000, 0x00000000
.long 0x00000000, 0x00000000, 0x00000000, 0x00000000, 0x00000000, 0x00000000, 0x00000000, 0x00000000
.long 0x00000000, 0x00000000, 0x00000000, 0x00000000, 0x00000000, 0x00000000, 0x00000000, 0x00000000
.long 0x00000000, 0x00000000, 0x00000000, 0x00000000, 0x00000000, 0x00000000, 0x00000000, 0x00000000
.long 0x00000000, 0x00000000, 0x00000000, 0x00000000, 0x00000000, 0x00000000, 0x00000000, 0x00000000
.long 0x00000000, 0x00000000, 0x00000000, 0x00000000, 0x00000000, 0x00000000, 0x00000000, 0x00000000
.long 0x250d0000, 0x250d0000, 0x00000000, 0x00000000, 0x3f4fbf16, 0x3f80bf73, 0x00000000, 0x00000000
.long 0xbf733f73, 0x00003f16, 0x00000000, 0x00000000, 0x3e9ebf73, 0xbf803f16, 0x00000000, 0x00000000
.long 0x3f163f16, 0x250dbf73, 0x00000000, 0x00000000, 0x00000000, 0x00000000, 0x00000000, 0x00000000
.long 0x00000000, 0x00000000, 0x00000000, 0x00000000, 0x00000000, 0x00000000, 0x00000000, 0x00000000
.long 0x00000000, 0x00000000, 0x00000000, 0x00000000, 0x00000000, 0x00000000, 0x00000000, 0x00000000
.long 0x00000000, 0x00000000, 0x00000000, 0x00000000, 0x00000000, 0x00000000, 0x00000000, 0x00000000
.long 0x00000000, 0x00000000, 0x00000000, 0x00000000, 0x00000000, 0x00000000, 0x00000000, 0x00000000
.long 0x00000000, 0x00000000, 0x00000000, 0x00000000, 0x00000000, 0x00000000, 0x00000000, 0x00000000
.long 0xa50d8000, 0xa50d8000, 0xa50d8000, 0xa50d8000, 0x3e9e8000, 0x3f4fbf16, 0xbf4f3f73, 0xbe9e3f16
.long 0x3f168000, 0x3f73bf73, 0xbf733f16, 0xbf163f73, 0x3f4f8000, 0x3e9ebf73, 0xbe9ebf16, 0xbf4f3f73
.long 0x3f738000, 0xbf16bf16, 0x3f16bf73, 0xbf733f16, 0x00000000, 0x00000000, 0x00000000, 0x00000000
.long 0x00000000, 0x00000000, 0x00000000, 0x00000000, 0x00000000, 0x00000000, 0x00000000, 0x00000000
.long 0x00000000, 0x00000000, 0x00000000, 0x00000000, 0x00000000, 0x00000000, 0x00000000, 0x00000000
.long 0x00000000, 0x00000000, 0x00000000, 0x00000000, 0x00000000, 0x00000000, 0x00000000, 0x00000000
.long 0x00000000, 0x00000000, 0x00000000, 0x00000000, 0x00000000, 0x00000000, 0x00000000, 0x00000000
.long 0x00000000, 0x00000000, 0x00000000, 0x00000000, 0x00000000, 0x00000000, 0x00000000, 0x00000000
.long 0xa50d8000, 0xa50d8000, 0x00000000, 0x00000000, 0x3f80bf73, 0x3f4fbf73, 0x00000000, 0x00000000
.long 0x8000bf16, 0xbf733f16, 0x00000000, 0x00000000, 0xbf803f16, 0x3e9e3f16, 0x00000000, 0x00000000
.long 0xa50d3f73, 0x3f16bf73, 0x00000000, 0x00000000, 0x00000000, 0x00000000, 0x00000000, 0x00000000
.long 0x00000000, 0x00000000, 0x00000000, 0x00000000, 0x00000000, 0x00000000, 0x00000000, 0x00000000
.long 0x00000000, 0x00000000, 0x00000000, 0x00000000, 0x00000000, 0x00000000, 0x00000000, 0x00000000
.long 0x00000000, 0x00000000, 0x00000000, 0x00000000, 0x00000000, 0x00000000, 0x00000000, 0x00000000
.long 0x00000000, 0x00000000, 0x00000000, 0x00000000, 0x00000000, 0x00000000, 0x00000000, 0x00000000
.long 0x00000000, 0x00000000, 0x00000000, 0x00000000, 0x00000000, 0x00000000, 0x00000000, 0x00000000
.long 0xa50d8000, 0xa50d8000, 0x00000000, 0x00000000, 0x3e9ebf16, 0xbe9ea50d, 0x00000000, 0x00000000
.long 0xbf163f73, 0x3f168000, 0x00000000, 0x00000000, 0x3f4fbf73, 0xbf4fa50d, 0x00000000, 0x00000000
.long 0xbf733f16, 0x3f738000, 0x00000000, 0x00000000, 0x00000000, 0x00000000, 0x00000000, 0x00000000
.long 0x00000000, 0x00000000, 0x00000000, 0x00000000, 0x00000000, 0x00000000, 0x00000000, 0x00000000
.long 0x00000000, 0x00000000, 0x00000000, 0x00000000, 0x00000000, 0x00000000, 0x00000000, 0x00000000
.long 0x00000000, 0x00000000, 0x00000000, 0x00000000, 0x00000000, 0x00000000, 0x00000000, 0x00000000
.long 0x00000000, 0x00000000, 0x00000000, 0x00000000, 0x00000000, 0x00000000, 0x00000000, 0x00000000
.long 0x00000000, 0x00000000, 0x00000000, 0x00000000, 0x00000000, 0x00000000, 0x00000000, 0x00000000
.long 0xa50d8000, 0xa50d8000, 0x00000000, 0x00000000, 0xbf4f3f16, 0xbf803f73, 0x00000000, 0x00000000
.long 0x3f73bf73, 0x8000bf16, 0x00000000, 0x00000000, 0xbe9e3f73, 0x3f80bf16, 0x00000000, 0x00000000
.long 0xbf16bf16, 0xa50d3f73, 0x00000000, 0x00000000, 0x00000000, 0x00000000, 0x00000000, 0x00000000
.long 0x00000000, 0x00000000, 0x00000000, 0x00000000, 0x00000000, 0x00000000, 0x00000000, 0x00000000
.long 0x00000000, 0x00000000, 0x00000000, 0x00000000, 0x00000000, 0x00000000, 0x00000000, 0x00000000
.long 0x00000000, 0x00000000, 0x00000000, 0x00000000, 0x00000000, 0x00000000, 0x00000000, 0x00000000
.long 0x00000000, 0x00000000, 0x00000000, 0x00000000, 0x00000000, 0x00000000, 0x00000000, 0x00000000
.long 0x00000000, 0x00000000, 0x00000000, 0x00000000, 0x00000000, 0x00000000, 0x00000000, 0x00000000
.long 0xa5543f80, 0x248dbf80, 0xa5543f80, 0x248dbf80, 0x3e9e3f80, 0xbf4fbf4f, 0xbf4f3e9e, 0x3e9ebf4f
.long 0x3f163f80, 0xbf73be9e, 0xbf73bf4f, 0x3f16be9e, 0x3f4f3f80, 0xbe9e3e9e, 0xbe9ebf4f, 0x3f4f3e9e
.long 0x3f733f80, 0x3f163f4f, 0x3f163e9e, 0x3f733f4f, 0x00000000, 0x00000000, 0x00000000, 0x00000000
.long 0x00000000, 0x00000000, 0x00000000, 0x00000000, 0x00000000, 0x00000000, 0x00000000, 0x00000000
.long 0x00000000, 0x00000000, 0x00000000, 0x00000000, 0x00000000, 0x00000000, 0x00000000, 0x00000000
.long 0x00000000, 0x00000000, 0x00000000, 0x00000000, 0x00000000, 0x00000000, 0x00000000, 0x00000000
.long 0x00000000, 0x00000000, 0x00000000, 0x00000000, 0x00000000, 0x00000000, 0x00000000, 0x00000000
.long 0x00000000, 0x00000000, 0x00000000, 0x00000000, 0x00000000, 0x00000000, 0x00000000, 0x00000000
.long 0xa5543f80, 0x248dbf80, 0x00000000, 0x00000000, 0x3f803e9e, 0xbf4f3e9e, 0x00000000, 0x00000000
.long 0x248dbf4f, 0x3f733f4f, 0x00000000, 0x00000000, 0xbf80bf4f, 0xbe9ebf4f, 0x00000000, 0x00000000
.long 0xa5543e9e, 0xbf16be9e, 0x00000000, 0x00000000, 0x00000000, 0x00000000, 0x00000000, 0x00000000
.long 0x00000000, 0x00000000, 0x00000000, 0x00000000, 0x00000000, 0x00000000, 0x00000000, 0x00000000
.long 0x00000000, 0x00000000, 0x00000000, 0x00000000, 0x00000000, 0x00000000, 0x00000000, 0x00000000
.long 0x00000000, 0x00000000, 0x00000000, 0x00000000, 0x00000000, 0x00000000, 0x00000000, 0x00000000
.long 0x00000000, 0x00000000, 0x00000000, 0x00000000, 0x00000000, 0x00000000, 0x00000000, 0x00000000
.long 0x00000000, 0x00000000, 0x00000000, 0x00000000, 0x00000000, 0x00000000, 0x00000000, 0x00000000
.long 0xa5543f80, 0x248dbf80, 0x00000000, 0x00000000, 0x3e9ebf4f, 0x3e9e3f80, 0x00000000, 0x00000000
.long 0xbf163e9e, 0xbf16bf80, 0x00000000, 0x00000000, 0x3f4f3e9e, 0x3f4f3f80, 0x00000000, 0x00000000
.long 0xbf73bf4f, 0xbf73bf80, 0x00000000, 0x00000000, 0x00000000, 0x00000000, 0x00000000, 0x00000000
.long 0x00000000, 0x00000000, 0x00000000, 0x00000000, 0x00000000, 0x00000000, 0x00000000, 0x00000000
.long 0x00000000, 0x00000000, 0x00000000, 0x00000000, 0x00000000, 0x00000000, 0x00000000, 0x00000000
.long 0x00000000, 0x00000000, 0x00000000, 0x00000000, 0x00000000, 0x00000000, 0x00000000, 0x00000000
.long 0x00000000, 0x00000000, 0x00000000, 0x00000000, 0x00000000, 0x00000000, 0x00000000, 0x00000000
.long 0x00000000, 0x00000000, 0x00000000, 0x00000000, 0x00000000, 0x00000000, 0x00000000, 0x00000000
.long 0xa5543f80, 0x248dbf80, 0x00000000, 0x00000000, 0xbf4fbf4f, 0x3f803e9e, 0x00000000, 0x00000000
.long 0x3f733e9e, 0xa5543f4f, 0x00000000, 0x00000000, 0xbe9e3e9e, 0xbf80bf4f, 0x00000000, 0x00000000
.long 0xbf16bf4f, 0x248dbe9e, 0x00000000, 0x00000000, 0x00000000, 0x00000000, 0x00000000, 0x00000000
.long 0x00000000, 0x00000000, 0x00000000, 0x00000000, 0x00000000, 0x00000000, 0x00000000, 0x00000000
.long 0x00000000, 0x00000000, 0x00000000, 0x00000000, 0x00000000, 0x00000000, 0x00000000, 0x00000000
.long 0x00000000, 0x00000000, 0x00000000, 0x00000000, 0x00000000, 0x00000000, 0x00000000, 0x00000000
.long 0x00000000, 0x00000000, 0x00000000, 0x00000000, 0x00000000, 0x00000000, 0x00000000, 0x00000000
.long 0x00000000, 0x00000000, 0x00000000, 0x00000000, 0x00000000, 0x00000000, 0x00000000, 0x00000000
.long 0xbf800000, 0x3f80250d, 0xbf800000, 0x3f80250d, 0xbf730000, 0x3f16bf16, 0xbf16bf73, 0x3f733f16
.long 0xbf4f0000, 0xbe9ebf73, 0x3e9ebf16, 0x3f4f3f73, 0xbf160000, 0xbf73bf73, 0x3f733f16, 0x3f163f73
.long 0xbe9e0000, 0xbf4fbf16, 0x3f4f3f73, 0x3e9e3f16, 0x00000000, 0x00000000, 0x00000000, 0x00000000
.long 0x00000000, 0x00000000, 0x00000000, 0x00000000, 0x00000000, 0x00000000, 0x00000000, 0x00000000
.long 0x00000000, 0x00000000, 0x00000000, 0x00000000, 0x00000000, 0x00000000, 0x00000000, 0x00000000
.long 0x00000000, 0x00000000, 0x00000000, 0x00000000, 0x00000000, 0x00000000, 0x00000000, 0x00000000
.long 0x00000000, 0x00000000, 0x00000000, 0x00000000, 0x00000000, 0x00000000, 0x00000000, 0x00000000
.long 0x00000000, 0x00000000, 0x00000000, 0x00000000, 0x00000000, 0x00000000, 0x00000000, 0x00000000
.long 0xbf800000, 0x3f80250d, 0x00000000, 0x00000000, 0x00003f73, 0xbf16bf73, 0x00000000, 0x00000000
.long 0x3f803f16, 0xbe9e3f16, 0x00000000, 0x00000000, 0x250dbf16, 0x3f733f16, 0x00000000, 0x00000000
.long 0xbf80bf73, 0xbf4fbf73, 0x00000000, 0x00000000, 0x00000000, 0x00000000, 0x00000000, 0x00000000
.long 0x00000000, 0x00000000, 0x00000000, 0x00000000, 0x00000000, 0x00000000, 0x00000000, 0x00000000
.long 0x00000000, 0x00000000, 0x00000000, 0x00000000, 0x00000000, 0x00000000, 0x00000000, 0x00000000
.long 0x00000000, 0x00000000, 0x00000000, 0x00000000, 0x00000000, 0x00000000, 0x00000000, 0x00000000
.long 0x00000000, 0x00000000, 0x00000000, 0x00000000, 0x00000000, 0x00000000, 0x00000000, 0x00000000
.long 0x00000000, 0x00000000, 0x00000000, 0x00000000, 0x00000000, 0x00000000, 0x00000000, 0x00000000
.long 0xbf800000, 0x3f80250d, 0x00000000, 0x00000000, 0x3f733f16, 0xbf730000, 0x00000000, 0x00000000
.long 0xbf4fbf73, 0x3f4f250d, 0x00000000, 0x00000000, 0x3f163f73, 0xbf160000, 0x00000000, 0x00000000
.long 0xbe9ebf16, 0x3e9e250d, 0x00000000, 0x00000000, 0x00000000, 0x00000000, 0x00000000, 0x00000000
.long 0x00000000, 0x00000000, 0x00000000, 0x00000000, 0x00000000, 0x00000000, 0x00000000, 0x00000000
.long 0x00000000, 0x00000000, 0x00000000, 0x00000000, 0x00000000, 0x00000000, 0x00000000, 0x00000000
.long 0x00000000, 0x00000000, 0x00000000, 0x00000000, 0x00000000, 0x00000000, 0x00000000, 0x00000000
.long 0x00000000, 0x00000000, 0x00000000, 0x00000000, 0x00000000, 0x00000000, 0x00000000, 0x00000000
.long 0x00000000, 0x00000000, 0x00000000, 0x00000000, 0x00000000, 0x00000000, 0x00000000, 0x00000000
.long 0xbf800000, 0x3f80250d, 0x00000000, 0x00000000, 0x3f16bf16, 0x00003f73, 0x00000000, 0x00000000
.long 0x3e9e3f73, 0xbf80bf16, 0x00000000, 0x00000000, 0xbf73bf73, 0x250dbf16, 0x00000000, 0x00000000
.long 0x3f4f3f16, 0x3f803f73, 0x00000000, 0x00000000, 0x00000000, 0x00000000, 0x00000000, 0x00000000
.long 0x00000000, 0x00000000, 0x00000000, 0x00000000, 0x00000000, 0x00000000, 0x00000000, 0x00000000
.long 0x00000000, 0x00000000, 0x00000000, 0x00000000, 0x00000000, 0x00000000, 0x00000000, 0x00000000
.long 0x00000000, 0x00000000, 0x00000000, 0x00000000, 0x00000000, 0x00000000, 0x00000000, 0x00000000
.long 0x00000000, 0x00000000, 0x00000000, 0x00000000, 0x00000000, 0x00000000, 0x00000000, 0x00000000
.long 0x00000000, 0x00000000, 0x00000000, 0x00000000, 0x00000000, 0x00000000, 0x00000000, 0x00000000
.long 0x3f808000, 0xbf80a50d, 0x3f808000, 0xbf80a50d, 0x3f738000, 0xbf163f16, 0x3f163f73, 0xbf73bf16
.long 0x3f4f8000, 0x3e9e3f73, 0xbe9e3f16, 0xbf4fbf73, 0x3f168000, 0x3f733f73, 0xbf73bf16, 0xbf16bf73
.long 0x3e9e8000, 0x3f4f3f16, 0xbf4fbf73, 0xbe9ebf16, 0x00000000, 0x00000000, 0x00000000, 0x00000000
.long 0x00000000, 0x00000000, 0x00000000, 0x00000000, 0x00000000, 0x00000000, 0x00000000, 0x00000000
.long 0x00000000, 0x00000000, 0x00000000, 0x00000000, 0x00000000, 0x00000000, 0x00000000, 0x00000000
.long 0x00000000, 0x00000000, 0x00000000, 0x00000000, 0x00000000, 0x00000000, 0x00000000, 0x00000000
.long 0x00000000, 0x00000000, 0x00000000, 0x00000000, 0x00000000, 0x00000000, 0x00000000, 0x00000000
.long 0x00000000, 0x00000000, 0x00000000, 0x00000000, 0x00000000, 0x00000000, 0x00000000, 0x00000000
.long 0x3f808000, 0xbf80a50d, 0x00000000, 0x00000000, 0x8000bf73, 0x3f163f73, 0x00000000, 0x00000000
.long 0xbf80bf16, 0x3e9ebf16, 0x00000000, 0x00000000, 0xa50d3f16, 0xbf73bf16, 0x00000000, 0x00000000
.long 0x3f803f73, 0x3f4f3f73, 0x00000000, 0x00000000, 0x00000000, 0x00000000, 0x00000000, 0x00000000
.long 0x00000000, 0x00000000, 0x00000000, 0x00000000, 0x00000000, 0x00000000, 0x00000000, 0x00000000
.long 0x00000000, 0x00000000, 0x00000000, 0x00000000, 0x00000000, 0x00000000, 0x00000000, 0x00000000
.long 0x00000000, 0x00000000, 0x00000000, 0x00000000, 0x00000000, 0x00000000, 0x00000000, 0x00000000
.long 0x00000000, 0x00000000, 0x00000000, 0x00000000, 0x00000000, 0x00000000, 0x00000000, 0x00000000
.long 0x00000000, 0x00000000, 0x00000000, 0x00000000, 0x00000000, 0x00000000, 0x00000000, 0x00000000
.long 0x3f808000, 0xbf80a50d, 0x00000000, 0x00000000, 0xbf73bf16, 0x3f738000, 0x00000000, 0x00000000
.long 0x3f4f3f73, 0xbf4fa50d, 0x00000000, 0x00000000, 0xbf16bf73, 0x3f168000, 0x00000000, 0x00000000
.long 0x3e9e3f16, 0xbe9ea50d, 0x00000000, 0x00000000, 0x00000000, 0x00000000, 0x00000000, 0x00000000
.long 0x00000000, 0x00000000, 0x00000000, 0x00000000, 0x00000000, 0x00000000, 0x00000000, 0x00000000
.long 0x00000000, 0x00000000, 0x00000000, 0x00000000, 0x00000000, 0x00000000, 0x00000000, 0x00000000
.long 0x00000000, 0x00000000, 0x00000000, 0x00000000, 0x00000000, 0x00000000, 0x00000000, 0x00000000
.long 0x00000000, 0x00000000, 0x00000000, 0x00000000, 0x00000000, 0x00000000, 0x00000000, 0x00000000
.long 0x00000000, 0x00000000, 0x00000000, 0x00000000, 0x00000000, 0x00000000, 0x00000000, 0x00000000
.long 0x3f808000, 0xbf80a50d, 0x00000000, 0x00000000, 0xbf163f16, 0x8000bf73, 0x00000000, 0x00000000
.long 0xbe9ebf73, 0x3f803f16, 0x00000000, 0x00000000, 0x3f733f73, 0xa50d3f16, 0x00000000, 0x00000000
.long 0xbf4fbf16, 0xbf80bf73, 0x00000000, 0x00000000, 0x00000000, 0x00000000, 0x00000000, 0x00000000
.long 0x00000000, 0x00000000, 0x00000000, 0x00000000, 0x00000000, 0x00000000, 0x00000000, 0x00000000
.long 0x00000000, 0x00000000, 0x00000000, 0x00000000, 0x00000000, 0x00000000, 0x00000000, 0x00000000
.long 0x00000000, 0x00000000, 0x00000000, 0x00000000, 0x00000000, 0x00000000, 0x00000000, 0x00000000
.long 0x00000000, 0x00000000, 0x00000000, 0x00000000, 0x00000000, 0x00000000, 0x00000000, 0x00000000
.long 0x00000000, 0x00000000, 0x00000000, 0x00000000, 0x00000000, 0x00000000, 0x00000000, 0x00000000
.long 0x3f803f80, 0x3f803f80, 0x3f803f80, 0x3f803f80, 0x3f7f3f80, 0x3f753f7b, 0xbdc9248d, 0xbe95be48
.long 0x3f7b3f80, 0x3f553f6d, 0xbf7bbf80, 0xbf55bf6d, 0x3f753f80, 0x3f223f55, 0x3e95a554, 0x3f463f0e
.long 0x3f6d3f80, 0x3ec43f35, 0x3f6d3f80, 0x3ec43f35, 0x3f623f80, 0x3dc93f0e, 0xbef1248d, 0xbf7fbf55
.long 0x3f553f80, 0xbe483ec4, 0xbf55bf80, 0x3e48bec4, 0x3f463f80, 0xbef13e48, 0x3f22a554, 0x3f623f7b
.long 0x3f353f80, 0xbf35248d, 0x3f353f80, 0xbf35248d, 0x3f223f80, 0xbf62be48, 0xbf46248d, 0xbef1bf7b
.long 0x3f0e3f80, 0xbf7bbec4, 0xbf0ebf80, 0x3f7b3ec4, 0x3ef13f80, 0xbf7fbf0e, 0x3f62a554, 0xbdc93f55
.long 0x3ec43f80, 0xbf6dbf35, 0x3ec43f80, 0xbf6dbf35, 0x3e953f80, 0xbf46bf55, 0xbf75248d, 0x3f22bf0e
.long 0x3e483f80, 0xbf0ebf6d, 0xbe48bf80, 0x3f0e3f6d, 0x3dc93f80, 0xbe95bf7b, 0x3f7fa554, 0xbf753e48
.long 0x3f803f80, 0x3f803f80, 0x3f803f80, 0x3f803f80, 0x3f623f6d, 0x3f463f55, 0xbef1bec4, 0xbf22bf0e
.long 0x3f0e3f35, 0x3e483ec4, 0xbf0ebf35, 0xbe48bec4, 0x3dc93ec4, 0xbef1be48, 0x3f7f3f6d, 0x3f623f7b
.long 0xbec4248d, 0xbf6dbf35, 0xbec4248d, 0xbf6dbf35, 0xbf46bec4, 0xbf75bf7b, 0xbf22bf6d, 0x3e95be48
.long 0xbf7bbf35, 0xbf0ebf6d, 0x3f7b3f35, 0x3f0e3f6d, 0xbf75bf6d, 0x3dc9bf0e, 0xbe953ec4, 0xbf7fbf55
.long 0xbf35bf80, 0x3f35a554, 0xbf35bf80, 0x3f35a554, 0xbe95bf6d, 0x3f7f3f0e, 0x3f753ec4, 0x3dc93f55
.long 0x3e48bf35, 0x3f553f6d, 0xbe483f35, 0xbf55bf6d, 0x3f22bec4, 0x3e953f7b, 0xbf46bf6d, 0x3f753e48
.long 0x3f6da554, 0xbec43f35, 0x3f6da554, 0xbec43f35, 0x3f7f3ec4, 0xbf623e48, 0xbdc93f6d, 0xbef1bf7b
.long 0x3f553f35, 0xbf7bbec4, 0xbf55bf35, 0x3f7b3ec4, 0x3ef13f6d, 0xbf22bf55, 0x3f62bec4, 0xbf463f0e
.long 0x3f803f80, 0x3f803f80, 0x3f803f80, 0x3f803f80, 0x3f223f35, 0x3ef13f0e, 0xbf46bf35, 0xbf62bf55
.long 0xbe48248d, 0xbf0ebec4, 0x3e48a554, 0x3f0e3ec4, 0xbf62bf35, 0xbf7fbf7b, 0x3ef13f35, 0xbdc93e48
.long 0xbf6dbf80, 0xbec4bf35, 0xbf6dbf80, 0xbec4bf35, 0xbe95bf35, 0x3f223e48, 0x3f753f35, 0x3f463f7b
.long 0x3f0ea554, 0x3f7b3f6d, 0xbf0e248d, 0xbf7bbf6d, 0x3f7f3f35, 0x3e953f55, 0xbdc9bf35, 0x3f753f0e
.long 0x3f353f80, 0xbf35248d, 0x3f353f80, 0xbf35248d, 0xbdc93f35, 0xbf75bf55, 0xbf7fbf35, 0x3e95bf0e
.long 0xbf55248d, 0xbe48bf6d, 0x3f55a554, 0x3e483f6d, 0xbf75bf35, 0x3f46be48, 0xbe953f35, 0xbf22bf7b
.long 0xbec4bf80, 0x3f6d3f35, 0xbec4bf80, 0x3f6d3f35, 0x3ef1bf35, 0x3dc93f7b, 0x3f623f35, 0xbf7fbe48
.long 0x3f7ba554, 0xbf553ec4, 0xbf7b248d, 0x3f55bec4, 0x3f463f35, 0xbf62bf0e, 0x3f22bf35, 0xbef13f55
.long 0x3f803f80, 0x3f803f80, 0x3f803f80, 0x3f803f80, 0x3e953ec4, 0x3dc93e48, 0xbf75bf6d, 0xbf7fbf7b
.long 0xbf55bf35, 0xbf7bbf6d, 0x3f553f35, 0x3f7b3f6d, 0xbf46bf6d, 0xbe95bf0e, 0xbf22bec4, 0xbf75bf55
.long 0x3ec4a554, 0x3f6d3f35, 0x3ec4a554, 0x3f6d3f35, 0x3f7f3f6d, 0x3ef13f55, 0xbdc93ec4, 0xbf62bf0e
.long 0x3e483f35, 0xbf55bec4, 0xbe48bf35, 0x3f553ec4, 0xbf62bec4, 0xbf22bf7b, 0x3ef13f6d, 0xbf46be48
.long 0xbf35bf80, 0x3f35a554, 0xbf35bf80, 0x3f35a554, 0x3ef1bec4, 0x3f463f7b, 0x3f623f6d, 0xbf223e48
.long 0x3f7b3f35, 0xbf0e3ec4, 0xbf7bbf35, 0x3f0ebec4, 0x3dc93f6d, 0xbf62bf55, 0x3f7f3ec4, 0xbef13f0e
.long 0xbf6d248d, 0x3ec4bf35, 0xbf6d248d, 0x3ec4bf35, 0xbf22bf6d, 0x3f753f0e, 0x3f46bec4, 0xbe953f55
.long 0x3f0ebf35, 0xbe483f6d, 0xbf0e3f35, 0x3e48bf6d, 0x3f753ec4, 0xbf7fbe48, 0x3e95bf6d, 0xbdc93f7b
.long 0x3f803f80, 0x3f803f80, 0x3f803f80, 0x3f803f80, 0xbf7fbf80, 0xbf75bf7b, 0x3dc9a554, 0x3e953e48
.long 0x3f7b3f80, 0x3f553f6d, 0xbf7bbf80, 0xbf55bf6d, 0xbf75bf80, 0xbf22bf55, 0xbe95248d, 0xbf46bf0e
.long 0x3f6d3f80, 0x3ec43f35, 0x3f6d3f80, 0x3ec43f35, 0xbf62bf80, 0xbdc9bf0e, 0x3ef1a554, 0x3f7f3f55
.long 0x3f553f80, 0xbe483ec4, 0xbf55bf80, 0x3e48bec4, 0xbf46bf80, 0x3ef1be48, 0xbf22248d, 0xbf62bf7b
.long 0x3f353f80, 0xbf35248d, 0x3f353f80, 0xbf35248d, 0xbf22bf80, 0x3f623e48, 0x3f46a554, 0x3ef13f7b
.long 0x3f0e3f80, 0xbf7bbec4, 0xbf0ebf80, 0x3f7b3ec4, 0xbef1bf80, 0x3f7f3f0e, 0xbf62248d, 0x3dc9bf55
.long 0x3ec43f80, 0xbf6dbf35, 0x3ec43f80, 0xbf6dbf35, 0xbe95bf80, 0x3f463f55, 0x3f75a554, 0xbf223f0e
.long 0x3e483f80, 0xbf0ebf6d, 0xbe48bf80, 0x3f0e3f6d, 0xbdc9bf80, 0x3e953f7b, 0xbf7f248d, 0x3f75be48
.long 0x3f803f80, 0x3f803f80, 0x3f803f80, 0x3f803f80, 0xbf62bf6d, 0xbf46bf55, 0x3ef13ec4, 0x3f223f0e
.long 0x3f0e3f35, 0x3e483ec4, 0xbf0ebf35, 0xbe48bec4, 0xbdc9bec4, 0x3ef13e48, 0xbf7fbf6d, 0xbf62bf7b
.long 0xbec4248d, 0xbf6dbf35, 0xbec4248d, 0xbf6dbf35, 0x3f463ec4, 0x3f753f7b, 0x3f223f6d, 0xbe953e48
.long 0xbf7bbf35, 0xbf0ebf6d, 0x3f7b3f35, 0x3f0e3f6d, 0x3f753f6d, 0xbdc93f0e, 0x3e95bec4, 0x3f7f3f55
.long 0xbf35bf80, 0x3f35a554, 0xbf35bf80, 0x3f35a554, 0x3e953f6d, 0xbf7fbf0e, 0xbf75bec4, 0xbdc9bf55
.long 0x3e48bf35, 0x3f553f6d, 0xbe483f35, 0xbf55bf6d, 0xbf223ec4, 0xbe95bf7b, 0x3f463f6d, 0xbf75be48
.long 0x3f6da554, 0xbec43f35, 0x3f6da554, 0xbec43f35, 0xbf7fbec4, 0x3f62be48, 0x3dc9bf6d, 0x3ef13f7b
.long 0x3f553f35, 0xbf7bbec4, 0xbf55bf35, 0x3f7b3ec4, 0xbef1bf6d, 0x3f223f55, 0xbf623ec4, 0x3f46bf0e
.long 0x3f803f80, 0x3f803f80, 0x3f803f80, 0x3f803f80, 0xbf22bf35, 0xbef1bf0e, 0x3f463f35, 0x3f623f55
.long 0xbe48248d, 0xbf0ebec4, 0x3e48a554, 0x3f0e3ec4, 0x3f623f35, 0x3f7f3f7b, 0xbef1bf35, 0x3dc9be48
.long 0xbf6dbf80, 0xbec4bf35, 0xbf6dbf80, 0xbec4bf35, 0x3e953f35, 0xbf22be48, 0xbf75bf35, 0xbf46bf7b
.long 0x3f0ea554, 0x3f7b3f6d, 0xbf0e248d, 0xbf7bbf6d, 0xbf7fbf35, 0xbe95bf55, 0x3dc93f35, 0xbf75bf0e
.long 0x3f353f80, 0xbf35248d, 0x3f353f80, 0xbf35248d, 0x3dc9bf35, 0x3f753f55, 0x3f7f3f35, 0xbe953f0e
.long 0xbf55248d, 0xbe48bf6d, 0x3f55a554, 0x3e483f6d, 0x3f753f35, 0xbf463e48, 0x3e95bf35, 0x3f223f7b
.long 0xbec4bf80, 0x3f6d3f35, 0xbec4bf80, 0x3f6d3f35, 0xbef13f35, 0xbdc9bf7b, 0xbf62bf35, 0x3f7f3e48
.long 0x3f7ba554, 0xbf553ec4, 0xbf7b248d, 0x3f55bec4, 0xbf46bf35, 0x3f623f0e, 0xbf223f35, 0x3ef1bf55
.long 0x3f803f80, 0x3f803f80, 0x3f803f80, 0x3f803f80, 0xbe95bec4, 0xbdc9be48, 0x3f753f6d, 0x3f7f3f7b
.long 0xbf55bf35, 0xbf7bbf6d, 0x3f553f35, 0x3f7b3f6d, 0x3f463f6d, 0x3e953f0e, 0x3f223ec4, 0x3f753f55
.long 0x3ec4a554, 0x3f6d3f35, 0x3ec4a554, 0x3f6d3f35, 0xbf7fbf6d, 0xbef1bf55, 0x3dc9bec4, 0x3f623f0e
.long 0x3e483f35, 0xbf55bec4, 0xbe48bf35, 0x3f553ec4, 0x3f623ec4, 0x3f223f7b, 0xbef1bf6d, 0x3f463e48
.long 0xbf35bf80, 0x3f35a554, 0xbf35bf80, 0x3f35a554, 0xbef13ec4, 0xbf46bf7b, 0xbf62bf6d, 0x3f22be48
.long 0x3f7b3f35, 0xbf0e3ec4, 0xbf7bbf35, 0x3f0ebec4, 0xbdc9bf6d, 0x3f623f55, 0xbf7fbec4, 0x3ef1bf0e
.long 0xbf6d248d, 0x3ec4bf35, 0xbf6d248d, 0x3ec4bf35, 0x3f223f6d, 0xbf75bf0e, 0xbf463ec4, 0x3e95bf55
.long 0x3f0ebf35, 0xbe483f6d, 0xbf0e3f35, 0x3e48bf6d, 0xbf75bec4, 0x3f7f3e48, 0xbe953f6d, 0x3dc9bf7b
.long 0x00000000, 0x00000000, 0x00000000, 0x00000000, 0x3dc90000, 0x3e953e48, 0x3f7f3f80, 0x3f753f7b
.long 0x3e480000, 0x3f0e3ec4, 0xbe48250d, 0xbf0ebec4, 0x3e950000, 0x3f463f0e, 0xbf75bf80, 0xbf22bf55
.long 0x3ec40000, 0x3f6d3f35, 0x3ec40000, 0x3f6d3f35, 0x3ef10000, 0x3f7f3f55, 0x3f623f80, 0x3dc93f0e
.long 0x3f0e0000, 0x3f7b3f6d, 0xbf0e250d, 0xbf7bbf6d, 0x3f220000, 0x3f623f7b, 0xbf46bf80, 0x3ef1be48
.long 0x3f350000, 0x3f353f80, 0x3f350000, 0x3f353f80, 0x3f460000, 0x3ef13f7b, 0x3f223f80, 0xbf62be48
.long 0x3f550000, 0x3e483f6d, 0xbf55250d, 0xbe48bf6d, 0x3f620000, 0xbdc93f55, 0xbef1bf80, 0x3f7f3f0e
.long 0x3f6d0000, 0xbec43f35, 0x3f6d0000, 0xbec43f35, 0x3f750000, 0xbf223f0e, 0x3e953f80, 0xbf46bf55
.long 0x3f7b0000, 0xbf553ec4, 0xbf7b250d, 0x3f55bec4, 0x3f7f0000, 0xbf753e48, 0xbdc9bf80, 0x3e953f7b
.long 0x00000000, 0x00000000, 0x00000000, 0x00000000, 0x3ef13ec4, 0x3f223f0e, 0x3f623f6d, 0x3f463f55
.long 0x3f553f35, 0x3f7b3f6d, 0xbf55bf35, 0xbf7bbf6d, 0x3f7f3f6d, 0x3f623f7b, 0xbdc9bec4, 0x3ef13e48
.long 0x3f6d3f80, 0x3ec43f35, 0x3f6d3f80, 0x3ec43f35, 0x3f223f6d, 0xbe953e48, 0xbf46bec4, 0xbf75bf7b
.long 0x3e483f35, 0xbf55bec4, 0xbe48bf35, 0x3f553ec4, 0xbe953ec4, 0xbf7fbf55, 0x3f753f6d, 0xbdc93f0e
.long 0xbf35250d, 0xbf35bf80, 0xbf35250d, 0xbf35bf80, 0xbf75bec4, 0xbdc9bf55, 0xbe95bf6d, 0x3f7f3f0e
.long 0xbf7bbf35, 0x3f0ebec4, 0x3f7b3f35, 0xbf0e3ec4, 0xbf46bf6d, 0x3f753e48, 0xbf223ec4, 0xbe95bf7b
.long 0xbec4bf80, 0x3f6d3f35, 0xbec4bf80, 0x3f6d3f35, 0x3dc9bf6d, 0x3ef13f7b, 0x3f7f3ec4, 0xbf623e48
.long 0x3f0ebf35, 0xbe483f6d, 0xbf0e3f35, 0x3e48bf6d, 0x3f62bec4, 0xbf463f0e, 0xbef1bf6d, 0x3f223f55
.long 0x00000000, 0x00000000, 0x00000000, 0x00000000, 0x3f463f35, 0x3f623f55, 0x3f223f35, 0x3ef13f0e
.long 0x3f7b3f80, 0x3f553f6d, 0xbf7bbf80, 0xbf55bf6d, 0x3ef13f35, 0xbdc93e48, 0x3f623f35, 0x3f7f3f7b
.long 0xbec4250d, 0xbf6dbf35, 0xbec4250d, 0xbf6dbf35, 0xbf75bf35, 0xbf46bf7b, 0xbe95bf35, 0x3f223e48
.long 0xbf55bf80, 0x3e48bec4, 0x3f553f80, 0xbe483ec4, 0xbdc9bf35, 0x3f753f0e, 0xbf7fbf35, 0xbe95bf55
.long 0x3f350000, 0x3f353f80, 0x3f350000, 0x3f353f80, 0x3f7f3f35, 0xbe953f0e, 0xbdc93f35, 0xbf75bf55
.long 0x3f0e3f80, 0xbf7bbec4, 0xbf0ebf80, 0x3f7b3ec4, 0xbe953f35, 0xbf22bf7b, 0x3f753f35, 0xbf463e48
.long 0xbf6d250d, 0x3ec4bf35, 0xbf6d250d, 0x3ec4bf35, 0xbf62bf35, 0x3f7f3e48, 0x3ef1bf35, 0x3dc93f7b
.long 0xbe48bf80, 0x3f0e3f6d, 0x3e483f80, 0xbf0ebf6d, 0x3f22bf35, 0xbef13f55, 0xbf46bf35, 0x3f623f0e
.long 0x00000000, 0x00000000, 0x00000000, 0x00000000, 0x3f753f6d, 0x3f7f3f7b, 0x3e953ec4, 0x3dc93e48
.long 0x3f0e3f35, 0x3e483ec4, 0xbf0ebf35, 0xbe48bec4, 0xbf22bec4, 0xbf75bf55, 0x3f463f6d, 0x3e953f0e
.long 0xbf6dbf80, 0xbec4bf35, 0xbf6dbf80, 0xbec4bf35, 0x3dc9bec4, 0x3f623f0e, 0x3f7f3f6d, 0x3ef13f55
.long 0x3f7b3f35, 0x3f0e3f6d, 0xbf7bbf35, 0xbf0ebf6d, 0x3ef13f6d, 0xbf46be48, 0x3f623ec4, 0x3f223f7b
.long 0xbf35250d, 0xbf35bf80, 0xbf35250d, 0xbf35bf80, 0xbf62bf6d, 0x3f22be48, 0x3ef1bec4, 0x3f463f7b
.long 0x3e48bf35, 0x3f553f6d, 0xbe483f35, 0xbf55bf6d, 0x3f7f3ec4, 0xbef13f0e, 0xbdc9bf6d, 0x3f623f55
.long 0x3ec43f80, 0xbf6dbf35, 0x3ec43f80, 0xbf6dbf35, 0xbf463ec4, 0x3e95bf55, 0xbf22bf6d, 0x3f753f0e
.long 0xbf55bf35, 0x3f7b3ec4, 0x3f553f35, 0xbf7bbec4, 0x3e95bf6d, 0xbdc93f7b, 0xbf75bec4, 0x3f7f3e48
.long 0x00000000, 0x00000000, 0x00000000, 0x00000000, 0xbdc9250d, 0xbe95be48, 0xbf7fbf80, 0xbf75bf7b
.long 0x3e480000, 0x3f0e3ec4, 0xbe48250d, 0xbf0ebec4, 0xbe95250d, 0xbf46bf0e, 0x3f753f80, 0x3f223f55
.long 0x3ec40000, 0x3f6d3f35, 0x3ec40000, 0x3f6d3f35, 0xbef1250d, 0xbf7fbf55, 0xbf62bf80, 0xbdc9bf0e
.long 0x3f0e0000, 0x3f7b3f6d, 0xbf0e250d, 0xbf7bbf6d, 0xbf22250d, 0xbf62bf7b, 0x3f463f80, 0xbef13e48
.long 0x3f350000, 0x3f353f80, 0x3f350000, 0x3f353f80, 0xbf46250d, 0xbef1bf7b, 0xbf22bf80, 0x3f623e48
.long 0x3f550000, 0x3e483f6d, 0xbf55250d, 0xbe48bf6d, 0xbf62250d, 0x3dc9bf55, 0x3ef13f80, 0xbf7fbf0e
.long 0x3f6d0000, 0xbec43f35, 0x3f6d0000, 0xbec43f35, 0xbf75250d, 0x3f22bf0e, 0xbe95bf80, 0x3f463f55
.long 0x3f7b0000, 0xbf553ec4, 0xbf7b250d, 0x3f55bec4, 0xbf7f250d, 0x3f75be48, 0x3dc93f80, 0xbe95bf7b
.long 0x00000000, 0x00000000, 0x00000000, 0x00000000, 0xbef1bec4, 0xbf22bf0e, 0xbf62bf6d, 0xbf46bf55
.long 0x3f553f35, 0x3f7b3f6d, 0xbf55bf35, 0xbf7bbf6d, 0xbf7fbf6d, 0xbf62bf7b, 0x3dc93ec4, 0xbef1be48
.long 0x3f6d3f80, 0x3ec43f35, 0x3f6d3f80, 0x3ec43f35, 0xbf22bf6d, 0x3e95be48, 0x3f463ec4, 0x3f753f7b
.long 0x3e483f35, 0xbf55bec4, 0xbe48bf35, 0x3f553ec4, 0x3e95bec4, 0x3f7f3f55, 0xbf75bf6d, 0x3dc9bf0e
.long 0xbf35250d, 0xbf35bf80, 0xbf35250d, 0xbf35bf80, 0x3f753ec4, 0x3dc93f55, 0x3e953f6d, 0xbf7fbf0e
.long 0xbf7bbf35, 0x3f0ebec4, 0x3f7b3f35, 0xbf0e3ec4, 0x3f463f6d, 0xbf75be48, 0x3f22bec4, 0x3e953f7b
.long 0xbec4bf80, 0x3f6d3f35, 0xbec4bf80, 0x3f6d3f35, 0xbdc93f6d, 0xbef1bf7b, 0xbf7fbec4, 0x3f62be48
.long 0x3f0ebf35, 0xbe483f6d, 0xbf0e3f35, 0x3e48bf6d, 0xbf623ec4, 0x3f46bf0e, 0x3ef13f6d, 0xbf22bf55
.long 0x00000000, 0x00000000, 0x00000000, 0x00000000, 0xbf46bf35, 0xbf62bf55, 0xbf22bf35, 0xbef1bf0e
.long 0x3f7b3f80, 0x3f553f6d, 0xbf7bbf80, 0xbf55bf6d, 0xbef1bf35, 0x3dc9be48, 0xbf62bf35, 0xbf7fbf7b
.long 0xbec4250d, 0xbf6dbf35, 0xbec4250d, 0xbf6dbf35, 0x3f753f35, 0x3f463f7b, 0x3e953f35, 0xbf22be48
.long 0xbf55bf80, 0x3e48bec4, 0x3f553f80, 0xbe483ec4, 0x3dc93f35, 0xbf75bf0e, 0x3f7f3f35, 0x3e953f55
.long 0x3f350000, 0x3f353f80, 0x3f350000, 0x3f353f80, 0xbf7fbf35, 0x3e95bf0e, 0x3dc9bf35, 0x3f753f55
.long 0x3f0e3f80, 0xbf7bbec4, 0xbf0ebf80, 0x3f7b3ec4, 0x3e95bf35, 0x3f223f7b, 0xbf75bf35, 0x3f46be48
.long 0xbf6d250d, 0x3ec4bf35, 0xbf6d250d, 0x3ec4bf35, 0x3f623f35, 0xbf7fbe48, 0xbef13f35, 0xbdc9bf7b
.long 0xbe48bf80, 0x3f0e3f6d, 0x3e483f80, 0xbf0ebf6d, 0xbf223f35, 0x3ef1bf55, 0x3f463f35, 0xbf62bf0e
.long 0x00000000, 0x00000000, 0x00000000, 0x00000000, 0xbf75bf6d, 0xbf7fbf7b, 0xbe95bec4, 0xbdc9be48
.long 0x3f0e3f35, 0x3e483ec4, 0xbf0ebf35, 0xbe48bec4, 0x3f223ec4, 0x3f753f55, 0xbf46bf6d, 0xbe95bf0e
.long 0xbf6dbf80, 0xbec4bf35, 0xbf6dbf80, 0xbec4bf35, 0xbdc93ec4, 0xbf62bf0e, 0xbf7fbf6d, 0xbef1bf55
.long 0x3f7b3f35, 0x3f0e3f6d, 0xbf7bbf35, 0xbf0ebf6d, 0xbef1bf6d, 0x3f463e48, 0xbf62bec4, 0xbf22bf7b
.long 0xbf35250d, 0xbf35bf80, 0xbf35250d, 0xbf35bf80, 0x3f623f6d, 0xbf223e48, 0xbef13ec4, 0xbf46bf7b
.long 0x3e48bf35, 0x3f553f6d, 0xbe483f35, 0xbf55bf6d, 0xbf7fbec4, 0x3ef1bf0e, 0x3dc93f6d, 0xbf62bf55
.long 0x3ec43f80, 0xbf6dbf35, 0x3ec43f80, 0xbf6dbf35, 0x3f46bec4, 0xbe953f55, 0x3f223f6d, 0xbf75bf0e
.long 0xbf55bf35, 0x3f7b3ec4, 0x3f553f35, 0xbf7bbec4, 0xbe953f6d, 0x3dc9bf7b, 0x3f753ec4, 0xbf7fbe48
.long 0x248d3f80, 0xa554bf80, 0x248d3f80, 0xa554bf80, 0xbdc93f80, 0x3e95bf7b, 0xbf7f248d, 0x3f753e48
.long 0xbe483f80, 0x3f0ebf6d, 0x3e48bf80, 0xbf0e3f6d, 0xbe953f80, 0x3f46bf55, 0x3f75a554, 0xbf22bf0e
.long 0xbec43f80, 0x3f6dbf35, 0xbec43f80, 0x3f6dbf35, 0xbef13f80, 0x3f7fbf0e, 0xbf62248d, 0x3dc93f55
.long 0xbf0e3f80, 0x3f7bbec4, 0x3f0ebf80, 0xbf7b3ec4, 0xbf223f80, 0x3f62be48, 0x3f46a554, 0x3ef1bf7b
.long 0xbf353f80, 0x3f35a554, 0xbf353f80, 0x3f35a554, 0xbf463f80, 0x3ef13e48, 0xbf22248d, 0xbf623f7b
.long 0xbf553f80, 0x3e483ec4, 0x3f55bf80, 0xbe48bec4, 0xbf623f80, 0xbdc93f0e, 0x3ef1a554, 0x3f7fbf55
.long 0xbf6d3f80, 0xbec43f35, 0xbf6d3f80, 0xbec43f35, 0xbf753f80, 0xbf223f55, 0xbe95248d, 0xbf463f0e
.long 0xbf7b3f80, 0xbf553f6d, 0x3f7bbf80, 0x3f55bf6d, 0xbf7f3f80, 0xbf753f7b, 0x3dc9a554, 0x3e95be48
.long 0x248d3f80, 0xa554bf80, 0x248d3f80, 0xa554bf80, 0xbef13f6d, 0x3f22bf55, 0xbf62bec4, 0x3f463f0e
.long 0xbf553f35, 0x3f7bbec4, 0x3f55bf35, 0xbf7b3ec4, 0xbf7f3ec4, 0x3f623e48, 0x3dc93f6d, 0x3ef1bf7b
.long 0xbf6d248d, 0x3ec43f35, 0xbf6d248d, 0x3ec43f35, 0xbf22bec4, 0xbe953f7b, 0x3f46bf6d, 0xbf753e48
.long 0xbe48bf35, 0xbf553f6d, 0x3e483f35, 0x3f55bf6d, 0x3e95bf6d, 0xbf7f3f0e, 0xbf753ec4, 0xbdc93f55
.long 0x3f35bf80, 0xbf35248d, 0x3f35bf80, 0xbf35248d, 0x3f75bf6d, 0xbdc9bf0e, 0x3e953ec4, 0x3f7fbf55
.long 0x3f7bbf35, 0x3f0ebf6d, 0xbf7b3f35, 0xbf0e3f6d, 0x3f46bec4, 0x3f75bf7b, 0x3f22bf6d, 0xbe95be48
.long 0x3ec4a554, 0x3f6dbf35, 0x3ec4a554, 0x3f6dbf35, 0xbdc93ec4, 0x3ef1be48, 0xbf7f3f6d, 0xbf623f7b
.long 0xbf0e3f35, 0xbe483ec4, 0x3f0ebf35, 0x3e48bec4, 0xbf623f6d, 0xbf463f55, 0x3ef1bec4, 0x3f22bf0e
.long 0x248d3f80, 0xa554bf80, 0x248d3f80, 0xa554bf80, 0xbf463f35, 0x3f62bf0e, 0xbf22bf35, 0x3ef13f55
.long 0xbf7b248d, 0x3f553ec4, 0x3f7ba554, 0xbf55bec4, 0xbef1bf35, 0xbdc93f7b, 0xbf623f35, 0x3f7fbe48
.long 0x3ec4bf80, 0xbf6d3f35, 0x3ec4bf80, 0xbf6d3f35, 0x3f75bf35, 0xbf46be48, 0x3e953f35, 0x3f22bf7b
.long 0x3f55a554, 0x3e48bf6d, 0xbf55248d, 0xbe483f6d, 0x3dc93f35, 0x3f75bf55, 0x3f7fbf35, 0xbe95bf0e
.long 0xbf353f80, 0x3f35a554, 0xbf353f80, 0x3f35a554, 0xbf7f3f35, 0xbe953f55, 0x3dc9bf35, 0xbf753f0e
.long 0xbf0e248d, 0xbf7b3f6d, 0x3f0ea554, 0x3f7bbf6d, 0x3e95bf35, 0xbf223e48, 0xbf753f35, 0xbf463f7b
.long 0x3f6dbf80, 0x3ec4bf35, 0x3f6dbf80, 0x3ec4bf35, 0x3f62bf35, 0x3f7fbf7b, 0xbef13f35, 0x3dc93e48
.long 0x3e48a554, 0x3f0ebec4, 0xbe48248d, 0xbf0e3ec4, 0xbf223f35, 0xbef13f0e, 0x3f46bf35, 0x3f62bf55
.long 0x248d3f80, 0xa554bf80, 0x248d3f80, 0xa554bf80, 0xbf753ec4, 0x3f7fbe48, 0xbe95bf6d, 0x3dc93f7b
.long 0xbf0ebf35, 0x3e483f6d, 0x3f0e3f35, 0xbe48bf6d, 0x3f22bf6d, 0xbf753f0e, 0xbf46bec4, 0x3e953f55
.long 0x3f6da554, 0xbec4bf35, 0x3f6da554, 0xbec4bf35, 0xbdc93f6d, 0x3f62bf55, 0xbf7f3ec4, 0x3ef13f0e
.long 0xbf7b3f35, 0x3f0e3ec4, 0x3f7bbf35, 0xbf0ebec4, 0xbef1bec4, 0xbf463f7b, 0xbf623f6d, 0x3f223e48
.long 0x3f35bf80, 0xbf35248d, 0x3f35bf80, 0xbf35248d, 0x3f62bec4, 0x3f22bf7b, 0xbef13f6d, 0x3f46be48
.long 0xbe483f35, 0x3f55bec4, 0x3e48bf35, 0xbf553ec4, 0xbf7f3f6d, 0xbef13f55, 0x3dc93ec4, 0x3f62bf0e
.long 0xbec4248d, 0xbf6d3f35, 0xbec4248d, 0xbf6d3f35, 0x3f46bf6d, 0x3e95bf0e, 0x3f22bec4, 0x3f75bf55
.long 0x3f55bf35, 0x3f7bbf6d, 0xbf553f35, 0xbf7b3f6d, 0xbe953ec4, 0xbdc93e48, 0x3f75bf6d, 0x3f7fbf7b
.long 0x248d3f80, 0xa554bf80, 0x248d3f80, 0xa554bf80, 0x3dc9bf80, 0xbe953f7b, 0x3f7fa554, 0xbf75be48
.long 0xbe483f80, 0x3f0ebf6d, 0x3e48bf80, 0xbf0e3f6d, 0x3e95bf80, 0xbf463f55, 0xbf75248d, 0x3f223f0e
.long 0xbec43f80, 0x3f6dbf35, 0xbec43f80, 0x3f6dbf35, 0x3ef1bf80, 0xbf7f3f0e, 0x3f62a554, 0xbdc9bf55
.long 0xbf0e3f80, 0x3f7bbec4, 0x3f0ebf80, 0xbf7b3ec4, 0x3f22bf80, 0xbf623e48, 0xbf46248d, 0xbef13f7b
.long 0xbf353f80, 0x3f35a554, 0xbf353f80, 0x3f35a554, 0x3f46bf80, 0xbef1be48, 0x3f22a554, 0x3f62bf7b
.long 0xbf553f80, 0x3e483ec4, 0x3f55bf80, 0xbe48bec4, 0x3f62bf80, 0x3dc9bf0e, 0xbef1248d, 0xbf7f3f55
.long 0xbf6d3f80, 0xbec43f35, 0xbf6d3f80, 0xbec43f35, 0x3f75bf80, 0x3f22bf55, 0x3e95a554, 0x3f46bf0e
.long 0xbf7b3f80, 0xbf553f6d, 0x3f7bbf80, 0x3f55bf6d, 0x3f7fbf80, 0x3f75bf7b, 0xbdc9248d, 0xbe953e48
.long 0x248d3f80, 0xa554bf80, 0x248d3f80, 0xa554bf80, 0x3ef1bf6d, 0xbf223f55, 0x3f623ec4, 0xbf46bf0e
.long 0xbf553f35, 0x3f7bbec4, 0x3f55bf35, 0xbf7b3ec4, 0x3f7fbec4, 0xbf62be48, 0xbdc9bf6d, 0xbef13f7b
.long 0xbf6d248d, 0x3ec43f35, 0xbf6d248d, 0x3ec43f35, 0x3f223ec4, 0x3e95bf7b, 0xbf463f6d, 0x3f75be48
.long 0xbe48bf35, 0xbf553f6d, 0x3e483f35, 0x3f55bf6d, 0xbe953f6d, 0x3f7fbf0e, 0x3f75bec4, 0x3dc9bf55
.long 0x3f35bf80, 0xbf35248d, 0x3f35bf80, 0xbf35248d, 0xbf753f6d, 0x3dc93f0e, 0xbe95bec4, 0xbf7f3f55
.long 0x3f7bbf35, 0x3f0ebf6d, 0xbf7b3f35, 0xbf0e3f6d, 0xbf463ec4, 0xbf753f7b, 0xbf223f6d, 0x3e953e48
.long 0x3ec4a554, 0x3f6dbf35, 0x3ec4a554, 0x3f6dbf35, 0x3dc9bec4, 0xbef13e48, 0x3f7fbf6d, 0x3f62bf7b
.long 0xbf0e3f35, 0xbe483ec4, 0x3f0ebf35, 0x3e48bec4, 0x3f62bf6d, 0x3f46bf55, 0xbef13ec4, 0xbf223f0e
.long 0x248d3f80, 0xa554bf80, 0x248d3f80, 0xa554bf80, 0x3f46bf35, 0xbf623f0e, 0x3f223f35, 0xbef1bf55
.long 0xbf7b248d, 0x3f553ec4, 0x3f7ba554, 0xbf55bec4, 0x3ef13f35, 0x3dc9bf7b, 0x3f62bf35, 0xbf7f3e48
.long 0x3ec4bf80, 0xbf6d3f35, 0x3ec4bf80, 0xbf6d3f35, 0xbf753f35, 0x3f463e48, 0xbe95bf35, 0xbf223f7b
.long 0x3f55a554, 0x3e48bf6d, 0xbf55248d, 0xbe483f6d, 0xbdc9bf35, 0xbf753f55, 0xbf7f3f35, 0x3e953f0e
.long 0xbf353f80, 0x3f35a554, 0xbf353f80, 0x3f35a554, 0x3f7fbf35, 0x3e95bf55, 0xbdc93f35, 0x3f75bf0e
.long 0xbf0e248d, 0xbf7b3f6d, 0x3f0ea554, 0x3f7bbf6d, 0xbe953f35, 0x3f22be48, 0x3f75bf35, 0x3f46bf7b
.long 0x3f6dbf80, 0x3ec4bf35, 0x3f6dbf80, 0x3ec4bf35, 0xbf623f35, 0xbf7f3f7b, 0x3ef1bf35, 0xbdc9be48
.long 0x3e48a554, 0x3f0ebec4, 0xbe48248d, 0xbf0e3ec4, 0x3f22bf35, 0x3ef1bf0e, 0xbf463f35, 0xbf623f55
.long 0x248d3f80, 0xa554bf80, 0x248d3f80, 0xa554bf80, 0x3f75bec4, 0xbf7f3e48, 0x3e953f6d, 0xbdc9bf7b
.long 0xbf0ebf35, 0x3e483f6d, 0x3f0e3f35, 0xbe48bf6d, 0xbf223f6d, 0x3f75bf0e, 0x3f463ec4, 0xbe95bf55
.long 0x3f6da554, 0xbec4bf35, 0x3f6da554, 0xbec4bf35, 0x3dc9bf6d, 0xbf623f55, 0x3f7fbec4, 0xbef1bf0e
.long 0xbf7b3f35, 0x3f0e3ec4, 0x3f7bbf35, 0xbf0ebec4, 0x3ef13ec4, 0x3f46bf7b, 0x3f62bf6d, 0xbf22be48
.long 0x3f35bf80, 0xbf35248d, 0x3f35bf80, 0xbf35248d, 0xbf623ec4, 0xbf223f7b, 0x3ef1bf6d, 0xbf463e48
.long 0xbe483f35, 0x3f55bec4, 0x3e48bf35, 0xbf553ec4, 0x3f7fbf6d, 0x3ef1bf55, 0xbdc9bec4, 0xbf623f0e
.long 0xbec4248d, 0xbf6d3f35, 0xbec4248d, 0xbf6d3f35, 0xbf463f6d, 0xbe953f0e, 0xbf223ec4, 0xbf753f55
.long 0x3f55bf35, 0x3f7bbf6d, 0xbf553f35, 0xbf7b3f6d, 0x3e95bec4, 0x3dc9be48, 0xbf753f6d, 0xbf7f3f7b
.long 0x3f800000, 0xbf80250d, 0x3f800000, 0xbf80250d, 0x3f7f0000, 0xbf75be48, 0xbdc93f80, 0x3e95bf7b
.long 0x3f7b0000, 0xbf55bec4, 0xbf7b250d, 0x3f553ec4, 0x3f750000, 0xbf22bf0e, 0x3e95bf80, 0xbf463f55
.long 0x3f6d0000, 0xbec4bf35, 0x3f6d0000, 0xbec4bf35, 0x3f620000, 0xbdc9bf55, 0xbef13f80, 0x3f7fbf0e
.long 0x3f550000, 0x3e48bf6d, 0xbf55250d, 0xbe483f6d, 0x3f460000, 0x3ef1bf7b, 0x3f22bf80, 0xbf623e48
.long 0x3f350000, 0x3f35bf80, 0x3f350000, 0x3f35bf80, 0x3f220000, 0x3f62bf7b, 0xbf463f80, 0x3ef13e48
.long 0x3f0e0000, 0x3f7bbf6d, 0xbf0e250d, 0xbf7b3f6d, 0x3ef10000, 0x3f7fbf55, 0x3f62bf80, 0x3dc9bf0e
.long 0x3ec40000, 0x3f6dbf35, 0x3ec40000, 0x3f6dbf35, 0x3e950000, 0x3f46bf0e, 0xbf753f80, 0xbf223f55
.long 0x3e480000, 0x3f0ebec4, 0xbe48250d, 0xbf0e3ec4, 0x3dc90000, 0x3e95be48, 0x3f7fbf80, 0x3f75bf7b
.long 0x3f800000, 0xbf80250d, 0x3f800000, 0xbf80250d, 0x3f623ec4, 0xbf46bf0e, 0xbef13f6d, 0x3f22bf55
.long 0x3f0e3f35, 0xbe48bf6d, 0xbf0ebf35, 0x3e483f6d, 0x3dc93f6d, 0x3ef1bf7b, 0x3f7fbec4, 0xbf62be48
.long 0xbec43f80, 0x3f6dbf35, 0xbec43f80, 0x3f6dbf35, 0xbf463f6d, 0x3f75be48, 0xbf22bec4, 0xbe953f7b
.long 0xbf7b3f35, 0x3f0e3ec4, 0x3f7bbf35, 0xbf0ebec4, 0xbf753ec4, 0xbdc93f55, 0xbe953f6d, 0x3f7fbf0e
.long 0xbf35250d, 0xbf353f80, 0xbf35250d, 0xbf353f80, 0xbe95bec4, 0xbf7f3f55, 0x3f75bf6d, 0xbdc9bf0e
.long 0x3e48bf35, 0xbf553ec4, 0xbe483f35, 0x3f55bec4, 0x3f22bf6d, 0xbe95be48, 0xbf463ec4, 0xbf753f7b
.long 0x3f6dbf80, 0x3ec4bf35, 0x3f6dbf80, 0x3ec4bf35, 0x3f7fbf6d, 0x3f62bf7b, 0xbdc93ec4, 0x3ef1be48
.long 0x3f55bf35, 0x3f7bbf6d, 0xbf553f35, 0xbf7b3f6d, 0x3ef1bec4, 0x3f22bf0e, 0x3f62bf6d, 0x3f46bf55
.long 0x3f800000, 0xbf80250d, 0x3f800000, 0xbf80250d, 0x3f223f35, 0xbef1bf55, 0xbf463f35, 0x3f62bf0e
.long 0xbe483f80, 0x3f0ebf6d, 0x3e48bf80, 0xbf0e3f6d, 0xbf623f35, 0x3f7fbe48, 0x3ef13f35, 0x3dc9bf7b
.long 0xbf6d250d, 0x3ec43f35, 0xbf6d250d, 0x3ec43f35, 0xbe95bf35, 0xbf223f7b, 0x3f75bf35, 0xbf46be48
.long 0x3f0ebf80, 0xbf7b3ec4, 0xbf0e3f80, 0x3f7bbec4, 0x3f7fbf35, 0xbe95bf0e, 0xbdc9bf35, 0xbf753f55
.long 0x3f350000, 0x3f35bf80, 0x3f350000, 0x3f35bf80, 0xbdc93f35, 0x3f75bf0e, 0xbf7f3f35, 0xbe953f55
.long 0xbf553f80, 0x3e483ec4, 0x3f55bf80, 0xbe48bec4, 0xbf753f35, 0xbf463f7b, 0xbe953f35, 0x3f22be48
.long 0xbec4250d, 0xbf6d3f35, 0xbec4250d, 0xbf6d3f35, 0x3ef1bf35, 0xbdc9be48, 0x3f62bf35, 0x3f7fbf7b
.long 0x3f7bbf80, 0x3f55bf6d, 0xbf7b3f80, 0xbf553f6d, 0x3f46bf35, 0x3f62bf55, 0x3f22bf35, 0x3ef1bf0e
.long 0x3f800000, 0xbf80250d, 0x3f800000, 0xbf80250d, 0x3e953f6d, 0xbdc9bf7b, 0xbf753ec4, 0x3f7fbe48
.long 0xbf553f35, 0x3f7bbec4, 0x3f55bf35, 0xbf7b3ec4, 0xbf46bec4, 0x3e953f55, 0xbf223f6d, 0x3f75bf0e
.long 0x3ec4bf80, 0xbf6d3f35, 0x3ec4bf80, 0xbf6d3f35, 0x3f7fbec4, 0xbef1bf0e, 0xbdc93f6d, 0x3f62bf55
.long 0x3e483f35, 0x3f55bf6d, 0xbe48bf35, 0xbf553f6d, 0xbf623f6d, 0x3f223e48, 0x3ef13ec4, 0x3f46bf7b
.long 0xbf35250d, 0xbf353f80, 0xbf35250d, 0xbf353f80, 0x3ef1bf6d, 0xbf463e48, 0x3f62bec4, 0x3f22bf7b
.long 0x3f7bbf35, 0x3f0ebf6d, 0xbf7b3f35, 0xbf0e3f6d, 0x3dc93ec4, 0x3f62bf0e, 0x3f7fbf6d, 0x3ef1bf55
.long 0xbf6d3f80, 0xbec43f35, 0xbf6d3f80, 0xbec43f35, 0xbf223ec4, 0xbf753f55, 0x3f46bf6d, 0x3e95bf0e
.long 0x3f0ebf35, 0x3e48bec4, 0xbf0e3f35, 0xbe483ec4, 0x3f75bf6d, 0x3f7fbf7b, 0x3e95bec4, 0x3dc9be48
.long 0x3f800000, 0xbf80250d, 0x3f800000, 0xbf80250d, 0xbf7f250d, 0x3f753e48, 0x3dc9bf80, 0xbe953f7b
.long 0x3f7b0000, 0xbf55bec4, 0xbf7b250d, 0x3f553ec4, 0xbf75250d, 0x3f223f0e, 0xbe953f80, 0x3f46bf55
.long 0x3f6d0000, 0xbec4bf35, 0x3f6d0000, 0xbec4bf35, 0xbf62250d, 0x3dc93f55, 0x3ef1bf80, 0xbf7f3f0e
.long 0x3f550000, 0x3e48bf6d, 0xbf55250d, 0xbe483f6d, 0xbf46250d, 0xbef13f7b, 0xbf223f80, 0x3f62be48
.long 0x3f350000, 0x3f35bf80, 0x3f350000, 0x3f35bf80, 0xbf22250d, 0xbf623f7b, 0x3f46bf80, 0xbef1be48
.long 0x3f0e0000, 0x3f7bbf6d, 0xbf0e250d, 0xbf7b3f6d, 0xbef1250d, 0xbf7f3f55, 0xbf623f80, 0xbdc93f0e
.long 0x3ec40000, 0x3f6dbf35, 0x3ec40000, 0x3f6dbf35, 0xbe95250d, 0xbf463f0e, 0x3f75bf80, 0x3f22bf55
.long 0x3e480000, 0x3f0ebec4, 0xbe48250d, 0xbf0e3ec4, 0xbdc9250d, 0xbe953e48, 0xbf7f3f80, 0xbf753f7b
.long 0x3f800000, 0xbf80250d, 0x3f800000, 0xbf80250d, 0xbf62bec4, 0x3f463f0e, 0x3ef1bf6d, 0xbf223f55
.long 0x3f0e3f35, 0xbe48bf6d, 0xbf0ebf35, 0x3e483f6d, 0xbdc9bf6d, 0xbef13f7b, 0xbf7f3ec4, 0x3f623e48
.long 0xbec43f80, 0x3f6dbf35, 0xbec43f80, 0x3f6dbf35, 0x3f46bf6d, 0xbf753e48, 0x3f223ec4, 0x3e95bf7b
.long 0xbf7b3f35, 0x3f0e3ec4, 0x3f7bbf35, 0xbf0ebec4, 0x3f75bec4, 0x3dc9bf55, 0x3e95bf6d, 0xbf7f3f0e
.long 0xbf35250d, 0xbf353f80, 0xbf35250d, 0xbf353f80, 0x3e953ec4, 0x3f7fbf55, 0xbf753f6d, 0x3dc93f0e
.long 0x3e48bf35, 0xbf553ec4, 0xbe483f35, 0x3f55bec4, 0xbf223f6d, 0x3e953e48, 0x3f46bec4, 0x3f75bf7b
.long 0x3f6dbf80, 0x3ec4bf35, 0x3f6dbf80, 0x3ec4bf35, 0xbf7f3f6d, 0xbf623f7b, 0x3dc9bec4, 0xbef13e48
.long 0x3f55bf35, 0x3f7bbf6d, 0xbf553f35, 0xbf7b3f6d, 0xbef13ec4, 0xbf223f0e, 0xbf623f6d, 0xbf463f55
.long 0x3f800000, 0xbf80250d, 0x3f800000, 0xbf80250d, 0xbf22bf35, 0x3ef13f55, 0x3f46bf35, 0xbf623f0e
.long 0xbe483f80, 0x3f0ebf6d, 0x3e48bf80, 0xbf0e3f6d, 0x3f62bf35, 0xbf7f3e48, 0xbef1bf35, 0xbdc93f7b
.long 0xbf6d250d, 0x3ec43f35, 0xbf6d250d, 0x3ec43f35, 0x3e953f35, 0x3f22bf7b, 0xbf753f35, 0x3f463e48
.long 0x3f0ebf80, 0xbf7b3ec4, 0xbf0e3f80, 0x3f7bbec4, 0xbf7f3f35, 0x3e953f0e, 0x3dc93f35, 0x3f75bf55
.long 0x3f350000, 0x3f35bf80, 0x3f350000, 0x3f35bf80, 0x3dc9bf35, 0xbf753f0e, 0x3f7fbf35, 0x3e95bf55
.long 0xbf553f80, 0x3e483ec4, 0x3f55bf80, 0xbe48bec4, 0x3f75bf35, 0x3f46bf7b, 0x3e95bf35, 0xbf223e48
.long 0xbec4250d, 0xbf6d3f35, 0xbec4250d, 0xbf6d3f35, 0xbef13f35, 0x3dc93e48, 0xbf623f35, 0xbf7f3f7b
.long 0x3f7bbf80, 0x3f55bf6d, 0xbf7b3f80, 0xbf553f6d, 0xbf463f35, 0xbf623f55, 0xbf223f35, 0xbef13f0e
.long 0x3f800000, 0xbf80250d, 0x3f800000, 0xbf80250d, 0xbe95bf6d, 0x3dc93f7b, 0x3f75bec4, 0xbf7f3e48
.long 0xbf553f35, 0x3f7bbec4, 0x3f55bf35, 0xbf7b3ec4, 0x3f463ec4, 0xbe95bf55, 0x3f22bf6d, 0xbf753f0e
.long 0x3ec4bf80, 0xbf6d3f35, 0x3ec4bf80, 0xbf6d3f35, 0xbf7f3ec4, 0x3ef13f0e, 0x3dc9bf6d, 0xbf623f55
.long 0x3e483f35, 0x3f55bf6d, 0xbe48bf35, 0xbf553f6d, 0x3f62bf6d, 0xbf22be48, 0xbef1bec4, 0xbf463f7b
.long 0xbf35250d, 0xbf353f80, 0xbf35250d, 0xbf353f80, 0xbef13f6d, 0x3f46be48, 0xbf623ec4, 0xbf223f7b
.long 0x3f7bbf35, 0x3f0ebf6d, 0xbf7b3f35, 0xbf0e3f6d, 0xbdc9bec4, 0xbf623f0e, 0xbf7f3f6d, 0xbef13f55
.long 0xbf6d3f80, 0xbec43f35, 0xbf6d3f80, 0xbec43f35, 0x3f22bec4, 0x3f75bf55, 0xbf463f6d, 0xbe953f0e
.long 0x3f0ebf35, 0x3e48bec4, 0xbf0e3f35, 0xbe483ec4, 0xbf753f6d, 0xbf7f3f7b, 0xbe953ec4, 0xbdc93e48
.long 0xbf803f80, 0xbf803f80, 0xbf803f80, 0xbf803f80, 0xbf7f3f80, 0xbf753f7b, 0x3dc9248d, 0x3e95be48
.long 0xbf7b3f80, 0xbf553f6d, 0x3f7bbf80, 0x3f55bf6d, 0xbf753f80, 0xbf223f55, 0xbe95a554, 0xbf463f0e
.long 0xbf6d3f80, 0xbec43f35, 0xbf6d3f80, 0xbec43f35, 0xbf623f80, 0xbdc93f0e, 0x3ef1248d, 0x3f7fbf55
.long 0xbf553f80, 0x3e483ec4, 0x3f55bf80, 0xbe48bec4, 0xbf463f80, 0x3ef13e48, 0xbf22a554, 0xbf623f7b
.long 0xbf353f80, 0x3f35248d, 0xbf353f80, 0x3f35248d, 0xbf223f80, 0x3f62be48, 0x3f46248d, 0x3ef1bf7b
.long 0xbf0e3f80, 0x3f7bbec4, 0x3f0ebf80, 0xbf7b3ec4, 0xbef13f80, 0x3f7fbf0e, 0xbf62a554, 0x3dc93f55
.long 0xbec43f80, 0x3f6dbf35, 0xbec43f80, 0x3f6dbf35, 0xbe953f80, 0x3f46bf55, 0x3f75248d, 0xbf22bf0e
.long 0xbe483f80, 0x3f0ebf6d, 0x3e48bf80, 0xbf0e3f6d, 0xbdc93f80, 0x3e95bf7b, 0xbf7fa554, 0x3f753e48
.long 0xbf803f80, 0xbf803f80, 0xbf803f80, 0xbf803f80, 0xbf623f6d, 0xbf463f55, 0x3ef1bec4, 0x3f22bf0e
.long 0xbf0e3f35, 0xbe483ec4, 0x3f0ebf35, 0x3e48bec4, 0xbdc93ec4, 0x3ef1be48, 0xbf7f3f6d, 0xbf623f7b
.long 0x3ec4248d, 0x3f6dbf35, 0x3ec4248d, 0x3f6dbf35, 0x3f46bec4, 0x3f75bf7b, 0x3f22bf6d, 0xbe95be48
.long 0x3f7bbf35, 0x3f0ebf6d, 0xbf7b3f35, 0xbf0e3f6d, 0x3f75bf6d, 0xbdc9bf0e, 0x3e953ec4, 0x3f7fbf55
.long 0x3f35bf80, 0xbf35a554, 0x3f35bf80, 0xbf35a554, 0x3e95bf6d, 0xbf7f3f0e, 0xbf753ec4, 0xbdc93f55
.long 0xbe48bf35, 0xbf553f6d, 0x3e483f35, 0x3f55bf6d, 0xbf22bec4, 0xbe953f7b, 0x3f46bf6d, 0xbf753e48
.long 0xbf6da554, 0x3ec43f35, 0xbf6da554, 0x3ec43f35, 0xbf7f3ec4, 0x3f623e48, 0x3dc93f6d, 0x3ef1bf7b
.long 0xbf553f35, 0x3f7bbec4, 0x3f55bf35, 0xbf7b3ec4, 0xbef13f6d, 0x3f22bf55, 0xbf62bec4, 0x3f463f0e
.long 0xbf803f80, 0xbf803f80, 0xbf803f80, 0xbf803f80, 0xbf223f35, 0xbef13f0e, 0x3f46bf35, 0x3f62bf55
.long 0x3e48248d, 0x3f0ebec4, 0xbe48a554, 0xbf0e3ec4, 0x3f62bf35, 0x3f7fbf7b, 0xbef13f35, 0x3dc93e48
.long 0x3f6dbf80, 0x3ec4bf35, 0x3f6dbf80, 0x3ec4bf35, 0x3e95bf35, 0xbf223e48, 0xbf753f35, 0xbf463f7b
.long 0xbf0ea554, 0xbf7b3f6d, 0x3f0e248d, 0x3f7bbf6d, 0xbf7f3f35, 0xbe953f55, 0x3dc9bf35, 0xbf753f0e
.long 0xbf353f80, 0x3f35248d, 0xbf353f80, 0x3f35248d, 0x3dc93f35, 0x3f75bf55, 0x3f7fbf35, 0xbe95bf0e
.long 0x3f55248d, 0x3e48bf6d, 0xbf55a554, 0xbe483f6d, 0x3f75bf35, 0xbf46be48, 0x3e953f35, 0x3f22bf7b
.long 0x3ec4bf80, 0xbf6d3f35, 0x3ec4bf80, 0xbf6d3f35, 0xbef1bf35, 0xbdc93f7b, 0xbf623f35, 0x3f7fbe48
.long 0xbf7ba554, 0x3f553ec4, 0x3f7b248d, 0xbf55bec4, 0xbf463f35, 0x3f62bf0e, 0xbf22bf35, 0x3ef13f55
.long 0xbf803f80, 0xbf803f80, 0xbf803f80, 0xbf803f80, 0xbe953ec4, 0xbdc93e48, 0x3f75bf6d, 0x3f7fbf7b
.long 0x3f55bf35, 0x3f7bbf6d, 0xbf553f35, 0xbf7b3f6d, 0x3f46bf6d, 0x3e95bf0e, 0x3f22bec4, 0x3f75bf55
.long 0xbec4a554, 0xbf6d3f35, 0xbec4a554, 0xbf6d3f35, 0xbf7f3f6d, 0xbef13f55, 0x3dc93ec4, 0x3f62bf0e
.long 0xbe483f35, 0x3f55bec4, 0x3e48bf35, 0xbf553ec4, 0x3f62bec4, 0x3f22bf7b, 0xbef13f6d, 0x3f46be48
.long 0x3f35bf80, 0xbf35a554, 0x3f35bf80, 0xbf35a554, 0xbef1bec4, 0xbf463f7b, 0xbf623f6d, 0x3f223e48
.long 0xbf7b3f35, 0x3f0e3ec4, 0x3f7bbf35, 0xbf0ebec4, 0xbdc93f6d, 0x3f62bf55, 0xbf7f3ec4, 0x3ef13f0e
.long 0x3f6d248d, 0xbec4bf35, 0x3f6d248d, 0xbec4bf35, 0x3f22bf6d, 0xbf753f0e, 0xbf46bec4, 0x3e953f55
.long 0xbf0ebf35, 0x3e483f6d, 0x3f0e3f35, 0xbe48bf6d, 0xbf753ec4, 0x3f7fbe48, 0xbe95bf6d, 0x3dc93f7b
.long 0xbf803f80, 0xbf803f80, 0xbf803f80, 0xbf803f80, 0x3f7fbf80, 0x3f75bf7b, 0xbdc9a554, 0xbe953e48
.long 0xbf7b3f80, 0xbf553f6d, 0x3f7bbf80, 0x3f55bf6d, 0x3f75bf80, 0x3f22bf55, 0x3e95248d, 0x3f46bf0e
.long 0xbf6d3f80, 0xbec43f35, 0xbf6d3f80, 0xbec43f35, 0x3f62bf80, 0x3dc9bf0e, 0xbef1a554, 0xbf7f3f55
.long 0xbf553f80, 0x3e483ec4, 0x3f55bf80, 0xbe48bec4, 0x3f46bf80, 0xbef1be48, 0x3f22248d, 0x3f62bf7b
.long 0xbf353f80, 0x3f35248d, 0xbf353f80, 0x3f35248d, 0x3f22bf80, 0xbf623e48, 0xbf46a554, 0xbef13f7b
.long 0xbf0e3f80, 0x3f7bbec4, 0x3f0ebf80, 0xbf7b3ec4, 0x3ef1bf80, 0xbf7f3f0e, 0x3f62248d, 0xbdc9bf55
.long 0xbec43f80, 0x3f6dbf35, 0xbec43f80, 0x3f6dbf35, 0x3e95bf80, 0xbf463f55, 0xbf75a554, 0x3f223f0e
.long 0xbe483f80, 0x3f0ebf6d, 0x3e48bf80, 0xbf0e3f6d, 0x3dc9bf80, 0xbe953f7b, 0x3f7f248d, 0xbf75be48
.long 0xbf803f80, 0xbf803f80, 0xbf803f80, 0xbf803f80, 0x3f62bf6d, 0x3f46bf55, 0xbef13ec4, 0xbf223f0e
.long 0xbf0e3f35, 0xbe483ec4, 0x3f0ebf35, 0x3e48bec4, 0x3dc9bec4, 0xbef13e48, 0x3f7fbf6d, 0x3f62bf7b
.long 0x3ec4248d, 0x3f6dbf35, 0x3ec4248d, 0x3f6dbf35, 0xbf463ec4, 0xbf753f7b, 0xbf223f6d, 0x3e953e48
.long 0x3f7bbf35, 0x3f0ebf6d, 0xbf7b3f35, 0xbf0e3f6d, 0xbf753f6d, 0x3dc93f0e, 0xbe95bec4, 0xbf7f3f55
.long 0x3f35bf80, 0xbf35a554, 0x3f35bf80, 0xbf35a554, 0xbe953f6d, 0x3f7fbf0e, 0x3f75bec4, 0x3dc9bf55
.long 0xbe48bf35, 0xbf553f6d, 0x3e483f35, 0x3f55bf6d, 0x3f223ec4, 0x3e95bf7b, 0xbf463f6d, 0x3f75be48
.long 0xbf6da554, 0x3ec43f35, 0xbf6da554, 0x3ec43f35, 0x3f7fbec4, 0xbf62be48, 0xbdc9bf6d, 0xbef13f7b
.long 0xbf553f35, 0x3f7bbec4, 0x3f55bf35, 0xbf7b3ec4, 0x3ef1bf6d, 0xbf223f55, 0x3f623ec4, 0xbf46bf0e
.long 0xbf803f80, 0xbf803f80, 0xbf803f80, 0xbf803f80, 0x3f22bf35, 0x3ef1bf0e, 0xbf463f35, 0xbf623f55
.long 0x3e48248d, 0x3f0ebec4, 0xbe48a554, 0xbf0e3ec4, 0xbf623f35, 0xbf7f3f7b, 0x3ef1bf35, 0xbdc9be48
.long 0x3f6dbf80, 0x3ec4bf35, 0x3f6dbf80, 0x3ec4bf35, 0xbe953f35, 0x3f22be48, 0x3f75bf35, 0x3f46bf7b
.long 0xbf0ea554, 0xbf7b3f6d, 0x3f0e248d, 0x3f7bbf6d, 0x3f7fbf35, 0x3e95bf55, 0xbdc93f35, 0x3f75bf0e
.long 0xbf353f80, 0x3f35248d, 0xbf353f80, 0x3f35248d, 0xbdc9bf35, 0xbf753f55, 0xbf7f3f35, 0x3e953f0e
.long 0x3f55248d, 0x3e48bf6d, 0xbf55a554, 0xbe483f6d, 0xbf753f35, 0x3f463e48, 0xbe95bf35, 0xbf223f7b
.long 0x3ec4bf80, 0xbf6d3f35, 0x3ec4bf80, 0xbf6d3f35, 0x3ef13f35, 0x3dc9bf7b, 0x3f62bf35, 0xbf7f3e48
.long 0xbf7ba554, 0x3f553ec4, 0x3f7b248d, 0xbf55bec4, 0x3f46bf35, 0xbf623f0e, 0x3f223f35, 0xbef1bf55
.long 0xbf803f80, 0xbf803f80, 0xbf803f80, 0xbf803f80, 0x3e95bec4, 0x3dc9be48, 0xbf753f6d, 0xbf7f3f7b
.long 0x3f55bf35, 0x3f7bbf6d, 0xbf553f35, 0xbf7b3f6d, 0xbf463f6d, 0xbe953f0e, 0xbf223ec4, 0xbf753f55
.long 0xbec4a554, 0xbf6d3f35, 0xbec4a554, 0xbf6d3f35, 0x3f7fbf6d, 0x3ef1bf55, 0xbdc9bec4, 0xbf623f0e
.long 0xbe483f35, 0x3f55bec4, 0x3e48bf35, 0xbf553ec4, 0xbf623ec4, 0xbf223f7b, 0x3ef1bf6d, 0xbf463e48
.long 0x3f35bf80, 0xbf35a554, 0x3f35bf80, 0xbf35a554, 0x3ef13ec4, 0x3f46bf7b, 0x3f62bf6d, 0xbf22be48
.long 0xbf7b3f35, 0x3f0e3ec4, 0x3f7bbf35, 0xbf0ebec4, 0x3dc9bf6d, 0xbf623f55, 0x3f7fbec4, 0xbef1bf0e
.long 0x3f6d248d, 0xbec4bf35, 0x3f6d248d, 0xbec4bf35, 0xbf223f6d, 0x3f75bf0e, 0x3f463ec4, 0xbe95bf55
.long 0xbf0ebf35, 0x3e483f6d, 0x3f0e3f35, 0xbe48bf6d, 0x3f75bec4, 0xbf7f3e48, 0x3e953f6d, 0xbdc9bf7b
.long 0x250d0000, 0x250d0000, 0x250d0000, 0x250d0000, 0xbdc90000, 0xbe953e48, 0xbf7f3f80, 0xbf753f7b
.long 0xbe480000, 0xbf0e3ec4, 0x3e48250d, 0x3f0ebec4, 0xbe950000, 0xbf463f0e, 0x3f75bf80, 0x3f22bf55
.long 0xbec40000, 0xbf6d3f35, 0xbec40000, 0xbf6d3f35, 0xbef10000, 0xbf7f3f55, 0xbf623f80, 0xbdc93f0e
.long 0xbf0e0000, 0xbf7b3f6d, 0x3f0e250d, 0x3f7bbf6d, 0xbf220000, 0xbf623f7b, 0x3f46bf80, 0xbef1be48
.long 0xbf350000, 0xbf353f80, 0xbf350000, 0xbf353f80, 0xbf460000, 0xbef13f7b, 0xbf223f80, 0x3f62be48
.long 0xbf550000, 0xbe483f6d, 0x3f55250d, 0x3e48bf6d, 0xbf620000, 0x3dc93f55, 0x3ef1bf80, 0xbf7f3f0e
.long 0xbf6d0000, 0x3ec43f35, 0xbf6d0000, 0x3ec43f35, 0xbf750000, 0x3f223f0e, 0xbe953f80, 0x3f46bf55
.long 0xbf7b0000, 0x3f553ec4, 0x3f7b250d, 0xbf55bec4, 0xbf7f0000, 0x3f753e48, 0x3dc9bf80, 0xbe953f7b
.long 0x250d0000, 0x250d0000, 0x250d0000, 0x250d0000, 0xbef13ec4, 0xbf223f0e, 0xbf623f6d, 0xbf463f55
.long 0xbf553f35, 0xbf7b3f6d, 0x3f55bf35, 0x3f7bbf6d, 0xbf7f3f6d, 0xbf623f7b, 0x3dc9bec4, 0xbef13e48
.long 0xbf6d3f80, 0xbec43f35, 0xbf6d3f80, 0xbec43f35, 0xbf223f6d, 0x3e953e48, 0x3f46bec4, 0x3f75bf7b
.long 0xbe483f35, 0x3f55bec4, 0x3e48bf35, 0xbf553ec4, 0x3e953ec4, 0x3f7fbf55, 0xbf753f6d, 0x3dc93f0e
.long 0x3f35250d, 0x3f35bf80, 0x3f35250d, 0x3f35bf80, 0x3f75bec4, 0x3dc9bf55, 0x3e95bf6d, 0xbf7f3f0e
.long 0x3f7bbf35, 0xbf0ebec4, 0xbf7b3f35, 0x3f0e3ec4, 0x3f46bf6d, 0xbf753e48, 0x3f223ec4, 0x3e95bf7b
.long 0x3ec4bf80, 0xbf6d3f35, 0x3ec4bf80, 0xbf6d3f35, 0xbdc9bf6d, 0xbef13f7b, 0xbf7f3ec4, 0x3f623e48
.long 0xbf0ebf35, 0x3e483f6d, 0x3f0e3f35, 0xbe48bf6d, 0xbf62bec4, 0x3f463f0e, 0x3ef1bf6d, 0xbf223f55
.long 0x250d0000, 0x250d0000, 0x250d0000, 0x250d0000, 0xbf463f35, 0xbf623f55, 0xbf223f35, 0xbef13f0e
.long 0xbf7b3f80, 0xbf553f6d, 0x3f7bbf80, 0x3f55bf6d, 0xbef13f35, 0x3dc93e48, 0xbf623f35, 0xbf7f3f7b
.long 0x3ec4250d, 0x3f6dbf35, 0x3ec4250d, 0x3f6dbf35, 0x3f75bf35, 0x3f46bf7b, 0x3e95bf35, 0xbf223e48
.long 0x3f55bf80, 0xbe48bec4, 0xbf553f80, 0x3e483ec4, 0x3dc9bf35, 0xbf753f0e, 0x3f7fbf35, 0x3e95bf55
.long 0xbf350000, 0xbf353f80, 0xbf350000, 0xbf353f80, 0xbf7f3f35, 0x3e953f0e, 0x3dc93f35, 0x3f75bf55
.long 0xbf0e3f80, 0x3f7bbec4, 0x3f0ebf80, 0xbf7b3ec4, 0x3e953f35, 0x3f22bf7b, 0xbf753f35, 0x3f463e48
.long 0x3f6d250d, 0xbec4bf35, 0x3f6d250d, 0xbec4bf35, 0x3f62bf35, 0xbf7f3e48, 0xbef1bf35, 0xbdc93f7b
.long 0x3e48bf80, 0xbf0e3f6d, 0xbe483f80, 0x3f0ebf6d, 0xbf22bf35, 0x3ef13f55, 0x3f46bf35, 0xbf623f0e
.long 0x250d0000, 0x250d0000, 0x250d0000, 0x250d0000, 0xbf753f6d, 0xbf7f3f7b, 0xbe953ec4, 0xbdc93e48
.long 0xbf0e3f35, 0xbe483ec4, 0x3f0ebf35, 0x3e48bec4, 0x3f22bec4, 0x3f75bf55, 0xbf463f6d, 0xbe953f0e
.long 0x3f6dbf80, 0x3ec4bf35, 0x3f6dbf80, 0x3ec4bf35, 0xbdc9bec4, 0xbf623f0e, 0xbf7f3f6d, 0xbef13f55
.long 0xbf7b3f35, 0xbf0e3f6d, 0x3f7bbf35, 0x3f0ebf6d, 0xbef13f6d, 0x3f46be48, 0xbf623ec4, 0xbf223f7b
.long 0x3f35250d, 0x3f35bf80, 0x3f35250d, 0x3f35bf80, 0x3f62bf6d, 0xbf22be48, 0xbef1bec4, 0xbf463f7b
.long 0xbe48bf35, 0xbf553f6d, 0x3e483f35, 0x3f55bf6d, 0xbf7f3ec4, 0x3ef13f0e, 0x3dc9bf6d, 0xbf623f55
.long 0xbec43f80, 0x3f6dbf35, 0xbec43f80, 0x3f6dbf35, 0x3f463ec4, 0xbe95bf55, 0x3f22bf6d, 0xbf753f0e
.long 0x3f55bf35, 0xbf7b3ec4, 0xbf553f35, 0x3f7bbec4, 0xbe95bf6d, 0x3dc93f7b, 0x3f75bec4, 0xbf7f3e48
.long 0x250d0000, 0x250d0000, 0x250d0000, 0x250d0000, 0x3dc9250d, 0x3e95be48, 0x3f7fbf80, 0x3f75bf7b
.long 0xbe480000, 0xbf0e3ec4, 0x3e48250d, 0x3f0ebec4, 0x3e95250d, 0x3f46bf0e, 0xbf753f80, 0xbf223f55
.long 0xbec40000, 0xbf6d3f35, 0xbec40000, 0xbf6d3f35, 0x3ef1250d, 0x3f7fbf55, 0x3f62bf80, 0x3dc9bf0e
.long 0xbf0e0000, 0xbf7b3f6d, 0x3f0e250d, 0x3f7bbf6d, 0x3f22250d, 0x3f62bf7b, 0xbf463f80, 0x3ef13e48
.long 0xbf350000, 0xbf353f80, 0xbf350000, 0xbf353f80, 0x3f46250d, 0x3ef1bf7b, 0x3f22bf80, 0xbf623e48
.long 0xbf550000, 0xbe483f6d, 0x3f55250d, 0x3e48bf6d, 0x3f62250d, 0xbdc9bf55, 0xbef13f80, 0x3f7fbf0e
.long 0xbf6d0000, 0x3ec43f35, 0xbf6d0000, 0x3ec43f35, 0x3f75250d, 0xbf22bf0e, 0x3e95bf80, 0xbf463f55
.long 0xbf7b0000, 0x3f553ec4, 0x3f7b250d, 0xbf55bec4, 0x3f7f250d, 0xbf75be48, 0xbdc93f80, 0x3e95bf7b
.long 0x250d0000, 0x250d0000, 0x250d0000, 0x250d0000, 0x3ef1bec4, 0x3f22bf0e, 0x3f62bf6d, 0x3f46bf55
.long 0xbf553f35, 0xbf7b3f6d, 0x3f55bf35, 0x3f7bbf6d, 0x3f7fbf6d, 0x3f62bf7b, 0xbdc93ec4, 0x3ef1be48
.long 0xbf6d3f80, 0xbec43f35, 0xbf6d3f80, 0xbec43f35, 0x3f22bf6d, 0xbe95be48, 0xbf463ec4, 0xbf753f7b
.long 0xbe483f35, 0x3f55bec4, 0x3e48bf35, 0xbf553ec4, 0xbe95bec4, 0xbf7f3f55, 0x3f75bf6d, 0xbdc9bf0e
.long 0x3f35250d, 0x3f35bf80, 0x3f35250d, 0x3f35bf80, 0xbf753ec4, 0xbdc93f55, 0xbe953f6d, 0x3f7fbf0e
.long 0x3f7bbf35, 0xbf0ebec4, 0xbf7b3f35, 0x3f0e3ec4, 0xbf463f6d, 0x3f75be48, 0xbf22bec4, 0xbe953f7b
.long 0x3ec4bf80, 0xbf6d3f35, 0x3ec4bf80, 0xbf6d3f35, 0x3dc93f6d, 0x3ef1bf7b, 0x3f7fbec4, 0xbf62be48
.long 0xbf0ebf35, 0x3e483f6d, 0x3f0e3f35, 0xbe48bf6d, 0x3f623ec4, 0xbf46bf0e, 0xbef13f6d, 0x3f22bf55
.long 0x250d0000, 0x250d0000, 0x250d0000, 0x250d0000, 0x3f46bf35, 0x3f62bf55, 0x3f22bf35, 0x3ef1bf0e
.long 0xbf7b3f80, 0xbf553f6d, 0x3f7bbf80, 0x3f55bf6d, 0x3ef1bf35, 0xbdc9be48, 0x3f62bf35, 0x3f7fbf7b
.long 0x3ec4250d, 0x3f6dbf35, 0x3ec4250d, 0x3f6dbf35, 0xbf753f35, 0xbf463f7b, 0xbe953f35, 0x3f22be48
.long 0x3f55bf80, 0xbe48bec4, 0xbf553f80, 0x3e483ec4, 0xbdc93f35, 0x3f75bf0e, 0xbf7f3f35, 0xbe953f55
.long 0xbf350000, 0xbf353f80, 0xbf350000, 0xbf353f80, 0x3f7fbf35, 0xbe95bf0e, 0xbdc9bf35, 0xbf753f55
.long 0xbf0e3f80, 0x3f7bbec4, 0x3f0ebf80, 0xbf7b3ec4, 0xbe95bf35, 0xbf223f7b, 0x3f75bf35, 0xbf46be48
.long 0x3f6d250d, 0xbec4bf35, 0x3f6d250d, 0xbec4bf35, 0xbf623f35, 0x3f7fbe48, 0x3ef13f35, 0x3dc9bf7b
.long 0x3e48bf80, 0xbf0e3f6d, 0xbe483f80, 0x3f0ebf6d, 0x3f223f35, 0xbef1bf55, 0xbf463f35, 0x3f62bf0e
.long 0x250d0000, 0x250d0000, 0x250d0000, 0x250d0000, 0x3f75bf6d, 0x3f7fbf7b, 0x3e95bec4, 0x3dc9be48
.long 0xbf0e3f35, 0xbe483ec4, 0x3f0ebf35, 0x3e48bec4, 0xbf223ec4, 0xbf753f55, 0x3f46bf6d, 0x3e95bf0e
.long 0x3f6dbf80, 0x3ec4bf35, 0x3f6dbf80, 0x3ec4bf35, 0x3dc93ec4, 0x3f62bf0e, 0x3f7fbf6d, 0x3ef1bf55
.long 0xbf7b3f35, 0xbf0e3f6d, 0x3f7bbf35, 0x3f0ebf6d, 0x3ef1bf6d, 0xbf463e48, 0x3f62bec4, 0x3f22bf7b
.long 0x3f35250d, 0x3f35bf80, 0x3f35250d, 0x3f35bf80, 0xbf623f6d, 0x3f223e48, 0x3ef13ec4, 0x3f46bf7b
.long 0xbe48bf35, 0xbf553f6d, 0x3e483f35, 0x3f55bf6d, 0x3f7fbec4, 0xbef1bf0e, 0xbdc93f6d, 0x3f62bf55
.long 0xbec43f80, 0x3f6dbf35, 0xbec43f80, 0x3f6dbf35, 0xbf46bec4, 0x3e953f55, 0xbf223f6d, 0x3f75bf0e
.long 0x3f55bf35, 0xbf7b3ec4, 0xbf553f35, 0x3f7bbec4, 0x3e953f6d, 0xbdc9bf7b, 0xbf753ec4, 0x3f7fbe48
.long 0xa5543f80, 0x248dbf80, 0xa5543f80, 0x248dbf80, 0x3dc93f80, 0xbe95bf7b, 0x3f7f248d, 0xbf753e48
.long 0x3e483f80, 0xbf0ebf6d, 0xbe48bf80, 0x3f0e3f6d, 0x3e953f80, 0xbf46bf55, 0xbf75a554, 0x3f22bf0e
.long 0x3ec43f80, 0xbf6dbf35, 0x3ec43f80, 0xbf6dbf35, 0x3ef13f80, 0xbf7fbf0e, 0x3f62248d, 0xbdc93f55
.long 0x3f0e3f80, 0xbf7bbec4, 0xbf0ebf80, 0x3f7b3ec4, 0x3f223f80, 0xbf62be48, 0xbf46a554, 0xbef1bf7b
.long 0x3f353f80, 0xbf35a554, 0x3f353f80, 0xbf35a554, 0x3f463f80, 0xbef13e48, 0x3f22248d, 0x3f623f7b
.long 0x3f553f80, 0xbe483ec4, 0xbf55bf80, 0x3e48bec4, 0x3f623f80, 0x3dc93f0e, 0xbef1a554, 0xbf7fbf55
.long 0x3f6d3f80, 0x3ec43f35, 0x3f6d3f80, 0x3ec43f35, 0x3f753f80, 0x3f223f55, 0x3e95248d, 0x3f463f0e
.long 0x3f7b3f80, 0x3f553f6d, 0xbf7bbf80, 0xbf55bf6d, 0x3f7f3f80, 0x3f753f7b, 0xbdc9a554, 0xbe95be48
.long 0xa5543f80, 0x248dbf80, 0xa5543f80, 0x248dbf80, 0x3ef13f6d, 0xbf22bf55, 0x3f62bec4, 0xbf463f0e
.long 0x3f553f35, 0xbf7bbec4, 0xbf55bf35, 0x3f7b3ec4, 0x3f7f3ec4, 0xbf623e48, 0xbdc93f6d, 0xbef1bf7b
.long 0x3f6d248d, 0xbec43f35, 0x3f6d248d, 0xbec43f35, 0x3f22bec4, 0x3e953f7b, 0xbf46bf6d, 0x3f753e48
.long 0x3e48bf35, 0x3f553f6d, 0xbe483f35, 0xbf55bf6d, 0xbe95bf6d, 0x3f7f3f0e, 0x3f753ec4, 0x3dc93f55
.long 0xbf35bf80, 0x3f35248d, 0xbf35bf80, 0x3f35248d, 0xbf75bf6d, 0x3dc9bf0e, 0xbe953ec4, 0xbf7fbf55
.long 0xbf7bbf35, 0xbf0ebf6d, 0x3f7b3f35, 0x3f0e3f6d, 0xbf46bec4, 0xbf75bf7b, 0xbf22bf6d, 0x3e95be48
.long 0xbec4a554, 0xbf6dbf35, 0xbec4a554, 0xbf6dbf35, 0x3dc93ec4, 0xbef1be48, 0x3f7f3f6d, 0x3f623f7b
.long 0x3f0e3f35, 0x3e483ec4, 0xbf0ebf35, 0xbe48bec4, 0x3f623f6d, 0x3f463f55, 0xbef1bec4, 0xbf22bf0e
.long 0xa5543f80, 0x248dbf80, 0xa5543f80, 0x248dbf80, 0x3f463f35, 0xbf62bf0e, 0x3f22bf35, 0xbef13f55
.long 0x3f7b248d, 0xbf553ec4, 0xbf7ba554, 0x3f55bec4, 0x3ef1bf35, 0x3dc93f7b, 0x3f623f35, 0xbf7fbe48
.long 0xbec4bf80, 0x3f6d3f35, 0xbec4bf80, 0x3f6d3f35, 0xbf75bf35, 0x3f46be48, 0xbe953f35, 0xbf22bf7b
.long 0xbf55a554, 0xbe48bf6d, 0x3f55248d, 0x3e483f6d, 0xbdc93f35, 0xbf75bf55, 0xbf7fbf35, 0x3e95bf0e
.long 0x3f353f80, 0xbf35a554, 0x3f353f80, 0xbf35a554, 0x3f7f3f35, 0x3e953f55, 0xbdc9bf35, 0x3f753f0e
.long 0x3f0e248d, 0x3f7b3f6d, 0xbf0ea554, 0xbf7bbf6d, 0xbe95bf35, 0x3f223e48, 0x3f753f35, 0x3f463f7b
.long 0xbf6dbf80, 0xbec4bf35, 0xbf6dbf80, 0xbec4bf35, 0xbf62bf35, 0xbf7fbf7b, 0x3ef13f35, 0xbdc93e48
.long 0xbe48a554, 0xbf0ebec4, 0x3e48248d, 0x3f0e3ec4, 0x3f223f35, 0x3ef13f0e, 0xbf46bf35, 0xbf62bf55
.long 0xa5543f80, 0x248dbf80, 0xa5543f80, 0x248dbf80, 0x3f753ec4, 0xbf7fbe48, 0x3e95bf6d, 0xbdc93f7b
.long 0x3f0ebf35, 0xbe483f6d, 0xbf0e3f35, 0x3e48bf6d, 0xbf22bf6d, 0x3f753f0e, 0x3f46bec4, 0xbe953f55
.long 0xbf6da554, 0x3ec4bf35, 0xbf6da554, 0x3ec4bf35, 0x3dc93f6d, 0xbf62bf55, 0x3f7f3ec4, 0xbef13f0e
.long 0x3f7b3f35, 0xbf0e3ec4, 0xbf7bbf35, 0x3f0ebec4, 0x3ef1bec4, 0x3f463f7b, 0x3f623f6d, 0xbf223e48
.long 0xbf35bf80, 0x3f35248d, 0xbf35bf80, 0x3f35248d, 0xbf62bec4, 0xbf22bf7b, 0x3ef13f6d, 0xbf46be48
.long 0x3e483f35, 0xbf55bec4, 0xbe48bf35, 0x3f553ec4, 0x3f7f3f6d, 0x3ef13f55, 0xbdc93ec4, 0xbf62bf0e
.long 0x3ec4248d, 0x3f6d3f35, 0x3ec4248d, 0x3f6d3f35, 0xbf46bf6d, 0xbe95bf0e, 0xbf22bec4, 0xbf75bf55
.long 0xbf55bf35, 0xbf7bbf6d, 0x3f553f35, 0x3f7b3f6d, 0x3e953ec4, 0x3dc93e48, 0xbf75bf6d, 0xbf7fbf7b
.long 0xa5543f80, 0x248dbf80, 0xa5543f80, 0x248dbf80, 0xbdc9bf80, 0x3e953f7b, 0xbf7fa554, 0x3f75be48
.long 0x3e483f80, 0xbf0ebf6d, 0xbe48bf80, 0x3f0e3f6d, 0xbe95bf80, 0x3f463f55, 0x3f75248d, 0xbf223f0e
.long 0x3ec43f80, 0xbf6dbf35, 0x3ec43f80, 0xbf6dbf35, 0xbef1bf80, 0x3f7f3f0e, 0xbf62a554, 0x3dc9bf55
.long 0x3f0e3f80, 0xbf7bbec4, 0xbf0ebf80, 0x3f7b3ec4, 0xbf22bf80, 0x3f623e48, 0x3f46248d, 0x3ef13f7b
.long 0x3f353f80, 0xbf35a554, 0x3f353f80, 0xbf35a554, 0xbf46bf80, 0x3ef1be48, 0xbf22a554, 0xbf62bf7b
.long 0x3f553f80, 0xbe483ec4, 0xbf55bf80, 0x3e48bec4, 0xbf62bf80, 0xbdc9bf0e, 0x3ef1248d, 0x3f7f3f55
.long 0x3f6d3f80, 0x3ec43f35, 0x3f6d3f80, 0x3ec43f35, 0xbf75bf80, 0xbf22bf55, 0xbe95a554, 0xbf46bf0e
.long 0x3f7b3f80, 0x3f553f6d, 0xbf7bbf80, 0xbf55bf6d, 0xbf7fbf80, 0xbf75bf7b, 0x3dc9248d, 0x3e953e48
.long 0xa5543f80, 0x248dbf80, 0xa5543f80, 0x248dbf80, 0xbef1bf6d, 0x3f223f55, 0xbf623ec4, 0x3f46bf0e
.long 0x3f553f35, 0xbf7bbec4, 0xbf55bf35, 0x3f7b3ec4, 0xbf7fbec4, 0x3f62be48, 0x3dc9bf6d, 0x3ef13f7b
.long 0x3f6d248d, 0xbec43f35, 0x3f6d248d, 0xbec43f35, 0xbf223ec4, 0xbe95bf7b, 0x3f463f6d, 0xbf75be48
.long 0x3e48bf35, 0x3f553f6d, 0xbe483f35, 0xbf55bf6d, 0x3e953f6d, 0xbf7fbf0e, 0xbf75bec4, 0xbdc9bf55
.long 0xbf35bf80, 0x3f35248d, 0xbf35bf80, 0x3f35248d, 0x3f753f6d, 0xbdc93f0e, 0x3e95bec4, 0x3f7f3f55
.long 0xbf7bbf35, 0xbf0ebf6d, 0x3f7b3f35, 0x3f0e3f6d, 0x3f463ec4, 0x3f753f7b, 0x3f223f6d, 0xbe953e48
.long 0xbec4a554, 0xbf6dbf35, 0xbec4a554, 0xbf6dbf35, 0xbdc9bec4, 0x3ef13e48, 0xbf7fbf6d, 0xbf62bf7b
.long 0x3f0e3f35, 0x3e483ec4, 0xbf0ebf35, 0xbe48bec4, 0xbf62bf6d, 0xbf46bf55, 0x3ef13ec4, 0x3f223f0e
.long 0xa5543f80, 0x248dbf80, 0xa5543f80, 0x248dbf80, 0xbf46bf35, 0x3f623f0e, 0xbf223f35, 0x3ef1bf55
.long 0x3f7b248d, 0xbf553ec4, 0xbf7ba554, 0x3f55bec4, 0xbef13f35, 0xbdc9bf7b, 0xbf62bf35, 0x3f7f3e48
.long 0xbec4bf80, 0x3f6d3f35, 0xbec4bf80, 0x3f6d3f35, 0x3f753f35, 0xbf463e48, 0x3e95bf35, 0x3f223f7b
.long 0xbf55a554, 0xbe48bf6d, 0x3f55248d, 0x3e483f6d, 0x3dc9bf35, 0x3f753f55, 0x3f7f3f35, 0xbe953f0e
.long 0x3f353f80, 0xbf35a554, 0x3f353f80, 0xbf35a554, 0xbf7fbf35, 0xbe95bf55, 0x3dc93f35, 0xbf75bf0e
.long 0x3f0e248d, 0x3f7b3f6d, 0xbf0ea554, 0xbf7bbf6d, 0x3e953f35, 0xbf22be48, 0xbf75bf35, 0xbf46bf7b
.long 0xbf6dbf80, 0xbec4bf35, 0xbf6dbf80, 0xbec4bf35, 0x3f623f35, 0x3f7f3f7b, 0xbef1bf35, 0x3dc9be48
.long 0xbe48a554, 0xbf0ebec4, 0x3e48248d, 0x3f0e3ec4, 0xbf22bf35, 0xbef1bf0e, 0x3f463f35, 0x3f623f55
.long 0xa5543f80, 0x248dbf80, 0xa5543f80, 0x248dbf80, 0xbf75bec4, 0x3f7f3e48, 0xbe953f6d, 0x3dc9bf7b
.long 0x3f0ebf35, 0xbe483f6d, 0xbf0e3f35, 0x3e48bf6d, 0x3f223f6d, 0xbf75bf0e, 0xbf463ec4, 0x3e95bf55
.long 0xbf6da554, 0x3ec4bf35, 0xbf6da554, 0x3ec4bf35, 0xbdc9bf6d, 0x3f623f55, 0xbf7fbec4, 0x3ef1bf0e
.long 0x3f7b3f35, 0xbf0e3ec4, 0xbf7bbf35, 0x3f0ebec4, 0xbef13ec4, 0xbf46bf7b, 0xbf62bf6d, 0x3f22be48
.long 0xbf35bf80, 0x3f35248d, 0xbf35bf80, 0x3f35248d, 0x3f623ec4, 0x3f223f7b, 0xbef1bf6d, 0x3f463e48
.long 0x3e483f35, 0xbf55bec4, 0xbe48bf35, 0x3f553ec4, 0xbf7fbf6d, 0xbef1bf55, 0x3dc9bec4, 0x3f623f0e
.long 0x3ec4248d, 0x3f6d3f35, 0x3ec4248d, 0x3f6d3f35, 0x3f463f6d, 0x3e953f0e, 0x3f223ec4, 0x3f753f55
.long 0xbf55bf35, 0xbf7bbf6d, 0x3f553f35, 0x3f7b3f6d, 0xbe95bec4, 0xbdc9be48, 0x3f753f6d, 0x3f7f3f7b
.long 0xbf800000, 0x3f80250d, 0xbf800000, 0x3f80250d, 0xbf7f0000, 0x3f75be48, 0x3dc93f80, 0xbe95bf7b
.long 0xbf7b0000, 0x3f55bec4, 0x3f7b250d, 0xbf553ec4, 0xbf750000, 0x3f22bf0e, 0xbe95bf80, 0x3f463f55
.long 0xbf6d0000, 0x3ec4bf35, 0xbf6d0000, 0x3ec4bf35, 0xbf620000, 0x3dc9bf55, 0x3ef13f80, 0xbf7fbf0e
.long 0xbf550000, 0xbe48bf6d, 0x3f55250d, 0x3e483f6d, 0xbf460000, 0xbef1bf7b, 0xbf22bf80, 0x3f623e48
.long 0xbf350000, 0xbf35bf80, 0xbf350000, 0xbf35bf80, 0xbf220000, 0xbf62bf7b, 0x3f463f80, 0xbef13e48
.long 0xbf0e0000, 0xbf7bbf6d, 0x3f0e250d, 0x3f7b3f6d, 0xbef10000, 0xbf7fbf55, 0xbf62bf80, 0xbdc9bf0e
.long 0xbec40000, 0xbf6dbf35, 0xbec40000, 0xbf6dbf35, 0xbe950000, 0xbf46bf0e, 0x3f753f80, 0x3f223f55
.long 0xbe480000, 0xbf0ebec4, 0x3e48250d, 0x3f0e3ec4, 0xbdc90000, 0xbe95be48, 0xbf7fbf80, 0xbf75bf7b
.long 0xbf800000, 0x3f80250d, 0xbf800000, 0x3f80250d, 0xbf623ec4, 0x3f46bf0e, 0x3ef13f6d, 0xbf22bf55
.long 0xbf0e3f35, 0x3e48bf6d, 0x3f0ebf35, 0xbe483f6d, 0xbdc93f6d, 0xbef1bf7b, 0xbf7fbec4, 0x3f62be48
.long 0x3ec43f80, 0xbf6dbf35, 0x3ec43f80, 0xbf6dbf35, 0x3f463f6d, 0xbf75be48, 0x3f22bec4, 0x3e953f7b
.long 0x3f7b3f35, 0xbf0e3ec4, 0xbf7bbf35, 0x3f0ebec4, 0x3f753ec4, 0x3dc93f55, 0x3e953f6d, 0xbf7fbf0e
.long 0x3f35250d, 0x3f353f80, 0x3f35250d, 0x3f353f80, 0x3e95bec4, 0x3f7f3f55, 0xbf75bf6d, 0x3dc9bf0e
.long 0xbe48bf35, 0x3f553ec4, 0x3e483f35, 0xbf55bec4, 0xbf22bf6d, 0x3e95be48, 0x3f463ec4, 0x3f753f7b
.long 0xbf6dbf80, 0xbec4bf35, 0xbf6dbf80, 0xbec4bf35, 0xbf7fbf6d, 0xbf62bf7b, 0x3dc93ec4, 0xbef1be48
.long 0xbf55bf35, 0xbf7bbf6d, 0x3f553f35, 0x3f7b3f6d, 0xbef1bec4, 0xbf22bf0e, 0xbf62bf6d, 0xbf46bf55
.long 0xbf800000, 0x3f80250d, 0xbf800000, 0x3f80250d, 0xbf223f35, 0x3ef1bf55, 0x3f463f35, 0xbf62bf0e
.long 0x3e483f80, 0xbf0ebf6d, 0xbe48bf80, 0x3f0e3f6d, 0x3f623f35, 0xbf7fbe48, 0xbef13f35, 0xbdc9bf7b
.long 0x3f6d250d, 0xbec43f35, 0x3f6d250d, 0xbec43f35, 0x3e95bf35, 0x3f223f7b, 0xbf75bf35, 0x3f46be48
.long 0xbf0ebf80, 0x3f7b3ec4, 0x3f0e3f80, 0xbf7bbec4, 0xbf7fbf35, 0x3e95bf0e, 0x3dc9bf35, 0x3f753f55
.long 0xbf350000, 0xbf35bf80, 0xbf350000, 0xbf35bf80, 0x3dc93f35, 0xbf75bf0e, 0x3f7f3f35, 0x3e953f55
.long 0x3f553f80, 0xbe483ec4, 0xbf55bf80, 0x3e48bec4, 0x3f753f35, 0x3f463f7b, 0x3e953f35, 0xbf22be48
.long 0x3ec4250d, 0x3f6d3f35, 0x3ec4250d, 0x3f6d3f35, 0xbef1bf35, 0x3dc9be48, 0xbf62bf35, 0xbf7fbf7b
.long 0xbf7bbf80, 0xbf55bf6d, 0x3f7b3f80, 0x3f553f6d, 0xbf46bf35, 0xbf62bf55, 0xbf22bf35, 0xbef1bf0e
.long 0xbf800000, 0x3f80250d, 0xbf800000, 0x3f80250d, 0xbe953f6d, 0x3dc9bf7b, 0x3f753ec4, 0xbf7fbe48
.long 0x3f553f35, 0xbf7bbec4, 0xbf55bf35, 0x3f7b3ec4, 0x3f46bec4, 0xbe953f55, 0x3f223f6d, 0xbf75bf0e
.long 0xbec4bf80, 0x3f6d3f35, 0xbec4bf80, 0x3f6d3f35, 0xbf7fbec4, 0x3ef1bf0e, 0x3dc93f6d, 0xbf62bf55
.long 0xbe483f35, 0xbf55bf6d, 0x3e48bf35, 0x3f553f6d, 0x3f623f6d, 0xbf223e48, 0xbef13ec4, 0xbf46bf7b
.long 0x3f35250d, 0x3f353f80, 0x3f35250d, 0x3f353f80, 0xbef1bf6d, 0x3f463e48, 0xbf62bec4, 0xbf22bf7b
.long 0xbf7bbf35, 0xbf0ebf6d, 0x3f7b3f35, 0x3f0e3f6d, 0xbdc93ec4, 0xbf62bf0e, 0xbf7fbf6d, 0xbef1bf55
.long 0x3f6d3f80, 0x3ec43f35, 0x3f6d3f80, 0x3ec43f35, 0x3f223ec4, 0x3f753f55, 0xbf46bf6d, 0xbe95bf0e
.long 0xbf0ebf35, 0xbe48bec4, 0x3f0e3f35, 0x3e483ec4, 0xbf75bf6d, 0xbf7fbf7b, 0xbe95bec4, 0xbdc9be48
.long 0xbf800000, 0x3f80250d, 0xbf800000, 0x3f80250d, 0x3f7f250d, 0xbf753e48, 0xbdc9bf80, 0x3e953f7b
.long 0xbf7b0000, 0x3f55bec4, 0x3f7b250d, 0xbf553ec4, 0x3f75250d, 0xbf223f0e, 0x3e953f80, 0xbf46bf55
.long 0xbf6d0000, 0x3ec4bf35, 0xbf6d0000, 0x3ec4bf35, 0x3f62250d, 0xbdc93f55, 0xbef1bf80, 0x3f7f3f0e
.long 0xbf550000, 0xbe48bf6d, 0x3f55250d, 0x3e483f6d, 0x3f46250d, 0x3ef13f7b, 0x3f223f80, 0xbf62be48
.long 0xbf350000, 0xbf35bf80, 0xbf350000, 0xbf35bf80, 0x3f22250d, 0x3f623f7b, 0xbf46bf80, 0x3ef1be48
.long 0xbf0e0000, 0xbf7bbf6d, 0x3f0e250d, 0x3f7b3f6d, 0x3ef1250d, 0x3f7f3f55, 0x3f623f80, 0x3dc93f0e
.long 0xbec40000, 0xbf6dbf35, 0xbec40000, 0xbf6dbf35, 0x3e95250d, 0x3f463f0e, 0xbf75bf80, 0xbf22bf55
.long 0xbe480000, 0xbf0ebec4, 0x3e48250d, 0x3f0e3ec4, 0x3dc9250d, 0x3e953e48, 0x3f7f3f80, 0x3f753f7b
.long 0xbf800000, 0x3f80250d, 0xbf800000, 0x3f80250d, 0x3f62bec4, 0xbf463f0e, 0xbef1bf6d, 0x3f223f55
.long 0xbf0e3f35, 0x3e48bf6d, 0x3f0ebf35, 0xbe483f6d, 0x3dc9bf6d, 0x3ef13f7b, 0x3f7f3ec4, 0xbf623e48
.long 0x3ec43f80, 0xbf6dbf35, 0x3ec43f80, 0xbf6dbf35, 0xbf46bf6d, 0x3f753e48, 0xbf223ec4, 0xbe95bf7b
.long 0x3f7b3f35, 0xbf0e3ec4, 0xbf7bbf35, 0x3f0ebec4, 0xbf75bec4, 0xbdc9bf55, 0xbe95bf6d, 0x3f7f3f0e
.long 0x3f35250d, 0x3f353f80, 0x3f35250d, 0x3f353f80, 0xbe953ec4, 0xbf7fbf55, 0x3f753f6d, 0xbdc93f0e
.long 0xbe48bf35, 0x3f553ec4, 0x3e483f35, 0xbf55bec4, 0x3f223f6d, 0xbe953e48, 0xbf46bec4, 0xbf75bf7b
.long 0xbf6dbf80, 0xbec4bf35, 0xbf6dbf80, 0xbec4bf35, 0x3f7f3f6d, 0x3f623f7b, 0xbdc9bec4, 0x3ef13e48
.long 0xbf55bf35, 0xbf7bbf6d, 0x3f553f35, 0x3f7b3f6d, 0x3ef13ec4, 0x3f223f0e, 0x3f623f6d, 0x3f463f55
.long 0xbf800000, 0x3f80250d, 0xbf800000, 0x3f80250d, 0x3f22bf35, 0xbef13f55, 0xbf46bf35, 0x3f623f0e
.long 0x3e483f80, 0xbf0ebf6d, 0xbe48bf80, 0x3f0e3f6d, 0xbf62bf35, 0x3f7f3e48, 0x3ef1bf35, 0x3dc93f7b
.long 0x3f6d250d, 0xbec43f35, 0x3f6d250d, 0xbec43f35, 0xbe953f35, 0xbf22bf7b, 0x3f753f35, 0xbf463e48
.long 0xbf0ebf80, 0x3f7b3ec4, 0x3f0e3f80, 0xbf7bbec4, 0x3f7f3f35, 0xbe953f0e, 0xbdc93f35, 0xbf75bf55
.long 0xbf350000, 0xbf35bf80, 0xbf350000, 0xbf35bf80, 0xbdc9bf35, 0x3f753f0e, 0xbf7fbf35, 0xbe95bf55
.long 0x3f553f80, 0xbe483ec4, 0xbf55bf80, 0x3e48bec4, 0xbf75bf35, 0xbf46bf7b, 0xbe95bf35, 0x3f223e48
.long 0x3ec4250d, 0x3f6d3f35, 0x3ec4250d, 0x3f6d3f35, 0x3ef13f35, 0xbdc93e48, 0x3f623f35, 0x3f7f3f7b
.long 0xbf7bbf80, 0xbf55bf6d, 0x3f7b3f80, 0x3f553f6d, 0x3f463f35, 0x3f623f55, 0x3f223f35, 0x3ef13f0e
.long 0xbf800000, 0x3f80250d, 0xbf800000, 0x3f80250d, 0x3e95bf6d, 0xbdc93f7b, 0xbf75bec4, 0x3f7f3e48
.long 0x3f553f35, 0xbf7bbec4, 0xbf55bf35, 0x3f7b3ec4, 0xbf463ec4, 0x3e95bf55, 0xbf22bf6d, 0x3f753f0e
.long 0xbec4bf80, 0x3f6d3f35, 0xbec4bf80, 0x3f6d3f35, 0x3f7f3ec4, 0xbef13f0e, 0xbdc9bf6d, 0x3f623f55
.long 0xbe483f35, 0xbf55bf6d, 0x3e48bf35, 0x3f553f6d, 0xbf62bf6d, 0x3f22be48, 0x3ef1bec4, 0x3f463f7b
.long 0x3f35250d, 0x3f353f80, 0x3f35250d, 0x3f353f80, 0x3ef13f6d, 0xbf46be48, 0x3f623ec4, 0x3f223f7b
.long 0xbf7bbf35, 0xbf0ebf6d, 0x3f7b3f35, 0x3f0e3f6d, 0x3dc9bec4, 0x3f623f0e, 0x3f7f3f6d, 0x3ef13f55
.long 0x3f6d3f80, 0x3ec43f35, 0x3f6d3f80, 0x3ec43f35, 0xbf22bec4, 0xbf75bf55, 0x3f463f6d, 0x3e953f0e
.long 0xbf0ebf35, 0xbe48bec4, 0x3f0e3f35, 0x3e483ec4, 0x3f753f6d, 0x3f7f3f7b, 0x3e953ec4, 0x3dc93e48
```
